```python
import torch

def _softmax(x, axis=-1):
    return torch.softmax(x, dim=axis)
def _gelu(x):
    return torch.nn.functional.gelu(x, approximate="tanh")
def _silu(x):
    return torch.nn.functional.silu(x)
def _sigmoid(x):
    return torch.sigmoid(x)
def _layernorm(x, axis=-1, eps=1e-5):
    m = x.mean(dim=axis, keepdim=True)
    v = x.var(dim=axis, keepdim=True, unbiased=False)
    return (x - m) / torch.sqrt(v + eps)
def _scatter_add(tgt, idx, src, axis=0):
    return tgt.clone().index_add_(axis, idx, src)
def _segment_sum(src, seg, n):
    out = torch.zeros((n,) + src.shape[1:], dtype=src.dtype)
    return out.index_add_(0, seg, src)
def _pad(x, pw):
    flat = tuple(v for pair in reversed(pw) for v in pair)
    return torch.nn.functional.pad(x, flat)

kernel_name = 'parallel_sum__spectral_gfnet__glu_gated_geglu__prompt'

def setup_inputs():

    _w = (lambda a: (lambda t: t.to(torch.bfloat16) if t.is_floating_point() else t)(torch.as_tensor(a)))
    def _A_setup():
        B, S, D = 1, 2048, 448
        Df = D // 2 + 1
        return {
            "x": _w((lambda *s: torch.randn(*s, dtype=torch.bfloat16) * 0.05)(B, S, D)),
            "w_r": _w((lambda *s: torch.randn(*s, dtype=torch.bfloat16) * 0.8)(S, Df) * 0.02),
            "w_i": _w((lambda *s: torch.randn(*s, dtype=torch.bfloat16) * 0.8)(S, Df) * 0.02),
        }
    _A_in = _A_setup()

    def _B_setup():
        B, S, Dm, Df = 1, 2048, 448, 1792
        return {
            "x": _w((lambda *s: torch.randn(*s, dtype=torch.bfloat16) * 0.05)(B, S, Dm)),
            "w_gate": _w((lambda *s: torch.randn(*s, dtype=torch.bfloat16) * 0.4)(Dm, Df) * (Dm ** -0.5)),
            "w_up": _w((lambda *s: torch.randn(*s, dtype=torch.bfloat16) * 0.4)(Dm, Df) * (Dm ** -0.5)),
            "w_down": _w((lambda *s: torch.randn(*s, dtype=torch.bfloat16) * 0.4)(Df, Dm) * (Df ** -0.5)),
        }
    _B_in = _B_setup()

    return {
        "A_x": _A_in["x"],
        "A_w_r": _A_in["w_r"],
        "A_w_i": _A_in["w_i"],
        "B_x": _B_in["x"],
        "B_w_gate": _B_in["w_gate"],
        "B_w_up": _B_in["w_up"],
        "B_w_down": _B_in["w_down"],
    }

def reference(A_x, A_w_r, A_w_i, B_x, B_w_gate, B_w_up, B_w_down):
    def _A_ref(x, w_r, w_i):
        B, S, D = x.shape
        X = (lambda x, axes=(-2,-1): torch.fft.rfft2(x.float(), dim=axes))(x, axes=(-2, -1))
        W = w_r + 1j * w_i
        X = X * W
        y = (lambda x, s, axes=(-2,-1): torch.fft.irfft2(x, s=s, dim=axes).to(torch.bfloat16))(X, (S, D), axes=(-2, -1))
        return y

    def _B_ref(x, w_gate, w_up, w_down):
        g = torch.einsum("bsd,df->bsf", x, w_gate)
        u = torch.einsum("bsd,df->bsf", x, w_up)
        h = _gelu(g) * u
        return torch.einsum("bsf,fd->bsd", h, w_down)

    x = A_x
    xn = _layernorm(x, axis=-1)
    return x + _A_ref(xn, A_w_r, A_w_i) + _B_ref(xn, B_w_gate, B_w_up, B_w_down)
```

```asm
; @launch kernel=k0_kernel grid=(256,1,1) block=(576,1,1) lds=64000
; @launch kernel=k1_kernel grid=(256,1,1) block=(512,1,1) lds=122880
; @launch kernel=k3_kernel grid=(224,1,1) block=(256,1,1) lds=151552
.amdgcn_target "amdgcn-amd-amdhsa--gfx950"
.text
.globl k0_kernel
.p2align 8
.type k0_kernel,@function
k0_kernel:
    s_cmp_ge_u32 s2, 256
    s_cbranch_scc1 K0_end
    s_load_dwordx16 s[4:19], s[0:1], 0
    s_load_dwordx4 s[20:23], s[0:1], 64
    s_getpc_b64 s[58:59]
    s_add_u32 s58, s58, t1tab@rel32@lo+4
    s_addc_u32 s59, s59, t1tab@rel32@hi+12
    s_getpc_b64 s[56:57]
    s_add_u32 s56, s56, gdftab@rel32@lo+4
    s_addc_u32 s57, s57, gdftab@rel32@hi+12
    v_lshrrev_b32 v1, 6, v0
    s_nop 0
    v_readfirstlane_b32 s52, v1
    v_and_b32 v1, 63, v0
    v_lshlrev_b32 v2, 4, v1
    s_cmp_lg_u32 s52, 8
    s_cbranch_scc1 K0_npf
    s_mov_b32 s35, 0x00020000
    s_getpc_b64 s[32:33]
    s_add_u32 s32, s32, k0_kernel@rel32@lo+4
    s_addc_u32 s33, s33, k0_kernel@rel32@hi+12
    s_and_b32 s33, s33, 0xffff
    s_mov_b32 s34, K3_end-k0_kernel
    s_lshr_b32 s67, s2, 3
    s_lshl_b32 s67, s67, 10
    buffer_load_dwordx4 v[32:35], v2, s[32:35], s67 offen
K0_npf:
    s_bfe_u32 s53, s2, 0x20003
    s_lshr_b32 s54, s2, 6
    s_lshl_b32 s54, s54, 4
    s_and_b32 s55, s2, 7
    s_lshl_b32 s55, s55, 1
    s_add_u32 s54, s54, s55
    s_bfe_u32 s55, s2, 0x10005
    s_add_u32 s54, s54, s55
    s_lshr_b32 s65, s54, 5
    s_lshl_b32 s65, s65, 4
    s_bfe_u32 s66, s54, 0x10004
    s_lshl_b32 s66, s66, 2
    s_add_u32 s65, s65, s66
    s_lshr_b32 s66, s52, 2
    s_lshl_b32 s66, s66, 3
    s_and_b32 s67, s52, 3
    s_add_u32 s66, s66, s67
    s_add_u32 s55, s65, s66
    s_lshl_b32 s55, s55, 4
    s_and_b32 s68, s54, 15
    s_add_u32 s55, s55, s68
    s_mul_i32 s55, s55, 3584
    s_mov_b32 s60, 0x3f803f80
    v_mov_b32 v40, 0
    v_mov_b32 v41, 0
    v_mov_b32 v42, 0
    v_mov_b32 v43, 0
    v_mov_b32 v44, 0
    v_mov_b32 v45, 0
    v_mov_b32 v46, 0
    v_mov_b32 v47, 0
    v_mov_b32 v48, 0
    v_mov_b32 v49, 0
    v_mov_b32 v50, 0
    v_mov_b32 v51, 0
    v_mov_b32 v52, 0
    v_mov_b32 v53, 0
    v_mov_b32 v54, 0
    v_mov_b32 v55, 0
    v_lshlrev_b32 v2, 4, v1
    s_waitcnt lgkmcnt(0)
    s_mov_b32 s24, s4
    s_and_b32 s25, s5, 0xffff
    s_mov_b32 s26, 1835008
    s_mov_b32 s27, 0x00020000
    s_cmp_eq_u32 s52, 8
    s_cbranch_scc1 K0_nox
    s_mov_b32 exec_hi, 0x00ffffff
    buffer_load_dwordx4 v[40:43], v2, s[24:27], s55 offen offset:0
    buffer_load_dwordx4 v[44:47], v2, s[24:27], s55 offen offset:896
    buffer_load_dwordx4 v[48:51], v2, s[24:27], s55 offen offset:1792
    buffer_load_dwordx4 v[52:55], v2, s[24:27], s55 offen offset:2688
    s_mov_b32 exec_hi, -1
K0_nox:
    s_mov_b32 s36, s22
    s_and_b32 s37, s23, 0xffff
    s_mov_b32 s38, 268435456
    s_mov_b32 s39, 0x00020000
    s_mov_b32 s40, s6
    s_and_b32 s41, s7, 0xffff
    s_mov_b32 s42, 921600
    s_mov_b32 s43, 0x00020000
    s_mov_b32 s44, s8
    s_and_b32 s45, s9, 0xffff
    s_mov_b32 s46, 921600
    s_mov_b32 s47, 0x00020000
    s_mov_b32 s48, s16
    s_and_b32 s49, s17, 0xffff
    s_mov_b32 s50, 1605632
    s_mov_b32 s51, 0x00020000
    s_mov_b32 s28, s58
    s_and_b32 s29, s59, 0xffff
    s_mov_b32 s30, 229376
    s_mov_b32 s31, 0x00020000
    v_lshrrev_b32 v7, 5, v1
    v_min_u32 v18, 55, v1
    v_lshlrev_b32 v18, 4, v18
    s_barrier
    s_mov_b32 s70, 0x05040100
    s_mov_b32 s71, 0x07060302
    s_cmp_eq_u32 s52, 8
    s_cbranch_scc1 K0_w8
    s_and_b32 s73, s52, 1
    s_bfe_u32 s74, s52, 0x10001
    s_lshr_b32 s75, s52, 2
    s_lshl_b32 s76, s53, 1
    s_add_u32 s76, s76, s73
    s_lshl_b32 s77, s76, 1
    s_add_u32 s77, s77, s74
    s_lshl_b32 s77, s77, 1
    s_add_u32 s77, s77, s75
    s_mul_i32 s77, s77, 7168
    buffer_load_dwordx4 v[96:99], v2, s[28:31], s77 offen offset:0
    buffer_load_dwordx4 v[100:103], v2, s[28:31], s77 offen offset:1024
    buffer_load_dwordx4 v[104:107], v2, s[28:31], s77 offen offset:2048
    buffer_load_dwordx4 v[108:111], v2, s[28:31], s77 offen offset:3072
    s_add_u32 s77, s77, 4096
    buffer_load_dwordx4 v[112:115], v2, s[28:31], s77 offen offset:0
    buffer_load_dwordx4 v[116:119], v2, s[28:31], s77 offen offset:1024
    buffer_load_dwordx4 v[120:123], v2, s[28:31], s77 offen offset:2048
    v_and_b32 v4, 31, v1
    s_movk_i32 s61, 912
    v_mul_lo_u32 v4, v4, s61
    v_lshrrev_b32 v5, 4, v1
    v_and_b32 v6, 7, v1
    v_lshl_add_u32 v8, v5, 3, v6
    v_mul_lo_u32 v8, v8, s61
    v_and_b32 v9, 8, v1
    v_add_u32 v8, v8, v9
    v_mul_u32_u24 v5, 28672, v5
    v_lshl_add_u32 v5, v9, 6, v5
    v_and_b32 v9, 4, v6
    v_lshl_add_u32 v5, v9, 5, v5
    v_and_b32 v9, 3, v6
    v_lshl_add_u32 v16, v9, 4, v5
    v_mov_b32 v5, v8
    v_lshl_add_u32 v4, v7, 4, v4
    s_mul_i32 s61, s74, 448
    s_mul_i32 s62, s75, 224
    s_add_u32 s61, s61, s62
    v_add_u32 v4, s61, v4
    s_mul_i32 s61, s53, 7
    s_add_u32 s61, s61, s52
    s_lshl_b32 s63, s61, 4
    v_add_u32 v5, s63, v5
    s_mul_i32 s69, s68, 112
    s_add_u32 s69, s69, s61
    s_lshl_b32 s69, s69, 10
    s_lshl_b32 s62, s65, 4
    s_add_u32 s69, s69, s62
    s_add_u32 s69, s69, 15210496
    s_mul_i32 s61, s52, 4352
    s_add_u32 s61, s61, 29184
    v_add_u32 v17, s61, v2
    v_and_b32 v13, 3, v1
    v_lshrrev_b32 v15, 2, v1
    s_lshl_b32 s62, s75, 4
    v_add_u32 v15, s62, v15
    v_mul_u32_u24 v32, 1088, v13
    v_lshl_add_u32 v32, v15, 4, v32
    s_mul_i32 s61, s73, 4352
    s_add_u32 s61, s61, 29184
    v_add_u32 v32, s61, v32
    v_and_b32 v14, 1, v15
    v_and_b32 v15, 30, v15
    s_lshl_b32 s61, s76, 5
    v_add_u32 v15, s61, v15
    s_lshl_b32 s63, s74, 1
    s_sub_u32 s63, 224, s63
    s_cmp_eq_u32 s74, 0
    s_cselect_b32 s61, 1, -1
    s_cselect_b32 s62, 0, 448
    s_cselect_b32 s64, 0, 0x80000000
    v_mul_lo_u32 v19, v15, s61
    v_add_u32 v19, s62, v19
    v_add_u32 v19, v19, v14
    v_lshlrev_b32 v19, 12, v19
    v_lshl_add_u32 v19, v13, 4, v19
    v_lshlrev_b32 v9, 31, v14
    v_and_b32 v9, s64, v9
    v_xor_b32 v33, 1.0, v9
    v_xor_b32 v34, s64, v33
    s_lshr_b32 s61, s68, 3
    s_lshl_b32 s61, s61, 11
    s_and_b32 s62, s68, 7
    s_lshl_b32 s62, s62, 6
    s_add_u32 s61, s61, s62
    s_lshr_b32 s62, s54, 4
    s_lshl_b32 s62, s62, 9
    s_add_u32 s61, s61, s62
    s_add_u32 s72, s61, 13113344
    v_cmp_ge_u32 s[78:79], s63, v15
    s_waitcnt vmcnt(7)
    v_dot2_f32_bf16 v8, v40, s60, 0
    v_dot2_f32_bf16 v12, v41, s60, 0
    v_dot2_f32_bf16 v9, v44, s60, 0
    v_dot2_f32_bf16 v13, v45, s60, 0
    v_dot2_f32_bf16 v10, v48, s60, 0
    v_dot2_f32_bf16 v14, v49, s60, 0
    v_dot2_f32_bf16 v11, v52, s60, 0
    v_dot2_f32_bf16 v15, v53, s60, 0
    v_dot2_f32_bf16 v8, v42, s60, v8
    v_dot2_f32_bf16 v12, v43, s60, v12
    v_dot2_f32_bf16 v9, v46, s60, v9
    v_dot2_f32_bf16 v13, v47, s60, v13
    v_dot2_f32_bf16 v10, v50, s60, v10
    v_dot2_f32_bf16 v14, v51, s60, v14
    v_dot2_f32_bf16 v11, v54, s60, v11
    v_dot2_f32_bf16 v15, v55, s60, v15
    s_nop 3
    v_add_f32 v8, v8, v12
    v_add_f32 v9, v9, v13
    v_add_f32 v10, v10, v14
    v_add_f32 v11, v11, v15
    s_nop 1
    v_add_f32_dpp v8, v8, v8 row_shr:1 row_mask:0xf bank_mask:0xf bound_ctrl:0
    v_add_f32_dpp v9, v9, v9 row_shr:1 row_mask:0xf bank_mask:0xf bound_ctrl:0
    v_add_f32_dpp v10, v10, v10 row_shr:1 row_mask:0xf bank_mask:0xf bound_ctrl:0
    v_add_f32_dpp v11, v11, v11 row_shr:1 row_mask:0xf bank_mask:0xf bound_ctrl:0
    v_add_f32_dpp v8, v8, v8 row_shr:2 row_mask:0xf bank_mask:0xf bound_ctrl:0
    v_add_f32_dpp v9, v9, v9 row_shr:2 row_mask:0xf bank_mask:0xf bound_ctrl:0
    v_add_f32_dpp v10, v10, v10 row_shr:2 row_mask:0xf bank_mask:0xf bound_ctrl:0
    v_add_f32_dpp v11, v11, v11 row_shr:2 row_mask:0xf bank_mask:0xf bound_ctrl:0
    v_add_f32_dpp v8, v8, v8 row_shr:4 row_mask:0xf bank_mask:0xf bound_ctrl:0
    v_add_f32_dpp v9, v9, v9 row_shr:4 row_mask:0xf bank_mask:0xf bound_ctrl:0
    v_add_f32_dpp v10, v10, v10 row_shr:4 row_mask:0xf bank_mask:0xf bound_ctrl:0
    v_add_f32_dpp v11, v11, v11 row_shr:4 row_mask:0xf bank_mask:0xf bound_ctrl:0
    v_add_f32_dpp v8, v8, v8 row_shr:8 row_mask:0xf bank_mask:0xf bound_ctrl:0
    v_add_f32_dpp v9, v9, v9 row_shr:8 row_mask:0xf bank_mask:0xf bound_ctrl:0
    v_add_f32_dpp v10, v10, v10 row_shr:8 row_mask:0xf bank_mask:0xf bound_ctrl:0
    v_add_f32_dpp v11, v11, v11 row_shr:8 row_mask:0xf bank_mask:0xf bound_ctrl:0
    v_add_f32_dpp v8, v8, v8 row_bcast:15 row_mask:0xa bank_mask:0xf
    v_add_f32_dpp v9, v9, v9 row_bcast:15 row_mask:0xa bank_mask:0xf
    v_add_f32_dpp v10, v10, v10 row_bcast:15 row_mask:0xa bank_mask:0xf
    v_add_f32_dpp v11, v11, v11 row_bcast:15 row_mask:0xa bank_mask:0xf
    v_add_f32_dpp v8, v8, v8 row_bcast:31 row_mask:0xc bank_mask:0xf
    v_add_f32_dpp v9, v9, v9 row_bcast:31 row_mask:0xc bank_mask:0xf
    v_add_f32_dpp v10, v10, v10 row_bcast:31 row_mask:0xc bank_mask:0xf
    v_add_f32_dpp v11, v11, v11 row_bcast:31 row_mask:0xc bank_mask:0xf
    v_readlane_b32 s61, v8, 63
    v_readlane_b32 s62, v9, 63
    v_readlane_b32 s63, v10, 63
    v_readlane_b32 s64, v11, 63
    s_nop 1
    v_mov_b32 v8, s61
    v_mov_b32 v9, s62
    v_mov_b32 v10, s63
    v_mov_b32 v11, s64
    v_mul_f32 v8, 0x3b124925, v8
    v_mul_f32 v9, 0x3b124925, v9
    v_mul_f32 v10, 0x3b124925, v10
    v_mul_f32 v11, 0x3b124925, v11
    v_cvt_pk_bf16_f32 v88, v8, v8
    v_cvt_pk_bf16_f32 v90, v9, v9
    v_cvt_pk_bf16_f32 v92, v10, v10
    v_cvt_pk_bf16_f32 v94, v11, v11
    v_and_b32 v88, 0xffff0000, v88
    v_and_b32 v90, 0xffff0000, v90
    v_and_b32 v92, 0xffff0000, v92
    v_and_b32 v94, 0xffff0000, v94
    v_lshlrev_b32 v56, 16, v40
    v_and_b32 v57, 0xffff0000, v40
    v_lshlrev_b32 v58, 16, v41
    v_and_b32 v59, 0xffff0000, v41
    v_lshlrev_b32 v60, 16, v42
    v_and_b32 v61, 0xffff0000, v42
    v_lshlrev_b32 v62, 16, v43
    v_and_b32 v63, 0xffff0000, v43
    v_mov_b32 v89, v88
    v_pk_add_f32 v[56:57], v[56:57], v[88:89] neg_lo:[0,1] neg_hi:[0,1]
    v_pk_add_f32 v[58:59], v[58:59], v[88:89] neg_lo:[0,1] neg_hi:[0,1]
    v_pk_add_f32 v[60:61], v[60:61], v[88:89] neg_lo:[0,1] neg_hi:[0,1]
    v_pk_add_f32 v[62:63], v[62:63], v[88:89] neg_lo:[0,1] neg_hi:[0,1]
    v_pk_mul_f32 v[24:25], v[56:57], v[56:57]
    v_pk_fma_f32 v[24:25], v[58:59], v[58:59], v[24:25]
    v_pk_fma_f32 v[24:25], v[60:61], v[60:61], v[24:25]
    v_pk_fma_f32 v[24:25], v[62:63], v[62:63], v[24:25]
    v_add_f32 v20, v24, v25
    v_lshlrev_b32 v64, 16, v44
    v_and_b32 v65, 0xffff0000, v44
    v_lshlrev_b32 v66, 16, v45
    v_and_b32 v67, 0xffff0000, v45
    v_lshlrev_b32 v68, 16, v46
    v_and_b32 v69, 0xffff0000, v46
    v_lshlrev_b32 v70, 16, v47
    v_and_b32 v71, 0xffff0000, v47
    v_mov_b32 v91, v90
    v_pk_add_f32 v[64:65], v[64:65], v[90:91] neg_lo:[0,1] neg_hi:[0,1]
    v_pk_add_f32 v[66:67], v[66:67], v[90:91] neg_lo:[0,1] neg_hi:[0,1]
    v_pk_add_f32 v[68:69], v[68:69], v[90:91] neg_lo:[0,1] neg_hi:[0,1]
    v_pk_add_f32 v[70:71], v[70:71], v[90:91] neg_lo:[0,1] neg_hi:[0,1]
    v_pk_mul_f32 v[26:27], v[64:65], v[64:65]
    v_pk_fma_f32 v[26:27], v[66:67], v[66:67], v[26:27]
    v_pk_fma_f32 v[26:27], v[68:69], v[68:69], v[26:27]
    v_pk_fma_f32 v[26:27], v[70:71], v[70:71], v[26:27]
    v_add_f32 v21, v26, v27
    v_lshlrev_b32 v72, 16, v48
    v_and_b32 v73, 0xffff0000, v48
    v_lshlrev_b32 v74, 16, v49
    v_and_b32 v75, 0xffff0000, v49
    v_lshlrev_b32 v76, 16, v50
    v_and_b32 v77, 0xffff0000, v50
    v_lshlrev_b32 v78, 16, v51
    v_and_b32 v79, 0xffff0000, v51
    v_mov_b32 v93, v92
    v_pk_add_f32 v[72:73], v[72:73], v[92:93] neg_lo:[0,1] neg_hi:[0,1]
    v_pk_add_f32 v[74:75], v[74:75], v[92:93] neg_lo:[0,1] neg_hi:[0,1]
    v_pk_add_f32 v[76:77], v[76:77], v[92:93] neg_lo:[0,1] neg_hi:[0,1]
    v_pk_add_f32 v[78:79], v[78:79], v[92:93] neg_lo:[0,1] neg_hi:[0,1]
    v_pk_mul_f32 v[28:29], v[72:73], v[72:73]
    v_pk_fma_f32 v[28:29], v[74:75], v[74:75], v[28:29]
    v_pk_fma_f32 v[28:29], v[76:77], v[76:77], v[28:29]
    v_pk_fma_f32 v[28:29], v[78:79], v[78:79], v[28:29]
    v_add_f32 v22, v28, v29
    v_lshlrev_b32 v80, 16, v52
    v_and_b32 v81, 0xffff0000, v52
    v_lshlrev_b32 v82, 16, v53
    v_and_b32 v83, 0xffff0000, v53
    v_lshlrev_b32 v84, 16, v54
    v_and_b32 v85, 0xffff0000, v54
    v_lshlrev_b32 v86, 16, v55
    v_and_b32 v87, 0xffff0000, v55
    v_mov_b32 v95, v94
    v_pk_add_f32 v[80:81], v[80:81], v[94:95] neg_lo:[0,1] neg_hi:[0,1]
    v_pk_add_f32 v[82:83], v[82:83], v[94:95] neg_lo:[0,1] neg_hi:[0,1]
    v_pk_add_f32 v[84:85], v[84:85], v[94:95] neg_lo:[0,1] neg_hi:[0,1]
    v_pk_add_f32 v[86:87], v[86:87], v[94:95] neg_lo:[0,1] neg_hi:[0,1]
    v_pk_mul_f32 v[30:31], v[80:81], v[80:81]
    v_pk_fma_f32 v[30:31], v[82:83], v[82:83], v[30:31]
    v_pk_fma_f32 v[30:31], v[84:85], v[84:85], v[30:31]
    v_pk_fma_f32 v[30:31], v[86:87], v[86:87], v[30:31]
    v_add_f32 v23, v30, v31
    v_cmp_gt_u32 vcc, 56, v1
    s_nop 1
    v_cndmask_b32 v20, 0, v20, vcc
    v_cndmask_b32 v21, 0, v21, vcc
    v_cndmask_b32 v22, 0, v22, vcc
    v_cndmask_b32 v23, 0, v23, vcc
    s_nop 1
    v_add_f32_dpp v20, v20, v20 row_shr:1 row_mask:0xf bank_mask:0xf bound_ctrl:0
    v_add_f32_dpp v21, v21, v21 row_shr:1 row_mask:0xf bank_mask:0xf bound_ctrl:0
    v_add_f32_dpp v22, v22, v22 row_shr:1 row_mask:0xf bank_mask:0xf bound_ctrl:0
    v_add_f32_dpp v23, v23, v23 row_shr:1 row_mask:0xf bank_mask:0xf bound_ctrl:0
    v_add_f32_dpp v20, v20, v20 row_shr:2 row_mask:0xf bank_mask:0xf bound_ctrl:0
    v_add_f32_dpp v21, v21, v21 row_shr:2 row_mask:0xf bank_mask:0xf bound_ctrl:0
    v_add_f32_dpp v22, v22, v22 row_shr:2 row_mask:0xf bank_mask:0xf bound_ctrl:0
    v_add_f32_dpp v23, v23, v23 row_shr:2 row_mask:0xf bank_mask:0xf bound_ctrl:0
    v_add_f32_dpp v20, v20, v20 row_shr:4 row_mask:0xf bank_mask:0xf bound_ctrl:0
    v_add_f32_dpp v21, v21, v21 row_shr:4 row_mask:0xf bank_mask:0xf bound_ctrl:0
    v_add_f32_dpp v22, v22, v22 row_shr:4 row_mask:0xf bank_mask:0xf bound_ctrl:0
    v_add_f32_dpp v23, v23, v23 row_shr:4 row_mask:0xf bank_mask:0xf bound_ctrl:0
    v_add_f32_dpp v20, v20, v20 row_shr:8 row_mask:0xf bank_mask:0xf bound_ctrl:0
    v_add_f32_dpp v21, v21, v21 row_shr:8 row_mask:0xf bank_mask:0xf bound_ctrl:0
    v_add_f32_dpp v22, v22, v22 row_shr:8 row_mask:0xf bank_mask:0xf bound_ctrl:0
    v_add_f32_dpp v23, v23, v23 row_shr:8 row_mask:0xf bank_mask:0xf bound_ctrl:0
    v_add_f32_dpp v20, v20, v20 row_bcast:15 row_mask:0xa bank_mask:0xf
    v_add_f32_dpp v21, v21, v21 row_bcast:15 row_mask:0xa bank_mask:0xf
    v_add_f32_dpp v22, v22, v22 row_bcast:15 row_mask:0xa bank_mask:0xf
    v_add_f32_dpp v23, v23, v23 row_bcast:15 row_mask:0xa bank_mask:0xf
    v_add_f32_dpp v20, v20, v20 row_bcast:31 row_mask:0xc bank_mask:0xf
    v_add_f32_dpp v21, v21, v21 row_bcast:31 row_mask:0xc bank_mask:0xf
    v_add_f32_dpp v22, v22, v22 row_bcast:31 row_mask:0xc bank_mask:0xf
    v_add_f32_dpp v23, v23, v23 row_bcast:31 row_mask:0xc bank_mask:0xf
    v_readlane_b32 s61, v20, 63
    v_readlane_b32 s62, v21, 63
    v_readlane_b32 s63, v22, 63
    v_readlane_b32 s64, v23, 63
    s_nop 1
    v_mov_b32 v20, s61
    v_mov_b32 v21, s62
    v_mov_b32 v22, s63
    v_mov_b32 v23, s64
    v_mul_f32 v20, 0x3b124925, v20
    v_mul_f32 v21, 0x3b124925, v21
    v_mul_f32 v22, 0x3b124925, v22
    v_mul_f32 v23, 0x3b124925, v23
    v_sub_f32 v12, v8, v88
    v_sub_f32 v13, v9, v90
    v_sub_f32 v14, v10, v92
    v_sub_f32 v15, v11, v94
    v_fma_f32 v20, -v12, v12, v20
    v_fma_f32 v21, -v13, v13, v21
    v_fma_f32 v22, -v14, v14, v22
    v_fma_f32 v23, -v15, v15, v23
    v_max_f32 v20, 0, v20
    v_max_f32 v21, 0, v21
    v_max_f32 v22, 0, v22
    v_max_f32 v23, 0, v23
    v_cvt_pk_bf16_f32 v20, v20, v20
    v_cvt_pk_bf16_f32 v21, v21, v21
    v_cvt_pk_bf16_f32 v22, v22, v22
    v_cvt_pk_bf16_f32 v23, v23, v23
    v_and_b32 v20, 0xffff0000, v20
    v_and_b32 v21, 0xffff0000, v21
    v_and_b32 v22, 0xffff0000, v22
    v_and_b32 v23, 0xffff0000, v23
    v_add_f32 v20, 0x3727c5ac, v20
    v_add_f32 v21, 0x3727c5ac, v21
    v_add_f32 v22, 0x3727c5ac, v22
    v_add_f32 v23, 0x3727c5ac, v23
    v_cvt_pk_bf16_f32 v20, v20, v20
    v_cvt_pk_bf16_f32 v21, v21, v21
    v_cvt_pk_bf16_f32 v22, v22, v22
    v_cvt_pk_bf16_f32 v23, v23, v23
    v_and_b32 v20, 0xffff0000, v20
    v_and_b32 v21, 0xffff0000, v21
    v_and_b32 v22, 0xffff0000, v22
    v_and_b32 v23, 0xffff0000, v23
    v_sqrt_f32 v20, v20
    v_sqrt_f32 v21, v21
    v_sqrt_f32 v22, v22
    v_sqrt_f32 v23, v23
    s_nop 0
    v_cvt_pk_bf16_f32 v20, v20, v20
    v_cvt_pk_bf16_f32 v21, v21, v21
    v_cvt_pk_bf16_f32 v22, v22, v22
    v_cvt_pk_bf16_f32 v23, v23, v23
    v_and_b32 v20, 0xffff0000, v20
    v_and_b32 v21, 0xffff0000, v21
    v_and_b32 v22, 0xffff0000, v22
    v_and_b32 v23, 0xffff0000, v23
    v_rcp_f32 v12, v20
    v_rcp_f32 v13, v21
    v_rcp_f32 v14, v22
    v_rcp_f32 v15, v23
    s_mul_i32 s61, s52, 912
    v_lshlrev_b32 v3, 3, v1
    v_add_u32 v3, s61, v3
    v_cvt_pk_bf16_f32 v40, v56, v57
    v_cvt_pk_bf16_f32 v41, v58, v59
    v_cvt_pk_bf16_f32 v42, v60, v61
    v_cvt_pk_bf16_f32 v43, v62, v63
    v_lshlrev_b32 v56, 16, v40
    v_and_b32 v57, 0xffff0000, v40
    v_lshlrev_b32 v58, 16, v41
    v_and_b32 v59, 0xffff0000, v41
    v_lshlrev_b32 v60, 16, v42
    v_and_b32 v61, 0xffff0000, v42
    v_lshlrev_b32 v62, 16, v43
    v_and_b32 v63, 0xffff0000, v43
    v_mov_b32 v88, v12
    v_mov_b32 v89, v12
    v_pk_mul_f32 v[56:57], v[56:57], v[88:89]
    v_pk_mul_f32 v[58:59], v[58:59], v[88:89]
    v_pk_mul_f32 v[60:61], v[60:61], v[88:89]
    v_pk_mul_f32 v[62:63], v[62:63], v[88:89]
    v_cvt_pk_bf16_f32 v40, v56, v57
    v_cvt_pk_bf16_f32 v41, v58, v59
    v_cvt_pk_bf16_f32 v42, v60, v61
    v_cvt_pk_bf16_f32 v43, v62, v63
    v_perm_b32 v56, v41, v40, s70
    v_perm_b32 v57, v43, v42, s70
    v_perm_b32 v58, v41, v40, s71
    v_perm_b32 v59, v43, v42, s71
    s_mov_b32 exec_hi, 0x00ffffff
    ds_write_b64 v3, v[56:57] offset:0
    ds_write_b64 v3, v[58:59] offset:448
    s_mov_b32 exec_hi, -1
    v_cvt_pk_bf16_f32 v44, v64, v65
    v_cvt_pk_bf16_f32 v45, v66, v67
    v_cvt_pk_bf16_f32 v46, v68, v69
    v_cvt_pk_bf16_f32 v47, v70, v71
    v_lshlrev_b32 v64, 16, v44
    v_and_b32 v65, 0xffff0000, v44
    v_lshlrev_b32 v66, 16, v45
    v_and_b32 v67, 0xffff0000, v45
    v_lshlrev_b32 v68, 16, v46
    v_and_b32 v69, 0xffff0000, v46
    v_lshlrev_b32 v70, 16, v47
    v_and_b32 v71, 0xffff0000, v47
    v_mov_b32 v90, v13
    v_mov_b32 v91, v13
    v_pk_mul_f32 v[64:65], v[64:65], v[90:91]
    v_pk_mul_f32 v[66:67], v[66:67], v[90:91]
    v_pk_mul_f32 v[68:69], v[68:69], v[90:91]
    v_pk_mul_f32 v[70:71], v[70:71], v[90:91]
    v_cvt_pk_bf16_f32 v44, v64, v65
    v_cvt_pk_bf16_f32 v45, v66, v67
    v_cvt_pk_bf16_f32 v46, v68, v69
    v_cvt_pk_bf16_f32 v47, v70, v71
    v_perm_b32 v64, v45, v44, s70
    v_perm_b32 v65, v47, v46, s70
    v_perm_b32 v66, v45, v44, s71
    v_perm_b32 v67, v47, v46, s71
    s_mov_b32 exec_hi, 0x00ffffff
    ds_write_b64 v3, v[64:65] offset:7296
    ds_write_b64 v3, v[66:67] offset:7744
    s_mov_b32 exec_hi, -1
    v_cvt_pk_bf16_f32 v48, v72, v73
    v_cvt_pk_bf16_f32 v49, v74, v75
    v_cvt_pk_bf16_f32 v50, v76, v77
    v_cvt_pk_bf16_f32 v51, v78, v79
    v_lshlrev_b32 v72, 16, v48
    v_and_b32 v73, 0xffff0000, v48
    v_lshlrev_b32 v74, 16, v49
    v_and_b32 v75, 0xffff0000, v49
    v_lshlrev_b32 v76, 16, v50
    v_and_b32 v77, 0xffff0000, v50
    v_lshlrev_b32 v78, 16, v51
    v_and_b32 v79, 0xffff0000, v51
    v_mov_b32 v92, v14
    v_mov_b32 v93, v14
    v_pk_mul_f32 v[72:73], v[72:73], v[92:93]
    v_pk_mul_f32 v[74:75], v[74:75], v[92:93]
    v_pk_mul_f32 v[76:77], v[76:77], v[92:93]
    v_pk_mul_f32 v[78:79], v[78:79], v[92:93]
    v_cvt_pk_bf16_f32 v48, v72, v73
    v_cvt_pk_bf16_f32 v49, v74, v75
    v_cvt_pk_bf16_f32 v50, v76, v77
    v_cvt_pk_bf16_f32 v51, v78, v79
    v_perm_b32 v72, v49, v48, s70
    v_perm_b32 v73, v51, v50, s70
    v_perm_b32 v74, v49, v48, s71
    v_perm_b32 v75, v51, v50, s71
    s_mov_b32 exec_hi, 0x00ffffff
    ds_write_b64 v3, v[72:73] offset:14592
    ds_write_b64 v3, v[74:75] offset:15040
    s_mov_b32 exec_hi, -1
    v_cvt_pk_bf16_f32 v52, v80, v81
    v_cvt_pk_bf16_f32 v53, v82, v83
    v_cvt_pk_bf16_f32 v54, v84, v85
    v_cvt_pk_bf16_f32 v55, v86, v87
    v_lshlrev_b32 v80, 16, v52
    v_and_b32 v81, 0xffff0000, v52
    v_lshlrev_b32 v82, 16, v53
    v_and_b32 v83, 0xffff0000, v53
    v_lshlrev_b32 v84, 16, v54
    v_and_b32 v85, 0xffff0000, v54
    v_lshlrev_b32 v86, 16, v55
    v_and_b32 v87, 0xffff0000, v55
    v_mov_b32 v94, v15
    v_mov_b32 v95, v15
    v_pk_mul_f32 v[80:81], v[80:81], v[94:95]
    v_pk_mul_f32 v[82:83], v[82:83], v[94:95]
    v_pk_mul_f32 v[84:85], v[84:85], v[94:95]
    v_pk_mul_f32 v[86:87], v[86:87], v[94:95]
    v_cvt_pk_bf16_f32 v52, v80, v81
    v_cvt_pk_bf16_f32 v53, v82, v83
    v_cvt_pk_bf16_f32 v54, v84, v85
    v_cvt_pk_bf16_f32 v55, v86, v87
    v_perm_b32 v80, v53, v52, s70
    v_perm_b32 v81, v55, v54, s70
    v_perm_b32 v82, v53, v52, s71
    v_perm_b32 v83, v55, v54, s71
    s_mov_b32 exec_hi, 0x00ffffff
    ds_write_b64 v3, v[80:81] offset:21888
    ds_write_b64 v3, v[82:83] offset:22336
    s_mov_b32 exec_hi, -1
    s_waitcnt vmcnt(0)
    s_branch K0_ln3
K0_w8:
    v_and_b32 v5, 7, v1
    v_and_b32 v6, 56, v1
    s_and_b32 s66, s2, 3
    s_lshl_b32 s66, s66, 6
    v_add_u32 v6, s66, v6
    v_min_u32 v6, 217, v6
    s_lshr_b32 s66, s2, 4
    s_bfe_u32 s67, s2, 0x20002
    s_lshl_b32 s67, s67, 3
    s_lshl_b32 s72, s66, 5
    s_add_u32 s72, s72, s67
    s_lshl_b32 s72, s72, 4
    s_add_u32 s72, s72, 11253760
    s_lshl_b32 s66, s66, 7
    s_add_u32 s66, s66, s67
    s_mul_i32 s66, s66, 450
    v_mul_u32_u24 v16, 450, v5
    v_lshl_add_u32 v16, v6, 1, v16
    v_add_u32 v17, 1, v6
    v_lshlrev_b32 v17, 13, v17
    v_lshl_add_u32 v17, v5, 4, v17
    buffer_load_dwordx4 v[40:43], v16, s[40:43], s66 offen
    buffer_load_dwordx4 v[56:59], v16, s[44:47], s66 offen
    s_add_u32 s66, s66, 14400
    buffer_load_dwordx4 v[44:47], v16, s[40:43], s66 offen
    buffer_load_dwordx4 v[60:63], v16, s[44:47], s66 offen
    s_add_u32 s66, s66, 14400
    buffer_load_dwordx4 v[48:51], v16, s[40:43], s66 offen
    buffer_load_dwordx4 v[64:67], v16, s[44:47], s66 offen
    s_add_u32 s66, s66, 14400
    buffer_load_dwordx4 v[52:55], v16, s[40:43], s66 offen
    buffer_load_dwordx4 v[68:71], v16, s[44:47], s66 offen
    s_getpc_b64 s[48:49]
    s_add_u32 s48, s48, ctab@rel32@lo+4
    s_addc_u32 s49, s49, ctab@rel32@hi+12
    s_and_b32 s49, s49, 0xffff
    s_mov_b32 s50, 53248
    s_lshr_b32 s66, s2, 3
    s_lshl_b32 s66, s66, 10
    buffer_load_dwordx4 v[32:35], v2, s[48:51], s66 offen
    s_add_u32 s66, s66, 32768
    buffer_load_dwordx4 v[32:35], v2, s[48:51], s66 offen
    s_mov_b32 s40, s12
    s_and_b32 s41, s13, 0xffff
    s_mov_b32 s42, 1605632
    s_mov_b32 s43, 0x00020000
    s_mov_b32 s44, s14
    s_and_b32 s45, s15, 0xffff
    s_mov_b32 s46, 1605632
    s_mov_b32 s47, 0x00020000
    s_lshr_b32 s66, s2, 3
    s_mul_i32 s66, s66, 50176
    s_and_b32 s67, s2, 7
    s_lshr_b32 s67, s67, 1
    s_mul_i32 s67, s67, 896
    s_add_u32 s66, s66, s67
    buffer_load_dwordx4 v[32:35], v18, s[40:43], s66 offen offset:0
    buffer_load_dwordx4 v[32:35], v18, s[44:47], s66 offen offset:0
    buffer_load_dwordx4 v[32:35], v18, s[40:43], s66 offen offset:3584
    buffer_load_dwordx4 v[32:35], v18, s[44:47], s66 offen offset:3584
    s_add_u32 s66, s66, 7168
    buffer_load_dwordx4 v[32:35], v18, s[40:43], s66 offen offset:0
    buffer_load_dwordx4 v[32:35], v18, s[44:47], s66 offen offset:0
    buffer_load_dwordx4 v[32:35], v18, s[40:43], s66 offen offset:3584
    buffer_load_dwordx4 v[32:35], v18, s[44:47], s66 offen offset:3584
    s_add_u32 s66, s66, 7168
    buffer_load_dwordx4 v[32:35], v18, s[40:43], s66 offen offset:0
    buffer_load_dwordx4 v[32:35], v18, s[44:47], s66 offen offset:0
    buffer_load_dwordx4 v[32:35], v18, s[40:43], s66 offen offset:3584
    buffer_load_dwordx4 v[32:35], v18, s[44:47], s66 offen offset:3584
    s_add_u32 s66, s66, 7168
    buffer_load_dwordx4 v[32:35], v18, s[40:43], s66 offen offset:0
    buffer_load_dwordx4 v[32:35], v18, s[44:47], s66 offen offset:0
    buffer_load_dwordx4 v[32:35], v18, s[40:43], s66 offen offset:3584
    buffer_load_dwordx4 v[32:35], v18, s[44:47], s66 offen offset:3584
    s_add_u32 s66, s66, 7168
    buffer_load_dwordx4 v[32:35], v18, s[40:43], s66 offen offset:0
    buffer_load_dwordx4 v[32:35], v18, s[44:47], s66 offen offset:0
    buffer_load_dwordx4 v[32:35], v18, s[40:43], s66 offen offset:3584
    buffer_load_dwordx4 v[32:35], v18, s[44:47], s66 offen offset:3584
    s_add_u32 s66, s66, 7168
    buffer_load_dwordx4 v[32:35], v18, s[40:43], s66 offen offset:0
    buffer_load_dwordx4 v[32:35], v18, s[44:47], s66 offen offset:0
    buffer_load_dwordx4 v[32:35], v18, s[40:43], s66 offen offset:3584
    buffer_load_dwordx4 v[32:35], v18, s[44:47], s66 offen offset:3584
    s_add_u32 s66, s66, 7168
    buffer_load_dwordx4 v[32:35], v18, s[40:43], s66 offen offset:0
    buffer_load_dwordx4 v[32:35], v18, s[44:47], s66 offen offset:0
    buffer_load_dwordx4 v[32:35], v18, s[40:43], s66 offen offset:3584
    buffer_load_dwordx4 v[32:35], v18, s[44:47], s66 offen offset:3584
    s_add_u32 s66, s66, 7168
    s_barrier
    s_waitcnt vmcnt(30)
    v_perm_b32 v72, v44, v40, s70
    v_perm_b32 v73, v52, v48, s70
    v_perm_b32 v74, v60, v56, s70
    v_perm_b32 v75, v68, v64, s70
    buffer_store_dwordx4 v[72:75], v17, s[36:39], s72 offen
    s_add_u32 s72, s72, 8192
    v_perm_b32 v76, v44, v40, s71
    v_perm_b32 v77, v52, v48, s71
    v_perm_b32 v78, v60, v56, s71
    v_perm_b32 v79, v68, v64, s71
    buffer_store_dwordx4 v[76:79], v17, s[36:39], s72 offen
    s_add_u32 s72, s72, 8192
    v_perm_b32 v80, v45, v41, s70
    v_perm_b32 v81, v53, v49, s70
    v_perm_b32 v82, v61, v57, s70
    v_perm_b32 v83, v69, v65, s70
    buffer_store_dwordx4 v[80:83], v17, s[36:39], s72 offen
    s_add_u32 s72, s72, 8192
    v_perm_b32 v84, v45, v41, s71
    v_perm_b32 v85, v53, v49, s71
    v_perm_b32 v86, v61, v57, s71
    v_perm_b32 v87, v69, v65, s71
    buffer_store_dwordx4 v[84:87], v17, s[36:39], s72 offen
    s_add_u32 s72, s72, 8192
    s_barrier
    v_perm_b32 v88, v46, v42, s70
    v_perm_b32 v89, v54, v50, s70
    v_perm_b32 v90, v62, v58, s70
    v_perm_b32 v91, v70, v66, s70
    buffer_store_dwordx4 v[88:91], v17, s[36:39], s72 offen
    s_add_u32 s72, s72, 8192
    v_perm_b32 v92, v46, v42, s71
    v_perm_b32 v93, v54, v50, s71
    v_perm_b32 v94, v62, v58, s71
    v_perm_b32 v95, v70, v66, s71
    buffer_store_dwordx4 v[92:95], v17, s[36:39], s72 offen
    s_add_u32 s72, s72, 8192
    v_perm_b32 v96, v47, v43, s70
    v_perm_b32 v97, v55, v51, s70
    v_perm_b32 v98, v63, v59, s70
    v_perm_b32 v99, v71, v67, s70
    buffer_store_dwordx4 v[96:99], v17, s[36:39], s72 offen
    s_add_u32 s72, s72, 8192
    v_perm_b32 v100, v47, v43, s71
    v_perm_b32 v101, v55, v51, s71
    v_perm_b32 v102, v63, v59, s71
    v_perm_b32 v103, v71, v67, s71
    buffer_store_dwordx4 v[100:103], v17, s[36:39], s72 offen
    s_add_u32 s72, s72, 8192
    s_branch K0_fin
K0_ln3:
    s_waitcnt lgkmcnt(0)
    s_barrier
    ds_read_b128 v[144:147], v4 offset:0
    ds_read_b128 v[148:151], v4 offset:32
    ds_read_b128 v[152:155], v4 offset:64
    ds_read_b128 v[156:159], v4 offset:96
    ds_read_b128 v[160:163], v4 offset:128
    ds_read_b128 v[164:167], v4 offset:160
    ds_read_b128 v[36:39], v4 offset:192
    ds_read_b64 v[56:57], v5
    ds_read_b64 v[58:59], v5 offset:448
    s_waitcnt lgkmcnt(8)
    v_mfma_f32_32x32x16_bf16 v[128:143], v[144:147], v[96:99], 0
    s_waitcnt lgkmcnt(7)
    v_mfma_f32_32x32x16_bf16 v[128:143], v[148:151], v[100:103], v[128:143]
    s_waitcnt lgkmcnt(6)
    v_mfma_f32_32x32x16_bf16 v[128:143], v[152:155], v[104:107], v[128:143]
    s_waitcnt lgkmcnt(5)
    v_mfma_f32_32x32x16_bf16 v[128:143], v[156:159], v[108:111], v[128:143]
    s_waitcnt lgkmcnt(4)
    v_mfma_f32_32x32x16_bf16 v[128:143], v[160:163], v[112:115], v[128:143]
    s_waitcnt lgkmcnt(3)
    v_mfma_f32_32x32x16_bf16 v[128:143], v[164:167], v[116:119], v[128:143]
    s_waitcnt lgkmcnt(2)
    v_mfma_f32_32x32x16_bf16 v[128:143], v[36:39], v[120:123], v[128:143]
    s_waitcnt lgkmcnt(0)
    v_perm_b32 v60, v58, v56, s70
    v_perm_b32 v61, v58, v56, s71
    v_perm_b32 v62, v59, v57, s70
    v_perm_b32 v63, v59, v57, s71
    s_cmp_eq_u32 s52, 7
    s_cbranch_scc1 K0_nx
    buffer_store_dwordx4 v[60:63], v16, s[36:39], s69 offen
K0_nx:
    s_nop 7
    s_nop 7
    ds_write_b128 v17, v[128:131] offset:0
    ds_write_b128 v17, v[132:135] offset:1088
    ds_write_b128 v17, v[136:139] offset:2176
    ds_write_b128 v17, v[140:143] offset:3264
    s_waitcnt lgkmcnt(0)
    s_barrier
    ds_read_b128 v[96:99], v32 offset:0
    ds_read_b128 v[100:103], v32 offset:512
    ds_read_b128 v[104:107], v32 offset:17408
    ds_read_b128 v[108:111], v32 offset:17920
    ds_read_b128 v[112:115], v32 offset:8704
    ds_read_b128 v[116:119], v32 offset:9216
    ds_read_b128 v[120:123], v32 offset:26112
    ds_read_b128 v[124:127], v32 offset:26624
    s_waitcnt lgkmcnt(4)
    v_add_f32 v96, v96, v104
    v_add_f32 v97, v97, v105
    v_add_f32 v98, v98, v106
    v_add_f32 v99, v99, v107
    v_add_f32 v100, v100, v108
    v_add_f32 v101, v101, v109
    v_add_f32 v102, v102, v110
    v_add_f32 v103, v103, v111
    v_mul_f32 v96, v33, v96
    v_mul_f32 v97, v33, v97
    v_mul_f32 v98, v33, v98
    v_mul_f32 v99, v33, v99
    v_mul_f32 v100, v33, v100
    v_mul_f32 v101, v33, v101
    v_mul_f32 v102, v33, v102
    v_mul_f32 v103, v33, v103
    s_waitcnt lgkmcnt(0)
    v_add_f32 v112, v112, v120
    v_add_f32 v113, v113, v121
    v_add_f32 v114, v114, v122
    v_add_f32 v115, v115, v123
    v_add_f32 v116, v116, v124
    v_add_f32 v117, v117, v125
    v_add_f32 v118, v118, v126
    v_add_f32 v119, v119, v127
    v_fma_f32 v96, v34, v112, v96
    v_fma_f32 v97, v34, v113, v97
    v_fma_f32 v98, v34, v114, v98
    v_fma_f32 v99, v34, v115, v99
    v_fma_f32 v100, v34, v116, v100
    v_fma_f32 v101, v34, v117, v101
    v_fma_f32 v102, v34, v118, v102
    v_fma_f32 v103, v34, v119, v103
    v_cvt_pk_bf16_f32 v104, v96, v97
    v_cvt_pk_bf16_f32 v105, v98, v99
    v_cvt_pk_bf16_f32 v106, v100, v101
    v_cvt_pk_bf16_f32 v107, v102, v103
    s_mov_b64 exec, s[78:79]
    buffer_store_dwordx4 v[104:107], v19, s[36:39], s72 offen
    s_mov_b64 exec, -1
K0_fin:
K0_end:
    s_endpgm
.globl k1_kernel
.p2align 8
.type k1_kernel,@function
k1_kernel:
    s_cmp_ge_u32 s2, 256
    s_cbranch_scc1 K1_end
    s_load_dwordx4 s[12:15], s[0:1], 32
    s_load_dwordx2 s[22:23], s[0:1], 72
    s_load_dwordx2 s[40:41], s[0:1], 48
    s_getpc_b64 s[58:59]
    s_add_u32 s58, s58, ctab@rel32@lo+4
    s_addc_u32 s59, s59, ctab@rel32@hi+12
    v_lshrrev_b32 v1, 6, v0
    s_nop 0
    v_readfirstlane_b32 s52, v1
    v_and_b32 v1, 63, v0
    s_cmp_ge_u32 s2, 32
    s_cbranch_scc1 K1_gemm
    s_cmp_ge_u32 s2, 29
    s_cbranch_scc1 K1_end
    s_waitcnt lgkmcnt(0)
    s_lshl_b32 s21, s2, 3
    s_add_u32 s21, s21, s52
    s_cmp_lt_u32 s21, 225
    s_cselect_b32 s26, -1, 0
    s_min_u32 s21, s21, 224
    s_mov_b32 s8, s22
    s_and_b32 s9, s23, 0xffff
    s_mov_b32 s10, 268435456
    s_mov_b32 s11, 0x00020000
    s_mov_b32 s12, s58
    s_and_b32 s13, s59, 0xffff
    s_mov_b32 s14, 53248
    s_mov_b32 s15, 0x00020000
    v_lshrrev_b32 v3, 5, v1
    v_lshlrev_b32 v4, 4, v1
    s_lshl_b32 s27, s21, 13
    s_add_u32 s27, s27, 13113344
    s_add_u32 s28, s27, 4096
    buffer_load_dwordx4 v[16:19], v4, s[8:11], s27 offen offset:0
    buffer_load_dwordx4 v[20:23], v4, s[8:11], s27 offen offset:1024
    buffer_load_dwordx4 v[32:35], v4, s[8:11], s28 offen offset:0
    buffer_load_dwordx4 v[36:39], v4, s[8:11], s28 offen offset:1024
    s_lshl_b32 s29, s52, 11
    s_mov_b32 m0, s29
    buffer_load_dwordx4 v4, s[12:15], s29 offen offset:0 lds
    buffer_load_dwordx4 v4, s[12:15], s29 offen offset:1024 lds
    s_sleep 6
    buffer_load_dwordx4 v[24:27], v4, s[8:11], s27 offen offset:2048
    buffer_load_dwordx4 v[28:31], v4, s[8:11], s27 offen offset:3072
    buffer_load_dwordx4 v[40:43], v4, s[8:11], s28 offen offset:2048
    buffer_load_dwordx4 v[44:47], v4, s[8:11], s28 offen offset:3072
    s_mov_b32 s31, 0x80008000
    s_lshl_b32 s27, s21, 13
    s_add_u32 s27, s27, 11261952
    s_add_u32 s28, s27, 4096
    s_mul_i32 s29, s52, 5120
    s_add_u32 s29, s29, 16384
    s_mov_b32 m0, s29
    s_waitcnt vmcnt(4)
    s_barrier
    ds_read_b128 v[128:131], v4 offset:0
    ds_read_b128 v[132:135], v4 offset:1024
    ds_read_b128 v[136:139], v4 offset:2048
    ds_read_b128 v[140:143], v4 offset:3072
    buffer_load_dwordx4 v4, s[12:15], s29 offen offset:0 lds
    buffer_load_dwordx4 v4, s[12:15], s29 offen offset:1024 lds
    buffer_load_dwordx4 v4, s[12:15], s29 offen offset:2048 lds
    buffer_load_dwordx4 v4, s[12:15], s29 offen offset:3072 lds
    s_add_u32 s29, s29, 4096
    s_mov_b32 m0, s29
    buffer_load_dwordx4 v4, s[12:15], s29 offen lds
    v_xor_b32 v48, s31, v16
    v_xor_b32 v49, s31, v17
    v_xor_b32 v50, s31, v18
    v_xor_b32 v51, s31, v19
    v_xor_b32 v52, s31, v20
    v_xor_b32 v53, s31, v21
    v_xor_b32 v54, s31, v22
    v_xor_b32 v55, s31, v23
    s_waitcnt lgkmcnt(0)
    s_lshl_b32 s29, s52, 13
    s_add_u32 s29, s29, 57344
    v_add_u32 v6, s29, v4
    v_mfma_f32_32x32x16_bf16 v[64:79], v[16:19], v[128:131], 0
    ds_read_b128 v[208:211], v4 offset:4096
    v_mfma_f32_32x32x16_bf16 v[96:111], v[32:35], v[128:131], 0
    ds_read_b128 v[212:215], v4 offset:5120
    v_mfma_f32_32x32x16_bf16 v[64:79], v[32:35], v[136:139], v[64:79]
    ds_read_b128 v[216:219], v4 offset:6144
    v_mfma_f32_32x32x16_bf16 v[96:111], v[48:51], v[136:139], v[96:111]
    ds_read_b128 v[220:223], v4 offset:7168
    v_mfma_f32_32x32x16_bf16 v[64:79], v[20:23], v[132:135], v[64:79]
    ds_read_b128 v[224:227], v4 offset:8192
    v_mfma_f32_32x32x16_bf16 v[96:111], v[36:39], v[132:135], v[96:111]
    ds_read_b128 v[228:231], v4 offset:9216
    v_mfma_f32_32x32x16_bf16 v[64:79], v[36:39], v[140:143], v[64:79]
    ds_read_b128 v[232:235], v4 offset:10240
    v_mfma_f32_32x32x16_bf16 v[96:111], v[52:55], v[140:143], v[96:111]
    ds_read_b128 v[236:239], v4 offset:11264
    s_waitcnt vmcnt(5)
    v_xor_b32 v56, s31, v24
    v_xor_b32 v57, s31, v25
    v_xor_b32 v58, s31, v26
    v_xor_b32 v59, s31, v27
    v_xor_b32 v60, s31, v28
    v_xor_b32 v61, s31, v29
    v_xor_b32 v62, s31, v30
    v_xor_b32 v63, s31, v31
    s_nop 1
    v_mfma_f32_32x32x16_bf16 v[80:95], v[24:27], v[128:131], 0
    v_mfma_f32_32x32x16_bf16 v[112:127], v[40:43], v[128:131], 0
    s_waitcnt lgkmcnt(7)
    v_mul_f32 v248, v96, v208
    v_mul_f32 v250, v64, v208
    v_mul_f32 v249, v97, v209
    v_mul_f32 v251, v65, v209
    v_fma_f32 v248, -v64, v210, v248
    v_fmac_f32 v250, v96, v210
    v_fma_f32 v249, -v65, v211, v249
    v_fmac_f32 v251, v97, v211
    v_cvt_pk_bf16_f32 v32, v248, v249
    v_cvt_pk_bf16_f32 v16, v250, v251
    v_cvt_pk_bf16_f32 v48, -v250, -v251
    s_mov_b32 m0, s29
    s_add_u32 s29, s29, 4096
    buffer_load_dwordx4 v4, s[8:11], s27 offen offset:0 lds
    s_waitcnt lgkmcnt(6)
    v_mul_f32 v252, v98, v212
    v_mul_f32 v254, v66, v212
    v_mul_f32 v253, v99, v213
    v_mul_f32 v255, v67, v213
    v_fma_f32 v252, -v66, v214, v252
    v_fmac_f32 v254, v98, v214
    v_fma_f32 v253, -v67, v215, v253
    v_fmac_f32 v255, v99, v215
    v_cvt_pk_bf16_f32 v33, v252, v253
    v_cvt_pk_bf16_f32 v17, v254, v255
    v_cvt_pk_bf16_f32 v49, -v254, -v255
    buffer_load_dwordx4 v4, s[8:11], s27 offen offset:1024 lds
    v_mfma_f32_32x32x16_bf16 v[80:95], v[40:43], v[136:139], v[80:95]
    s_waitcnt lgkmcnt(5)
    v_mul_f32 v248, v100, v216
    v_mul_f32 v250, v68, v216
    v_mul_f32 v249, v101, v217
    v_mul_f32 v251, v69, v217
    v_fma_f32 v248, -v68, v218, v248
    v_fmac_f32 v250, v100, v218
    v_fma_f32 v249, -v69, v219, v249
    v_fmac_f32 v251, v101, v219
    v_cvt_pk_bf16_f32 v34, v248, v249
    v_cvt_pk_bf16_f32 v18, v250, v251
    v_cvt_pk_bf16_f32 v50, -v250, -v251
    buffer_load_dwordx4 v4, s[8:11], s27 offen offset:2048 lds
    v_mfma_f32_32x32x16_bf16 v[112:127], v[56:59], v[136:139], v[112:127]
    s_waitcnt lgkmcnt(4)
    v_mul_f32 v252, v102, v220
    v_mul_f32 v254, v70, v220
    v_mul_f32 v253, v103, v221
    v_mul_f32 v255, v71, v221
    v_fma_f32 v252, -v70, v222, v252
    v_fmac_f32 v254, v102, v222
    v_fma_f32 v253, -v71, v223, v253
    v_fmac_f32 v255, v103, v223
    v_cvt_pk_bf16_f32 v35, v252, v253
    v_cvt_pk_bf16_f32 v19, v254, v255
    v_cvt_pk_bf16_f32 v51, -v254, -v255
    buffer_load_dwordx4 v4, s[8:11], s27 offen offset:3072 lds
    v_mfma_f32_32x32x16_bf16 v[80:95], v[28:31], v[132:135], v[80:95]
    s_waitcnt lgkmcnt(3)
    v_mul_f32 v248, v104, v224
    v_mul_f32 v250, v72, v224
    v_mul_f32 v249, v105, v225
    v_mul_f32 v251, v73, v225
    v_fma_f32 v248, -v72, v226, v248
    v_fmac_f32 v250, v104, v226
    v_fma_f32 v249, -v73, v227, v249
    v_fmac_f32 v251, v105, v227
    v_cvt_pk_bf16_f32 v36, v248, v249
    v_cvt_pk_bf16_f32 v20, v250, v251
    v_cvt_pk_bf16_f32 v52, -v250, -v251
    s_mov_b32 m0, s29
    s_add_u32 s29, s29, 4096
    buffer_load_dwordx4 v4, s[8:11], s28 offen offset:0 lds
    v_mfma_f32_32x32x16_bf16 v[112:127], v[44:47], v[132:135], v[112:127]
    s_waitcnt lgkmcnt(2)
    v_mul_f32 v252, v106, v228
    v_mul_f32 v254, v74, v228
    v_mul_f32 v253, v107, v229
    v_mul_f32 v255, v75, v229
    v_fma_f32 v252, -v74, v230, v252
    v_fmac_f32 v254, v106, v230
    v_fma_f32 v253, -v75, v231, v253
    v_fmac_f32 v255, v107, v231
    v_cvt_pk_bf16_f32 v37, v252, v253
    v_cvt_pk_bf16_f32 v21, v254, v255
    v_cvt_pk_bf16_f32 v53, -v254, -v255
    buffer_load_dwordx4 v4, s[8:11], s28 offen offset:1024 lds
    v_mfma_f32_32x32x16_bf16 v[80:95], v[44:47], v[140:143], v[80:95]
    s_waitcnt lgkmcnt(1)
    v_mul_f32 v248, v108, v232
    v_mul_f32 v250, v76, v232
    v_mul_f32 v249, v109, v233
    v_mul_f32 v251, v77, v233
    v_fma_f32 v248, -v76, v234, v248
    v_fmac_f32 v250, v108, v234
    v_fma_f32 v249, -v77, v235, v249
    v_fmac_f32 v251, v109, v235
    v_cvt_pk_bf16_f32 v38, v248, v249
    v_cvt_pk_bf16_f32 v22, v250, v251
    v_cvt_pk_bf16_f32 v54, -v250, -v251
    buffer_load_dwordx4 v4, s[8:11], s28 offen offset:2048 lds
    v_mfma_f32_32x32x16_bf16 v[112:127], v[60:63], v[140:143], v[112:127]
    s_waitcnt lgkmcnt(0)
    v_mul_f32 v252, v110, v236
    v_mul_f32 v254, v78, v236
    v_mul_f32 v253, v111, v237
    v_mul_f32 v255, v79, v237
    v_fma_f32 v252, -v78, v238, v252
    v_fmac_f32 v254, v110, v238
    v_fma_f32 v253, -v79, v239, v253
    v_fmac_f32 v255, v111, v239
    v_cvt_pk_bf16_f32 v39, v252, v253
    v_cvt_pk_bf16_f32 v23, v254, v255
    v_cvt_pk_bf16_f32 v55, -v254, -v255
    buffer_load_dwordx4 v4, s[8:11], s28 offen offset:3072 lds
    s_nop 1
F_skipA:
    s_waitcnt vmcnt(8)
    s_barrier
    ds_read_b128 v[144:147], v4 offset:12288
    ds_read_b128 v[148:151], v4 offset:13312
    ds_read_b128 v[176:179], v4 offset:20480
    ds_read_b128 v[180:183], v4 offset:21504
    ds_read_b128 v[208:211], v4 offset:28672
    ds_read_b128 v[212:215], v4 offset:29696
    ds_read_b128 v[216:219], v4 offset:30720
    ds_read_b128 v[220:223], v4 offset:31744
    ds_read_b128 v[224:227], v4 offset:32768
    ds_read_b128 v[228:231], v4 offset:33792
    ds_read_b128 v[232:235], v4 offset:34816
    ds_read_b128 v[236:239], v4 offset:35840
    ds_read_b128 v[152:155], v4 offset:14336
    ds_read_b128 v[156:159], v4 offset:15360
    ds_read_b128 v[160:163], v4 offset:16384
    ds_read_b128 v[164:167], v4 offset:17408
    ds_read_b128 v[168:171], v4 offset:18432
    ds_read_b128 v[172:175], v4 offset:19456
    ds_read_b128 v[184:187], v4 offset:22528
    ds_read_b128 v[188:191], v4 offset:23552
    ds_read_b128 v[192:195], v4 offset:24576
    ds_read_b128 v[196:199], v4 offset:25600
    ds_read_b128 v[200:203], v4 offset:26624
    ds_read_b128 v[204:207], v4 offset:27648
    s_waitcnt lgkmcnt(15)
    v_mfma_f32_32x32x16_bf16 v[64:79], v[144:147], v[16:19], 0
    v_mfma_f32_32x32x16_bf16 v[96:111], v[144:147], v[32:35], 0
    s_waitcnt lgkmcnt(15)
    v_mul_f32 v248, v112, v208
    v_mul_f32 v250, v80, v208
    v_mul_f32 v249, v113, v209
    v_mul_f32 v251, v81, v209
    v_fma_f32 v248, -v80, v210, v248
    v_fmac_f32 v250, v112, v210
    v_fma_f32 v249, -v81, v211, v249
    v_fmac_f32 v251, v113, v211
    v_cvt_pk_bf16_f32 v40, v248, v249
    v_cvt_pk_bf16_f32 v24, v250, v251
    v_cvt_pk_bf16_f32 v56, -v250, -v251
    s_waitcnt lgkmcnt(15)
    v_mul_f32 v252, v114, v212
    v_mul_f32 v254, v82, v212
    v_mul_f32 v253, v115, v213
    v_mul_f32 v255, v83, v213
    v_fma_f32 v252, -v82, v214, v252
    v_fmac_f32 v254, v114, v214
    v_fma_f32 v253, -v83, v215, v253
    v_fmac_f32 v255, v115, v215
    v_cvt_pk_bf16_f32 v41, v252, v253
    v_cvt_pk_bf16_f32 v25, v254, v255
    v_cvt_pk_bf16_f32 v57, -v254, -v255
    v_mfma_f32_32x32x16_bf16 v[64:79], v[176:179], v[32:35], v[64:79]
    s_waitcnt lgkmcnt(15)
    v_mul_f32 v248, v116, v216
    v_mul_f32 v250, v84, v216
    v_mul_f32 v249, v117, v217
    v_mul_f32 v251, v85, v217
    v_fma_f32 v248, -v84, v218, v248
    v_fmac_f32 v250, v116, v218
    v_fma_f32 v249, -v85, v219, v249
    v_fmac_f32 v251, v117, v219
    v_cvt_pk_bf16_f32 v42, v248, v249
    v_cvt_pk_bf16_f32 v26, v250, v251
    v_cvt_pk_bf16_f32 v58, -v250, -v251
    v_mfma_f32_32x32x16_bf16 v[96:111], v[176:179], v[48:51], v[96:111]
    s_waitcnt lgkmcnt(15)
    v_mul_f32 v252, v118, v220
    v_mul_f32 v254, v86, v220
    v_mul_f32 v253, v119, v221
    v_mul_f32 v255, v87, v221
    v_fma_f32 v252, -v86, v222, v252
    v_fmac_f32 v254, v118, v222
    v_fma_f32 v253, -v87, v223, v253
    v_fmac_f32 v255, v119, v223
    v_cvt_pk_bf16_f32 v43, v252, v253
    v_cvt_pk_bf16_f32 v27, v254, v255
    v_cvt_pk_bf16_f32 v59, -v254, -v255
    v_mfma_f32_32x32x16_bf16 v[64:79], v[148:151], v[20:23], v[64:79]
    s_waitcnt lgkmcnt(15)
    v_mul_f32 v248, v120, v224
    v_mul_f32 v250, v88, v224
    v_mul_f32 v249, v121, v225
    v_mul_f32 v251, v89, v225
    v_fma_f32 v248, -v88, v226, v248
    v_fmac_f32 v250, v120, v226
    v_fma_f32 v249, -v89, v227, v249
    v_fmac_f32 v251, v121, v227
    v_cvt_pk_bf16_f32 v44, v248, v249
    v_cvt_pk_bf16_f32 v28, v250, v251
    v_cvt_pk_bf16_f32 v60, -v250, -v251
    v_mfma_f32_32x32x16_bf16 v[96:111], v[148:151], v[36:39], v[96:111]
    s_waitcnt lgkmcnt(14)
    v_mul_f32 v252, v122, v228
    v_mul_f32 v254, v90, v228
    v_mul_f32 v253, v123, v229
    v_mul_f32 v255, v91, v229
    v_fma_f32 v252, -v90, v230, v252
    v_fmac_f32 v254, v122, v230
    v_fma_f32 v253, -v91, v231, v253
    v_fmac_f32 v255, v123, v231
    v_cvt_pk_bf16_f32 v45, v252, v253
    v_cvt_pk_bf16_f32 v29, v254, v255
    v_cvt_pk_bf16_f32 v61, -v254, -v255
    v_mfma_f32_32x32x16_bf16 v[64:79], v[180:183], v[36:39], v[64:79]
    s_waitcnt lgkmcnt(13)
    v_mul_f32 v248, v124, v232
    v_mul_f32 v250, v92, v232
    v_mul_f32 v249, v125, v233
    v_mul_f32 v251, v93, v233
    v_fma_f32 v248, -v92, v234, v248
    v_fmac_f32 v250, v124, v234
    v_fma_f32 v249, -v93, v235, v249
    v_fmac_f32 v251, v125, v235
    v_cvt_pk_bf16_f32 v46, v248, v249
    v_cvt_pk_bf16_f32 v30, v250, v251
    v_cvt_pk_bf16_f32 v62, -v250, -v251
    v_mfma_f32_32x32x16_bf16 v[96:111], v[180:183], v[52:55], v[96:111]
    s_waitcnt lgkmcnt(12)
    v_mul_f32 v252, v126, v236
    v_mul_f32 v254, v94, v236
    v_mul_f32 v253, v127, v237
    v_mul_f32 v255, v95, v237
    v_fma_f32 v252, -v94, v238, v252
    v_fmac_f32 v254, v126, v238
    v_fma_f32 v253, -v95, v239, v253
    v_fmac_f32 v255, v127, v239
    v_cvt_pk_bf16_f32 v47, v252, v253
    v_cvt_pk_bf16_f32 v31, v254, v255
    v_cvt_pk_bf16_f32 v63, -v254, -v255
    s_nop 1
    s_waitcnt lgkmcnt(0)
    v_mfma_f32_32x32x16_bf16 v[64:79], v[152:155], v[24:27], v[64:79]
    v_mfma_f32_32x32x16_bf16 v[96:111], v[152:155], v[40:43], v[96:111]
    v_mfma_f32_32x32x16_bf16 v[64:79], v[184:187], v[40:43], v[64:79]
    v_mfma_f32_32x32x16_bf16 v[96:111], v[184:187], v[56:59], v[96:111]
    v_mfma_f32_32x32x16_bf16 v[64:79], v[156:159], v[28:31], v[64:79]
    v_mfma_f32_32x32x16_bf16 v[96:111], v[156:159], v[44:47], v[96:111]
    v_mfma_f32_32x32x16_bf16 v[64:79], v[188:191], v[44:47], v[64:79]
    v_mfma_f32_32x32x16_bf16 v[96:111], v[188:191], v[60:63], v[96:111]
    v_mfma_f32_32x32x16_bf16 v[80:95], v[160:163], v[16:19], 0
    v_mfma_f32_32x32x16_bf16 v[112:127], v[160:163], v[32:35], 0
    v_mfma_f32_32x32x16_bf16 v[80:95], v[192:195], v[32:35], v[80:95]
    v_mfma_f32_32x32x16_bf16 v[112:127], v[192:195], v[48:51], v[112:127]
    s_waitcnt vmcnt(0)
    ds_read_b128 v[208:211], v6 offset:0
    ds_read_b128 v[212:215], v6 offset:1024
    ds_read_b128 v[216:219], v6 offset:2048
    ds_read_b128 v[220:223], v6 offset:3072
    ds_read_b128 v[224:227], v6 offset:4096
    ds_read_b128 v[228:231], v6 offset:5120
    ds_read_b128 v[232:235], v6 offset:6144
    ds_read_b128 v[236:239], v6 offset:7168
    v_mfma_f32_32x32x16_bf16 v[80:95], v[164:167], v[20:23], v[80:95]
    v_mfma_f32_32x32x16_bf16 v[112:127], v[164:167], v[36:39], v[112:127]
    v_mfma_f32_32x32x16_bf16 v[80:95], v[196:199], v[36:39], v[80:95]
    v_mfma_f32_32x32x16_bf16 v[112:127], v[196:199], v[52:55], v[112:127]
    v_mfma_f32_32x32x16_bf16 v[80:95], v[168:171], v[24:27], v[80:95]
    v_mfma_f32_32x32x16_bf16 v[112:127], v[168:171], v[40:43], v[112:127]
    s_waitcnt lgkmcnt(7)
    v_lshlrev_b32 v240, 16, v208
    v_and_b32 v241, 0xffff0000, v208
    v_lshlrev_b32 v242, 16, v210
    v_and_b32 v243, 0xffff0000, v210
    v_mul_f32 v248, v96, v240
    v_mul_f32 v250, v64, v240
    v_mul_f32 v249, v97, v241
    v_mul_f32 v251, v65, v241
    v_fmac_f32 v248, v64, v242
    v_fma_f32 v250, -v96, v242, v250
    v_fmac_f32 v249, v65, v243
    v_fma_f32 v251, -v97, v243, v251
    v_cvt_pk_bf16_f32 v32, v248, v249
    v_cvt_pk_bf16_f32 v16, v250, v251
    v_cvt_pk_bf16_f32 v48, -v248, -v249
    s_waitcnt lgkmcnt(7)
    v_lshlrev_b32 v244, 16, v209
    v_and_b32 v245, 0xffff0000, v209
    v_lshlrev_b32 v246, 16, v211
    v_and_b32 v247, 0xffff0000, v211
    ds_read_b128 v[208:211], v4 offset:36864
    v_mul_f32 v252, v98, v244
    v_mul_f32 v254, v66, v244
    v_mul_f32 v253, v99, v245
    v_mul_f32 v255, v67, v245
    v_fmac_f32 v252, v66, v246
    v_fma_f32 v254, -v98, v246, v254
    v_fmac_f32 v253, v67, v247
    v_fma_f32 v255, -v99, v247, v255
    v_cvt_pk_bf16_f32 v33, v252, v253
    v_cvt_pk_bf16_f32 v17, v254, v255
    v_cvt_pk_bf16_f32 v49, -v252, -v253
    v_mfma_f32_32x32x16_bf16 v[80:95], v[200:203], v[40:43], v[80:95]
    s_waitcnt lgkmcnt(7)
    v_lshlrev_b32 v240, 16, v212
    v_and_b32 v241, 0xffff0000, v212
    v_lshlrev_b32 v242, 16, v214
    v_and_b32 v243, 0xffff0000, v214
    v_mul_f32 v248, v100, v240
    v_mul_f32 v250, v68, v240
    v_mul_f32 v249, v101, v241
    v_mul_f32 v251, v69, v241
    v_fmac_f32 v248, v68, v242
    v_fma_f32 v250, -v100, v242, v250
    v_fmac_f32 v249, v69, v243
    v_fma_f32 v251, -v101, v243, v251
    v_cvt_pk_bf16_f32 v34, v248, v249
    v_cvt_pk_bf16_f32 v18, v250, v251
    v_cvt_pk_bf16_f32 v50, -v248, -v249
    v_mfma_f32_32x32x16_bf16 v[112:127], v[200:203], v[56:59], v[112:127]
    s_waitcnt lgkmcnt(7)
    v_lshlrev_b32 v244, 16, v213
    v_and_b32 v245, 0xffff0000, v213
    v_lshlrev_b32 v246, 16, v215
    v_and_b32 v247, 0xffff0000, v215
    ds_read_b128 v[212:215], v4 offset:37888
    v_mul_f32 v252, v102, v244
    v_mul_f32 v254, v70, v244
    v_mul_f32 v253, v103, v245
    v_mul_f32 v255, v71, v245
    v_fmac_f32 v252, v70, v246
    v_fma_f32 v254, -v102, v246, v254
    v_fmac_f32 v253, v71, v247
    v_fma_f32 v255, -v103, v247, v255
    v_cvt_pk_bf16_f32 v35, v252, v253
    v_cvt_pk_bf16_f32 v19, v254, v255
    v_cvt_pk_bf16_f32 v51, -v252, -v253
    v_mfma_f32_32x32x16_bf16 v[80:95], v[172:175], v[28:31], v[80:95]
    s_waitcnt lgkmcnt(7)
    v_lshlrev_b32 v240, 16, v216
    v_and_b32 v241, 0xffff0000, v216
    v_lshlrev_b32 v242, 16, v218
    v_and_b32 v243, 0xffff0000, v218
    v_mul_f32 v248, v104, v240
    v_mul_f32 v250, v72, v240
    v_mul_f32 v249, v105, v241
    v_mul_f32 v251, v73, v241
    v_fmac_f32 v248, v72, v242
    v_fma_f32 v250, -v104, v242, v250
    v_fmac_f32 v249, v73, v243
    v_fma_f32 v251, -v105, v243, v251
    v_cvt_pk_bf16_f32 v36, v248, v249
    v_cvt_pk_bf16_f32 v20, v250, v251
    v_cvt_pk_bf16_f32 v52, -v248, -v249
    v_mfma_f32_32x32x16_bf16 v[112:127], v[172:175], v[44:47], v[112:127]
    s_waitcnt lgkmcnt(7)
    v_lshlrev_b32 v244, 16, v217
    v_and_b32 v245, 0xffff0000, v217
    v_lshlrev_b32 v246, 16, v219
    v_and_b32 v247, 0xffff0000, v219
    ds_read_b128 v[216:219], v4 offset:38912
    v_mul_f32 v252, v106, v244
    v_mul_f32 v254, v74, v244
    v_mul_f32 v253, v107, v245
    v_mul_f32 v255, v75, v245
    v_fmac_f32 v252, v74, v246
    v_fma_f32 v254, -v106, v246, v254
    v_fmac_f32 v253, v75, v247
    v_fma_f32 v255, -v107, v247, v255
    v_cvt_pk_bf16_f32 v37, v252, v253
    v_cvt_pk_bf16_f32 v21, v254, v255
    v_cvt_pk_bf16_f32 v53, -v252, -v253
    v_mfma_f32_32x32x16_bf16 v[80:95], v[204:207], v[44:47], v[80:95]
    s_waitcnt lgkmcnt(7)
    v_lshlrev_b32 v240, 16, v220
    v_and_b32 v241, 0xffff0000, v220
    v_lshlrev_b32 v242, 16, v222
    v_and_b32 v243, 0xffff0000, v222
    v_mul_f32 v248, v108, v240
    v_mul_f32 v250, v76, v240
    v_mul_f32 v249, v109, v241
    v_mul_f32 v251, v77, v241
    v_fmac_f32 v248, v76, v242
    v_fma_f32 v250, -v108, v242, v250
    v_fmac_f32 v249, v77, v243
    v_fma_f32 v251, -v109, v243, v251
    v_cvt_pk_bf16_f32 v38, v248, v249
    v_cvt_pk_bf16_f32 v22, v250, v251
    v_cvt_pk_bf16_f32 v54, -v248, -v249
    v_mfma_f32_32x32x16_bf16 v[112:127], v[204:207], v[60:63], v[112:127]
    s_waitcnt lgkmcnt(7)
    v_lshlrev_b32 v244, 16, v221
    v_and_b32 v245, 0xffff0000, v221
    v_lshlrev_b32 v246, 16, v223
    v_and_b32 v247, 0xffff0000, v223
    ds_read_b128 v[220:223], v4 offset:39936
    v_mul_f32 v252, v110, v244
    v_mul_f32 v254, v78, v244
    v_mul_f32 v253, v111, v245
    v_mul_f32 v255, v79, v245
    v_fmac_f32 v252, v78, v246
    v_fma_f32 v254, -v110, v246, v254
    v_fmac_f32 v253, v79, v247
    v_fma_f32 v255, -v111, v247, v255
    v_cvt_pk_bf16_f32 v39, v252, v253
    v_cvt_pk_bf16_f32 v23, v254, v255
    v_cvt_pk_bf16_f32 v55, -v252, -v253
    s_nop 1
    v_mfma_f32_32x32x16_bf16 v[64:79], v[16:19], v[144:147], 0
    v_mfma_f32_32x32x16_bf16 v[96:111], v[32:35], v[144:147], 0
    s_waitcnt lgkmcnt(7)
    v_lshlrev_b32 v240, 16, v224
    v_and_b32 v241, 0xffff0000, v224
    v_lshlrev_b32 v242, 16, v226
    v_and_b32 v243, 0xffff0000, v226
    v_mul_f32 v248, v112, v240
    v_mul_f32 v250, v80, v240
    v_mul_f32 v249, v113, v241
    v_mul_f32 v251, v81, v241
    v_fmac_f32 v248, v80, v242
    v_fma_f32 v250, -v112, v242, v250
    v_fmac_f32 v249, v81, v243
    v_fma_f32 v251, -v113, v243, v251
    v_cvt_pk_bf16_f32 v40, v248, v249
    v_cvt_pk_bf16_f32 v24, v250, v251
    v_cvt_pk_bf16_f32 v56, -v248, -v249
    s_waitcnt lgkmcnt(7)
    v_lshlrev_b32 v244, 16, v225
    v_and_b32 v245, 0xffff0000, v225
    v_lshlrev_b32 v246, 16, v227
    v_and_b32 v247, 0xffff0000, v227
    ds_read_b128 v[224:227], v4 offset:40960
    v_mul_f32 v252, v114, v244
    v_mul_f32 v254, v82, v244
    v_mul_f32 v253, v115, v245
    v_mul_f32 v255, v83, v245
    v_fmac_f32 v252, v82, v246
    v_fma_f32 v254, -v114, v246, v254
    v_fmac_f32 v253, v83, v247
    v_fma_f32 v255, -v115, v247, v255
    v_cvt_pk_bf16_f32 v41, v252, v253
    v_cvt_pk_bf16_f32 v25, v254, v255
    v_cvt_pk_bf16_f32 v57, -v252, -v253
    v_mfma_f32_32x32x16_bf16 v[64:79], v[48:51], v[176:179], v[64:79]
    s_waitcnt lgkmcnt(7)
    v_lshlrev_b32 v240, 16, v228
    v_and_b32 v241, 0xffff0000, v228
    v_lshlrev_b32 v242, 16, v230
    v_and_b32 v243, 0xffff0000, v230
    v_mul_f32 v248, v116, v240
    v_mul_f32 v250, v84, v240
    v_mul_f32 v249, v117, v241
    v_mul_f32 v251, v85, v241
    v_fmac_f32 v248, v84, v242
    v_fma_f32 v250, -v116, v242, v250
    v_fmac_f32 v249, v85, v243
    v_fma_f32 v251, -v117, v243, v251
    v_cvt_pk_bf16_f32 v42, v248, v249
    v_cvt_pk_bf16_f32 v26, v250, v251
    v_cvt_pk_bf16_f32 v58, -v248, -v249
    v_mfma_f32_32x32x16_bf16 v[96:111], v[16:19], v[176:179], v[96:111]
    s_waitcnt lgkmcnt(7)
    v_lshlrev_b32 v244, 16, v229
    v_and_b32 v245, 0xffff0000, v229
    v_lshlrev_b32 v246, 16, v231
    v_and_b32 v247, 0xffff0000, v231
    ds_read_b128 v[228:231], v4 offset:41984
    v_mul_f32 v252, v118, v244
    v_mul_f32 v254, v86, v244
    v_mul_f32 v253, v119, v245
    v_mul_f32 v255, v87, v245
    v_fmac_f32 v252, v86, v246
    v_fma_f32 v254, -v118, v246, v254
    v_fmac_f32 v253, v87, v247
    v_fma_f32 v255, -v119, v247, v255
    v_cvt_pk_bf16_f32 v43, v252, v253
    v_cvt_pk_bf16_f32 v27, v254, v255
    v_cvt_pk_bf16_f32 v59, -v252, -v253
    v_mfma_f32_32x32x16_bf16 v[64:79], v[20:23], v[148:151], v[64:79]
    s_waitcnt lgkmcnt(7)
    v_lshlrev_b32 v240, 16, v232
    v_and_b32 v241, 0xffff0000, v232
    v_lshlrev_b32 v242, 16, v234
    v_and_b32 v243, 0xffff0000, v234
    v_mul_f32 v248, v120, v240
    v_mul_f32 v250, v88, v240
    v_mul_f32 v249, v121, v241
    v_mul_f32 v251, v89, v241
    v_fmac_f32 v248, v88, v242
    v_fma_f32 v250, -v120, v242, v250
    v_fmac_f32 v249, v89, v243
    v_fma_f32 v251, -v121, v243, v251
    v_cvt_pk_bf16_f32 v44, v248, v249
    v_cvt_pk_bf16_f32 v28, v250, v251
    v_cvt_pk_bf16_f32 v60, -v248, -v249
    v_mfma_f32_32x32x16_bf16 v[96:111], v[36:39], v[148:151], v[96:111]
    s_waitcnt lgkmcnt(7)
    v_lshlrev_b32 v244, 16, v233
    v_and_b32 v245, 0xffff0000, v233
    v_lshlrev_b32 v246, 16, v235
    v_and_b32 v247, 0xffff0000, v235
    ds_read_b128 v[232:235], v4 offset:43008
    v_mul_f32 v252, v122, v244
    v_mul_f32 v254, v90, v244
    v_mul_f32 v253, v123, v245
    v_mul_f32 v255, v91, v245
    v_fmac_f32 v252, v90, v246
    v_fma_f32 v254, -v122, v246, v254
    v_fmac_f32 v253, v91, v247
    v_fma_f32 v255, -v123, v247, v255
    v_cvt_pk_bf16_f32 v45, v252, v253
    v_cvt_pk_bf16_f32 v29, v254, v255
    v_cvt_pk_bf16_f32 v61, -v252, -v253
    v_mfma_f32_32x32x16_bf16 v[64:79], v[52:55], v[180:183], v[64:79]
    s_waitcnt lgkmcnt(7)
    v_lshlrev_b32 v240, 16, v236
    v_and_b32 v241, 0xffff0000, v236
    v_lshlrev_b32 v242, 16, v238
    v_and_b32 v243, 0xffff0000, v238
    v_mul_f32 v248, v124, v240
    v_mul_f32 v250, v92, v240
    v_mul_f32 v249, v125, v241
    v_mul_f32 v251, v93, v241
    v_fmac_f32 v248, v92, v242
    v_fma_f32 v250, -v124, v242, v250
    v_fmac_f32 v249, v93, v243
    v_fma_f32 v251, -v125, v243, v251
    v_cvt_pk_bf16_f32 v46, v248, v249
    v_cvt_pk_bf16_f32 v30, v250, v251
    v_cvt_pk_bf16_f32 v62, -v248, -v249
    v_mfma_f32_32x32x16_bf16 v[96:111], v[20:23], v[180:183], v[96:111]
    s_waitcnt lgkmcnt(7)
    v_lshlrev_b32 v244, 16, v237
    v_and_b32 v245, 0xffff0000, v237
    v_lshlrev_b32 v246, 16, v239
    v_and_b32 v247, 0xffff0000, v239
    ds_read_b128 v[236:239], v4 offset:44032
    v_mul_f32 v252, v126, v244
    v_mul_f32 v254, v94, v244
    v_mul_f32 v253, v127, v245
    v_mul_f32 v255, v95, v245
    v_fmac_f32 v252, v94, v246
    v_fma_f32 v254, -v126, v246, v254
    v_fmac_f32 v253, v95, v247
    v_fma_f32 v255, -v127, v247, v255
    v_cvt_pk_bf16_f32 v47, v252, v253
    v_cvt_pk_bf16_f32 v31, v254, v255
    v_cvt_pk_bf16_f32 v63, -v252, -v253
    s_nop 1
    v_mfma_f32_32x32x16_bf16 v[64:79], v[24:27], v[152:155], v[64:79]
    v_mfma_f32_32x32x16_bf16 v[96:111], v[40:43], v[152:155], v[96:111]
    v_mfma_f32_32x32x16_bf16 v[64:79], v[56:59], v[184:187], v[64:79]
    v_mfma_f32_32x32x16_bf16 v[96:111], v[24:27], v[184:187], v[96:111]
    v_mfma_f32_32x32x16_bf16 v[64:79], v[28:31], v[156:159], v[64:79]
    v_mfma_f32_32x32x16_bf16 v[96:111], v[44:47], v[156:159], v[96:111]
    v_mfma_f32_32x32x16_bf16 v[64:79], v[60:63], v[188:191], v[64:79]
    v_mfma_f32_32x32x16_bf16 v[96:111], v[28:31], v[188:191], v[96:111]
    v_mfma_f32_32x32x16_bf16 v[80:95], v[16:19], v[160:163], 0
    v_mfma_f32_32x32x16_bf16 v[112:127], v[32:35], v[160:163], 0
    v_mfma_f32_32x32x16_bf16 v[80:95], v[48:51], v[192:195], v[80:95]
    v_mfma_f32_32x32x16_bf16 v[112:127], v[16:19], v[192:195], v[112:127]
    v_mfma_f32_32x32x16_bf16 v[80:95], v[20:23], v[164:167], v[80:95]
    v_mfma_f32_32x32x16_bf16 v[112:127], v[36:39], v[164:167], v[112:127]
    v_mfma_f32_32x32x16_bf16 v[80:95], v[52:55], v[196:199], v[80:95]
    v_mfma_f32_32x32x16_bf16 v[112:127], v[20:23], v[196:199], v[112:127]
    v_mfma_f32_32x32x16_bf16 v[80:95], v[24:27], v[168:171], v[80:95]
    v_mfma_f32_32x32x16_bf16 v[112:127], v[40:43], v[168:171], v[112:127]
    s_waitcnt lgkmcnt(7)
    v_mul_f32 v248, v96, v208
    v_mul_f32 v250, v64, v208
    v_mul_f32 v249, v97, v209
    v_mul_f32 v251, v65, v209
    v_fma_f32 v248, -v64, v210, v248
    v_fmac_f32 v250, v96, v210
    v_fma_f32 v249, -v65, v211, v249
    v_fmac_f32 v251, v97, v211
    ds_read_b128 v[208:211], v4 offset:45056
    v_cvt_pk_bf16_f32 v32, v248, v249
    v_cvt_pk_bf16_f32 v16, v250, v251
    v_cvt_pk_bf16_f32 v48, -v248, -v249
    s_waitcnt lgkmcnt(7)
    v_mul_f32 v252, v98, v212
    v_mul_f32 v254, v66, v212
    v_mul_f32 v253, v99, v213
    v_mul_f32 v255, v67, v213
    v_fma_f32 v252, -v66, v214, v252
    v_fmac_f32 v254, v98, v214
    v_fma_f32 v253, -v67, v215, v253
    v_fmac_f32 v255, v99, v215
    ds_read_b128 v[212:215], v4 offset:46080
    v_cvt_pk_bf16_f32 v33, v252, v253
    v_cvt_pk_bf16_f32 v17, v254, v255
    v_cvt_pk_bf16_f32 v49, -v252, -v253
    v_mfma_f32_32x32x16_bf16 v[80:95], v[56:59], v[200:203], v[80:95]
    s_waitcnt lgkmcnt(7)
    v_mul_f32 v248, v100, v216
    v_mul_f32 v250, v68, v216
    v_mul_f32 v249, v101, v217
    v_mul_f32 v251, v69, v217
    v_fma_f32 v248, -v68, v218, v248
    v_fmac_f32 v250, v100, v218
    v_fma_f32 v249, -v69, v219, v249
    v_fmac_f32 v251, v101, v219
    ds_read_b128 v[216:219], v4 offset:47104
    v_cvt_pk_bf16_f32 v34, v248, v249
    v_cvt_pk_bf16_f32 v18, v250, v251
    v_cvt_pk_bf16_f32 v50, -v248, -v249
    v_mfma_f32_32x32x16_bf16 v[112:127], v[24:27], v[200:203], v[112:127]
    s_waitcnt lgkmcnt(7)
    v_mul_f32 v252, v102, v220
    v_mul_f32 v254, v70, v220
    v_mul_f32 v253, v103, v221
    v_mul_f32 v255, v71, v221
    v_fma_f32 v252, -v70, v222, v252
    v_fmac_f32 v254, v102, v222
    v_fma_f32 v253, -v71, v223, v253
    v_fmac_f32 v255, v103, v223
    ds_read_b128 v[220:223], v4 offset:48128
    v_cvt_pk_bf16_f32 v35, v252, v253
    v_cvt_pk_bf16_f32 v19, v254, v255
    v_cvt_pk_bf16_f32 v51, -v252, -v253
    v_mfma_f32_32x32x16_bf16 v[80:95], v[28:31], v[172:175], v[80:95]
    s_waitcnt lgkmcnt(7)
    v_mul_f32 v248, v104, v224
    v_mul_f32 v250, v72, v224
    v_mul_f32 v249, v105, v225
    v_mul_f32 v251, v73, v225
    v_fma_f32 v248, -v72, v226, v248
    v_fmac_f32 v250, v104, v226
    v_fma_f32 v249, -v73, v227, v249
    v_fmac_f32 v251, v105, v227
    ds_read_b128 v[224:227], v4 offset:49152
    v_cvt_pk_bf16_f32 v36, v248, v249
    v_cvt_pk_bf16_f32 v20, v250, v251
    v_cvt_pk_bf16_f32 v52, -v248, -v249
    v_mfma_f32_32x32x16_bf16 v[112:127], v[44:47], v[172:175], v[112:127]
    s_waitcnt lgkmcnt(7)
    v_mul_f32 v252, v106, v228
    v_mul_f32 v254, v74, v228
    v_mul_f32 v253, v107, v229
    v_mul_f32 v255, v75, v229
    v_fma_f32 v252, -v74, v230, v252
    v_fmac_f32 v254, v106, v230
    v_fma_f32 v253, -v75, v231, v253
    v_fmac_f32 v255, v107, v231
    ds_read_b128 v[228:231], v4 offset:50176
    v_cvt_pk_bf16_f32 v37, v252, v253
    v_cvt_pk_bf16_f32 v21, v254, v255
    v_cvt_pk_bf16_f32 v53, -v252, -v253
    v_mfma_f32_32x32x16_bf16 v[80:95], v[60:63], v[204:207], v[80:95]
    s_waitcnt lgkmcnt(7)
    v_mul_f32 v248, v108, v232
    v_mul_f32 v250, v76, v232
    v_mul_f32 v249, v109, v233
    v_mul_f32 v251, v77, v233
    v_fma_f32 v248, -v76, v234, v248
    v_fmac_f32 v250, v108, v234
    v_fma_f32 v249, -v77, v235, v249
    v_fmac_f32 v251, v109, v235
    ds_read_b128 v[232:235], v4 offset:51200
    v_cvt_pk_bf16_f32 v38, v248, v249
    v_cvt_pk_bf16_f32 v22, v250, v251
    v_cvt_pk_bf16_f32 v54, -v248, -v249
    v_mfma_f32_32x32x16_bf16 v[112:127], v[28:31], v[204:207], v[112:127]
    s_waitcnt lgkmcnt(7)
    v_mul_f32 v252, v110, v236
    v_mul_f32 v254, v78, v236
    v_mul_f32 v253, v111, v237
    v_mul_f32 v255, v79, v237
    v_fma_f32 v252, -v78, v238, v252
    v_fmac_f32 v254, v110, v238
    v_fma_f32 v253, -v79, v239, v253
    v_fmac_f32 v255, v111, v239
    ds_read_b128 v[236:239], v4 offset:52224
    v_cvt_pk_bf16_f32 v39, v252, v253
    v_cvt_pk_bf16_f32 v23, v254, v255
    v_cvt_pk_bf16_f32 v55, -v252, -v253
    s_nop 1
    v_mfma_f32_32x32x16_bf16 v[64:79], v[16:19], v[128:131], 0
    v_mfma_f32_32x32x16_bf16 v[96:111], v[32:35], v[128:131], 0
    s_waitcnt lgkmcnt(7)
    v_mul_f32 v248, v112, v208
    v_mul_f32 v250, v80, v208
    v_mul_f32 v249, v113, v209
    v_mul_f32 v251, v81, v209
    v_fma_f32 v248, -v80, v210, v248
    v_fmac_f32 v250, v112, v210
    v_fma_f32 v249, -v81, v211, v249
    v_fmac_f32 v251, v113, v211
    v_cvt_pk_bf16_f32 v40, v248, v249
    v_cvt_pk_bf16_f32 v24, v250, v251
    v_cvt_pk_bf16_f32 v56, -v248, -v249
    s_waitcnt lgkmcnt(6)
    v_mul_f32 v252, v114, v212
    v_mul_f32 v254, v82, v212
    v_mul_f32 v253, v115, v213
    v_mul_f32 v255, v83, v213
    v_fma_f32 v252, -v82, v214, v252
    v_fmac_f32 v254, v114, v214
    v_fma_f32 v253, -v83, v215, v253
    v_fmac_f32 v255, v115, v215
    v_cvt_pk_bf16_f32 v41, v252, v253
    v_cvt_pk_bf16_f32 v25, v254, v255
    v_cvt_pk_bf16_f32 v57, -v252, -v253
    v_mfma_f32_32x32x16_bf16 v[64:79], v[48:51], v[136:139], v[64:79]
    s_waitcnt lgkmcnt(5)
    v_mul_f32 v248, v116, v216
    v_mul_f32 v250, v84, v216
    v_mul_f32 v249, v117, v217
    v_mul_f32 v251, v85, v217
    v_fma_f32 v248, -v84, v218, v248
    v_fmac_f32 v250, v116, v218
    v_fma_f32 v249, -v85, v219, v249
    v_fmac_f32 v251, v117, v219
    v_cvt_pk_bf16_f32 v42, v248, v249
    v_cvt_pk_bf16_f32 v26, v250, v251
    v_cvt_pk_bf16_f32 v58, -v248, -v249
    v_mfma_f32_32x32x16_bf16 v[96:111], v[16:19], v[136:139], v[96:111]
    s_waitcnt lgkmcnt(4)
    v_mul_f32 v252, v118, v220
    v_mul_f32 v254, v86, v220
    v_mul_f32 v253, v119, v221
    v_mul_f32 v255, v87, v221
    v_fma_f32 v252, -v86, v222, v252
    v_fmac_f32 v254, v118, v222
    v_fma_f32 v253, -v87, v223, v253
    v_fmac_f32 v255, v119, v223
    v_cvt_pk_bf16_f32 v43, v252, v253
    v_cvt_pk_bf16_f32 v27, v254, v255
    v_cvt_pk_bf16_f32 v59, -v252, -v253
    v_mfma_f32_32x32x16_bf16 v[64:79], v[20:23], v[132:135], v[64:79]
    s_waitcnt lgkmcnt(3)
    v_mul_f32 v248, v120, v224
    v_mul_f32 v250, v88, v224
    v_mul_f32 v249, v121, v225
    v_mul_f32 v251, v89, v225
    v_fma_f32 v248, -v88, v226, v248
    v_fmac_f32 v250, v120, v226
    v_fma_f32 v249, -v89, v227, v249
    v_fmac_f32 v251, v121, v227
    v_cvt_pk_bf16_f32 v44, v248, v249
    v_cvt_pk_bf16_f32 v28, v250, v251
    v_cvt_pk_bf16_f32 v60, -v248, -v249
    v_mfma_f32_32x32x16_bf16 v[96:111], v[36:39], v[132:135], v[96:111]
    s_waitcnt lgkmcnt(2)
    v_mul_f32 v252, v122, v228
    v_mul_f32 v254, v90, v228
    v_mul_f32 v253, v123, v229
    v_mul_f32 v255, v91, v229
    v_fma_f32 v252, -v90, v230, v252
    v_fmac_f32 v254, v122, v230
    v_fma_f32 v253, -v91, v231, v253
    v_fmac_f32 v255, v123, v231
    v_cvt_pk_bf16_f32 v45, v252, v253
    v_cvt_pk_bf16_f32 v29, v254, v255
    v_cvt_pk_bf16_f32 v61, -v252, -v253
    v_mfma_f32_32x32x16_bf16 v[64:79], v[52:55], v[140:143], v[64:79]
    s_waitcnt lgkmcnt(1)
    v_mul_f32 v248, v124, v232
    v_mul_f32 v250, v92, v232
    v_mul_f32 v249, v125, v233
    v_mul_f32 v251, v93, v233
    v_fma_f32 v248, -v92, v234, v248
    v_fmac_f32 v250, v124, v234
    v_fma_f32 v249, -v93, v235, v249
    v_fmac_f32 v251, v125, v235
    v_cvt_pk_bf16_f32 v46, v248, v249
    v_cvt_pk_bf16_f32 v30, v250, v251
    v_cvt_pk_bf16_f32 v62, -v248, -v249
    v_mfma_f32_32x32x16_bf16 v[96:111], v[20:23], v[140:143], v[96:111]
    s_waitcnt lgkmcnt(0)
    v_mul_f32 v252, v126, v236
    v_mul_f32 v254, v94, v236
    v_mul_f32 v253, v127, v237
    v_mul_f32 v255, v95, v237
    v_fma_f32 v252, -v94, v238, v252
    v_fmac_f32 v254, v126, v238
    v_fma_f32 v253, -v95, v239, v253
    v_fmac_f32 v255, v127, v239
    v_cvt_pk_bf16_f32 v47, v252, v253
    v_cvt_pk_bf16_f32 v31, v254, v255
    v_cvt_pk_bf16_f32 v63, -v252, -v253
    s_nop 1
    v_and_b32 v2, 31, v1
    v_lshlrev_b32 v2, 2, v2
    v_lshl_add_u32 v2, v3, 9, v2
    s_lshl_b32 s28, s52, 13
    s_add_u32 s28, s28, 57344
    v_add_u32 v2, s28, v2
    v_mfma_f32_32x32x16_bf16 v[80:95], v[24:27], v[128:131], 0
    v_mfma_f32_32x32x16_bf16 v[112:127], v[40:43], v[128:131], 0
    v_cvt_pk_bf16_f32 v64, v64, v96
    ds_write_b32 v2, v64 offset:0
    v_cvt_pk_bf16_f32 v65, v65, v97
    ds_write_b32 v2, v65 offset:128
    v_cvt_pk_bf16_f32 v66, v66, v98
    ds_write_b32 v2, v66 offset:256
    v_cvt_pk_bf16_f32 v67, v67, v99
    ds_write_b32 v2, v67 offset:384
    v_mfma_f32_32x32x16_bf16 v[80:95], v[56:59], v[136:139], v[80:95]
    v_cvt_pk_bf16_f32 v68, v68, v100
    ds_write_b32 v2, v68 offset:1024
    v_cvt_pk_bf16_f32 v69, v69, v101
    ds_write_b32 v2, v69 offset:1152
    v_mfma_f32_32x32x16_bf16 v[112:127], v[24:27], v[136:139], v[112:127]
    v_cvt_pk_bf16_f32 v70, v70, v102
    ds_write_b32 v2, v70 offset:1280
    v_cvt_pk_bf16_f32 v71, v71, v103
    ds_write_b32 v2, v71 offset:1408
    v_mfma_f32_32x32x16_bf16 v[80:95], v[28:31], v[132:135], v[80:95]
    v_cvt_pk_bf16_f32 v72, v72, v104
    ds_write_b32 v2, v72 offset:2048
    v_cvt_pk_bf16_f32 v73, v73, v105
    ds_write_b32 v2, v73 offset:2176
    v_mfma_f32_32x32x16_bf16 v[112:127], v[44:47], v[132:135], v[112:127]
    v_cvt_pk_bf16_f32 v74, v74, v106
    ds_write_b32 v2, v74 offset:2304
    v_cvt_pk_bf16_f32 v75, v75, v107
    ds_write_b32 v2, v75 offset:2432
    v_mfma_f32_32x32x16_bf16 v[80:95], v[60:63], v[140:143], v[80:95]
    v_cvt_pk_bf16_f32 v76, v76, v108
    ds_write_b32 v2, v76 offset:3072
    v_cvt_pk_bf16_f32 v77, v77, v109
    ds_write_b32 v2, v77 offset:3200
    v_mfma_f32_32x32x16_bf16 v[112:127], v[28:31], v[140:143], v[112:127]
    v_cvt_pk_bf16_f32 v78, v78, v110
    ds_write_b32 v2, v78 offset:3328
    v_cvt_pk_bf16_f32 v79, v79, v111
    ds_write_b32 v2, v79 offset:3456
    s_nop 1
    v_and_b32 v5, 31, v1
    v_lshlrev_b32 v5, 2, v5
    v_lshl_add_u32 v5, v3, 15, v5
    s_lshl_b32 s28, s52, 7
    s_add_u32 s28, s28, 57344
    v_add_u32 v5, s28, v5
    s_mul_i32 s28, s52, 141
    s_add_u32 s28, s28, s2
    s_add_u32 s28, s28, 112
    s_lshl_b32 s28, s28, 10
    s_add_u32 s28, s28, 0
    s_waitcnt lgkmcnt(0)
    s_barrier
    ds_read_b32 v208, v5 offset:0
    ds_read_b32 v209, v5 offset:8192
    ds_read_b32 v210, v5 offset:16384
    ds_read_b32 v211, v5 offset:24576
    ds_read_b32 v212, v5 offset:1024
    ds_read_b32 v213, v5 offset:9216
    ds_read_b32 v214, v5 offset:17408
    ds_read_b32 v215, v5 offset:25600
    ds_read_b32 v216, v5 offset:2048
    ds_read_b32 v217, v5 offset:10240
    ds_read_b32 v218, v5 offset:18432
    ds_read_b32 v219, v5 offset:26624
    ds_read_b32 v220, v5 offset:3072
    ds_read_b32 v221, v5 offset:11264
    ds_read_b32 v222, v5 offset:19456
    ds_read_b32 v223, v5 offset:27648
    v_cvt_pk_bf16_f32 v80, v80, v112
    ds_write_b32 v2, v80 offset:4096
    v_cvt_pk_bf16_f32 v81, v81, v113
    ds_write_b32 v2, v81 offset:4224
    v_cvt_pk_bf16_f32 v82, v82, v114
    ds_write_b32 v2, v82 offset:4352
    v_cvt_pk_bf16_f32 v83, v83, v115
    ds_write_b32 v2, v83 offset:4480
    s_waitcnt lgkmcnt(15)
    buffer_store_dwordx4 v[208:211], v4, s[8:11], s28 offen sc1
    s_add_u32 s28, s28, 1155072
    v_cvt_pk_bf16_f32 v84, v84, v116
    ds_write_b32 v2, v84 offset:5120
    v_cvt_pk_bf16_f32 v85, v85, v117
    ds_write_b32 v2, v85 offset:5248
    v_cvt_pk_bf16_f32 v86, v86, v118
    ds_write_b32 v2, v86 offset:5376
    v_cvt_pk_bf16_f32 v87, v87, v119
    ds_write_b32 v2, v87 offset:5504
    s_waitcnt lgkmcnt(15)
    buffer_store_dwordx4 v[212:215], v4, s[8:11], s28 offen sc1
    s_add_u32 s28, s28, 1155072
    v_cvt_pk_bf16_f32 v88, v88, v120
    ds_write_b32 v2, v88 offset:6144
    v_cvt_pk_bf16_f32 v89, v89, v121
    ds_write_b32 v2, v89 offset:6272
    v_cvt_pk_bf16_f32 v90, v90, v122
    ds_write_b32 v2, v90 offset:6400
    v_cvt_pk_bf16_f32 v91, v91, v123
    ds_write_b32 v2, v91 offset:6528
    s_waitcnt lgkmcnt(15)
    buffer_store_dwordx4 v[216:219], v4, s[8:11], s28 offen sc1
    s_add_u32 s28, s28, 1155072
    v_cvt_pk_bf16_f32 v92, v92, v124
    ds_write_b32 v2, v92 offset:7168
    v_cvt_pk_bf16_f32 v93, v93, v125
    ds_write_b32 v2, v93 offset:7296
    v_cvt_pk_bf16_f32 v94, v94, v126
    ds_write_b32 v2, v94 offset:7424
    v_cvt_pk_bf16_f32 v95, v95, v127
    ds_write_b32 v2, v95 offset:7552
    s_waitcnt lgkmcnt(15)
    buffer_store_dwordx4 v[220:223], v4, s[8:11], s28 offen sc1
    s_add_u32 s28, s28, 1155072
F_skipB:
    s_waitcnt lgkmcnt(0)
    s_barrier
    ds_read_b32 v32, v5 offset:4096
    ds_read_b32 v33, v5 offset:12288
    ds_read_b32 v34, v5 offset:20480
    ds_read_b32 v35, v5 offset:28672
    ds_read_b32 v36, v5 offset:5120
    ds_read_b32 v37, v5 offset:13312
    ds_read_b32 v38, v5 offset:21504
    ds_read_b32 v39, v5 offset:29696
    ds_read_b32 v40, v5 offset:6144
    ds_read_b32 v41, v5 offset:14336
    ds_read_b32 v42, v5 offset:22528
    ds_read_b32 v43, v5 offset:30720
    ds_read_b32 v44, v5 offset:7168
    ds_read_b32 v45, v5 offset:15360
    ds_read_b32 v46, v5 offset:23552
    ds_read_b32 v47, v5 offset:31744
    s_waitcnt lgkmcnt(12)
    buffer_store_dwordx4 v[32:35], v4, s[8:11], s28 offen sc1
    s_add_u32 s28, s28, 1155072
    s_waitcnt lgkmcnt(8)
    buffer_store_dwordx4 v[36:39], v4, s[8:11], s28 offen sc1
    s_add_u32 s28, s28, 1155072
    s_waitcnt lgkmcnt(4)
    buffer_store_dwordx4 v[40:43], v4, s[8:11], s28 offen sc1
    s_add_u32 s28, s28, 1155072
    s_waitcnt lgkmcnt(0)
    buffer_store_dwordx4 v[44:47], v4, s[8:11], s28 offen sc1
    s_add_u32 s28, s28, 1155072
    s_branch K1_fin2
K1_gemm:
    s_sub_u32 s57, s2, 32
    s_lshr_b32 s54, s57, 3
    s_mov_b32 s70, s54
    s_and_b32 s57, s57, 7
    s_lshr_b32 s53, s57, 1
    s_mul_i32 s53, s53, 7
    s_lshr_b32 s61, s54, 2
    s_add_u32 s53, s53, s61
    s_and_b32 s54, s54, 3
    s_and_b32 s57, s57, 1
    s_lshl_b32 s57, s57, 2
    s_add_u32 s54, s54, s57
    s_lshl_b32 s55, s54, 3
    s_add_u32 s55, s55, s52
    s_waitcnt lgkmcnt(0)
    s_mov_b32 s36, s22
    s_and_b32 s37, s23, 0xffff
    s_mov_b32 s38, 268435456
    s_mov_b32 s39, 0x00020000
    s_and_b32 s62, s52, 1
    s_cmp_eq_u32 s62, 0
    s_cselect_b32 s28, s12, s14
    s_cselect_b32 s29, s13, s15
    s_and_b32 s29, s29, 0xffff
    s_mov_b32 s30, 1605632
    s_mov_b32 s31, 0x00020000
    s_lshl_b32 s57, s53, 7
    v_lshlrev_b32 v2, 4, v1
    s_mul_i32 s68, s55, 28672
    s_add_u32 s68, s68, 15210496
    v_lshrrev_b32 v3, 3, v1
    v_and_b32 v4, 7, v1
    v_bfe_u32 v5, v3, 1, 1
    v_lshlrev_b32 v5, 2, v5
    v_xor_b32 v4, v4, v5
    s_lshr_b32 s63, s52, 1
    s_lshl_b32 s64, s63, 3
    v_add_u32 v3, s64, v3
    s_movk_i32 s56, 3584
    v_mul_lo_u32 v3, v3, s56
    v_lshl_add_u32 v3, v4, 4, v3
    v_add_u32 v3, s57, v3
    s_mul_i32 s65, s62, 57344
    s_lshl_b32 s64, s63, 10
    s_add_u32 s65, s65, s64
    s_lshr_b32 s72, s70, 2
    s_and_b32 s73, s70, 3
    s_lshl_b32 s73, s73, 1
    s_add_u32 s72, s72, s73
    s_cmp_ge_u32 s72, 7
    s_cselect_b32 s73, 7, 0
    s_sub_u32 s72, s72, s73
    s_mov_b32 s72, 0
    s_mul_i32 s67, s72, 229376
    s_lshl_b32 s72, s72, 12
    s_add_u32 s68, s68, s72
    s_mov_b32 m0, s65
    s_add_u32 s65, s65, 4096
    buffer_load_dwordx4 v3, s[28:31], s67 offen lds
    s_add_u32 s67, s67, 114688
    s_mov_b32 m0, s65
    s_add_u32 s65, s65, 4096
    buffer_load_dwordx4 v3, s[28:31], s67 offen lds
    s_add_u32 s67, s67, 114688
    buffer_load_dwordx4 v[16:19], v2, s[36:39], s68 offen offset:0
    buffer_load_dwordx4 v[20:23], v2, s[36:39], s68 offen offset:1024
    buffer_load_dwordx4 v[24:27], v2, s[36:39], s68 offen offset:2048
    buffer_load_dwordx4 v[28:31], v2, s[36:39], s68 offen offset:3072
    s_add_u32 s68, s68, 4096
    v_lshrrev_b32 v4, 5, v1
    v_bfe_u32 v5, v1, 2, 2
    v_lshl_add_u32 v4, v4, 3, v5
    v_lshlrev_b32 v4, 7, v4
    v_bfe_u32 v6, v1, 4, 1
    v_bfe_u32 v7, v1, 1, 1
    v_lshl_add_u32 v6, v6, 1, v7
    v_lshrrev_b32 v7, 1, v5
    v_lshlrev_b32 v7, 2, v7
    v_xor_b32 v6, v6, v7
    v_lshl_add_u32 v4, v6, 4, v4
    v_and_b32 v7, 1, v1
    v_lshl_add_u32 v4, v7, 3, v4
    v_xor_b32 v5, 64, v4
    v_add_u32 v6, 57344, v4
    v_add_u32 v7, 57344, v5
    s_waitcnt vmcnt(3)
    s_mov_b32 m0, s65
    s_add_u32 s65, s65, 4096
    buffer_load_dwordx4 v3, s[28:31], s67 offen lds
    s_add_u32 s67, s67, 114688
    s_mov_b32 m0, s65
    s_add_u32 s65, s65, 4096
    buffer_load_dwordx4 v3, s[28:31], s67 offen lds
    s_add_u32 s67, s67, 114688
    buffer_load_dwordx4 v[32:35], v2, s[36:39], s68 offen offset:0
    buffer_load_dwordx4 v[36:39], v2, s[36:39], s68 offen offset:1024
    buffer_load_dwordx4 v[40:43], v2, s[36:39], s68 offen offset:2048
    buffer_load_dwordx4 v[44:47], v2, s[36:39], s68 offen offset:3072
    s_add_u32 s68, s68, 4096
    s_waitcnt vmcnt(6)
    s_barrier
    ds_read_b64_tr_b16 v[192:193], v4 offset:0
    ds_read_b64_tr_b16 v[194:195], v4 offset:512
    ds_read_b64_tr_b16 v[196:197], v5 offset:0
    ds_read_b64_tr_b16 v[198:199], v5 offset:512
    ds_read_b64_tr_b16 v[200:201], v6 offset:0
    ds_read_b64_tr_b16 v[202:203], v6 offset:512
    ds_read_b64_tr_b16 v[204:205], v7 offset:0
    ds_read_b64_tr_b16 v[206:207], v7 offset:512
    s_and_b32 s41, s41, 0xffff
    s_mov_b32 s42, 1605632
    s_mov_b32 s43, 0x00020000
    s_getpc_b64 s[44:45]
    s_add_u32 s44, s44, gdftab@rel32@lo+4
    s_addc_u32 s45, s45, gdftab@rel32@hi+12
    s_and_b32 s45, s45, 0xffff
    s_mov_b32 s46, 415744
    s_mov_b32 s47, 0x00020000
    s_getpc_b64 s[48:49]
    s_add_u32 s48, s48, k3_kernel@rel32@lo+4
    s_addc_u32 s49, s49, k3_kernel@rel32@hi+12
    s_and_b32 s49, s49, 0xffff
    s_mov_b32 s50, K3_end-k3_kernel
    s_mov_b32 s51, 0x00020000
    s_lshl_b32 s74, s70, 3
    s_add_u32 s74, s74, s52
    s_mul_i32 s75, s74, 1171
    s_lshr_b32 s75, s75, 16
    s_mul_i32 s76, s75, 56
    s_sub_u32 s76, s74, s76
    s_mul_i32 s75, s75, 473088
    s_mul_i32 s76, s76, 4096
    s_add_u32 s75, s75, s76
    s_mul_i32 s76, s74, 4682
    s_lshr_b32 s76, s76, 16
    s_mul_i32 s78, s76, 14
    s_sub_u32 s78, s74, s78
    s_mul_i32 s78, s78, 29
    s_add_u32 s76, s76, s78
    s_lshl_b32 s76, s76, 10
    s_lshl_b32 s74, s74, 10
    s_sub_u32 s77, s2, 32
    s_lshl_b32 s77, s77, 3
    s_add_u32 s77, s77, s52
    s_lshl_b32 s77, s77, 10
    ds_read_b64_tr_b16 v[208:209], v4 offset:2048
    ds_read_b64_tr_b16 v[210:211], v4 offset:2560
    ds_read_b64_tr_b16 v[212:213], v5 offset:2048
    ds_read_b64_tr_b16 v[214:215], v5 offset:2560
    ds_read_b64_tr_b16 v[216:217], v6 offset:2048
    ds_read_b64_tr_b16 v[218:219], v6 offset:2560
    ds_read_b64_tr_b16 v[220:221], v7 offset:2048
    ds_read_b64_tr_b16 v[222:223], v7 offset:2560
    s_waitcnt lgkmcnt(8)
    v_mfma_f32_32x32x16_bf16 v[128:143], v[192:195], v[16:19], 0
    v_mfma_f32_32x32x16_bf16 v[144:159], v[196:199], v[16:19], 0
    s_mov_b32 m0, s65
    s_add_u32 s65, s65, 4096
    buffer_load_dwordx4 v3, s[28:31], s67 offen lds
    s_add_u32 s67, s67, 114688
    v_mfma_f32_32x32x16_bf16 v[160:175], v[200:203], v[16:19], 0
    v_mfma_f32_32x32x16_bf16 v[176:191], v[204:207], v[16:19], 0
    s_mov_b32 m0, s65
    s_add_u32 s65, s65, 4096
    buffer_load_dwordx4 v3, s[28:31], s67 offen lds
    s_add_u32 s67, s67, 114688
    ds_read_b64_tr_b16 v[192:193], v4 offset:4096
    ds_read_b64_tr_b16 v[194:195], v4 offset:4608
    ds_read_b64_tr_b16 v[196:197], v5 offset:4096
    ds_read_b64_tr_b16 v[198:199], v5 offset:4608
    ds_read_b64_tr_b16 v[200:201], v6 offset:4096
    ds_read_b64_tr_b16 v[202:203], v6 offset:4608
    ds_read_b64_tr_b16 v[204:205], v7 offset:4096
    ds_read_b64_tr_b16 v[206:207], v7 offset:4608
    s_waitcnt lgkmcnt(8)
    v_mfma_f32_32x32x16_bf16 v[128:143], v[208:211], v[20:23], v[128:143]
    v_mfma_f32_32x32x16_bf16 v[144:159], v[212:215], v[20:23], v[144:159]
    buffer_load_dwordx4 v[48:51], v2, s[36:39], s68 offen offset:0
    v_mfma_f32_32x32x16_bf16 v[160:175], v[216:219], v[20:23], v[160:175]
    v_mfma_f32_32x32x16_bf16 v[176:191], v[220:223], v[20:23], v[176:191]
    buffer_load_dwordx4 v[52:55], v2, s[36:39], s68 offen offset:1024
    ds_read_b64_tr_b16 v[208:209], v4 offset:6144
    ds_read_b64_tr_b16 v[210:211], v4 offset:6656
    ds_read_b64_tr_b16 v[212:213], v5 offset:6144
    ds_read_b64_tr_b16 v[214:215], v5 offset:6656
    ds_read_b64_tr_b16 v[216:217], v6 offset:6144
    ds_read_b64_tr_b16 v[218:219], v6 offset:6656
    ds_read_b64_tr_b16 v[220:221], v7 offset:6144
    ds_read_b64_tr_b16 v[222:223], v7 offset:6656
    s_waitcnt lgkmcnt(8)
    v_mfma_f32_32x32x16_bf16 v[128:143], v[192:195], v[24:27], v[128:143]
    v_mfma_f32_32x32x16_bf16 v[144:159], v[196:199], v[24:27], v[144:159]
    buffer_load_dwordx4 v[56:59], v2, s[36:39], s68 offen offset:2048
    v_mfma_f32_32x32x16_bf16 v[160:175], v[200:203], v[24:27], v[160:175]
    v_mfma_f32_32x32x16_bf16 v[176:191], v[204:207], v[24:27], v[176:191]
    s_waitcnt vmcnt(5)
    s_barrier
    ds_read_b64_tr_b16 v[192:193], v4 offset:8192
    ds_read_b64_tr_b16 v[194:195], v4 offset:8704
    ds_read_b64_tr_b16 v[196:197], v5 offset:8192
    ds_read_b64_tr_b16 v[198:199], v5 offset:8704
    ds_read_b64_tr_b16 v[200:201], v6 offset:8192
    ds_read_b64_tr_b16 v[202:203], v6 offset:8704
    ds_read_b64_tr_b16 v[204:205], v7 offset:8192
    ds_read_b64_tr_b16 v[206:207], v7 offset:8704
    s_waitcnt lgkmcnt(8)
    v_mfma_f32_32x32x16_bf16 v[128:143], v[208:211], v[28:31], v[128:143]
    v_mfma_f32_32x32x16_bf16 v[144:159], v[212:215], v[28:31], v[144:159]
    buffer_load_dwordx4 v[60:63], v2, s[36:39], s68 offen offset:3072
    s_add_u32 s68, s68, 4096
    v_mfma_f32_32x32x16_bf16 v[160:175], v[216:219], v[28:31], v[160:175]
    v_mfma_f32_32x32x16_bf16 v[176:191], v[220:223], v[28:31], v[176:191]
    ds_read_b64_tr_b16 v[208:209], v4 offset:10240
    ds_read_b64_tr_b16 v[210:211], v4 offset:10752
    ds_read_b64_tr_b16 v[212:213], v5 offset:10240
    ds_read_b64_tr_b16 v[214:215], v5 offset:10752
    ds_read_b64_tr_b16 v[216:217], v6 offset:10240
    ds_read_b64_tr_b16 v[218:219], v6 offset:10752
    ds_read_b64_tr_b16 v[220:221], v7 offset:10240
    ds_read_b64_tr_b16 v[222:223], v7 offset:10752
    s_waitcnt lgkmcnt(8)
    v_mfma_f32_32x32x16_bf16 v[128:143], v[192:195], v[32:35], v[128:143]
    v_mfma_f32_32x32x16_bf16 v[144:159], v[196:199], v[32:35], v[144:159]
    s_mov_b32 m0, s65
    s_add_u32 s65, s65, 4096
    buffer_load_dwordx4 v3, s[28:31], s67 offen lds
    s_add_u32 s67, s67, 114688
    v_mfma_f32_32x32x16_bf16 v[160:175], v[200:203], v[32:35], v[160:175]
    v_mfma_f32_32x32x16_bf16 v[176:191], v[204:207], v[32:35], v[176:191]
    s_mov_b32 m0, s65
    s_add_u32 s65, s65, 4096
    buffer_load_dwordx4 v3, s[28:31], s67 offen lds
    s_add_u32 s67, s67, 114688
    ds_read_b64_tr_b16 v[192:193], v4 offset:12288
    ds_read_b64_tr_b16 v[194:195], v4 offset:12800
    ds_read_b64_tr_b16 v[196:197], v5 offset:12288
    ds_read_b64_tr_b16 v[198:199], v5 offset:12800
    ds_read_b64_tr_b16 v[200:201], v6 offset:12288
    ds_read_b64_tr_b16 v[202:203], v6 offset:12800
    ds_read_b64_tr_b16 v[204:205], v7 offset:12288
    ds_read_b64_tr_b16 v[206:207], v7 offset:12800
    s_waitcnt lgkmcnt(8)
    v_mfma_f32_32x32x16_bf16 v[128:143], v[208:211], v[36:39], v[128:143]
    v_mfma_f32_32x32x16_bf16 v[144:159], v[212:215], v[36:39], v[144:159]
    buffer_load_dwordx4 v[64:67], v2, s[36:39], s68 offen offset:0
    v_mfma_f32_32x32x16_bf16 v[160:175], v[216:219], v[36:39], v[160:175]
    v_mfma_f32_32x32x16_bf16 v[176:191], v[220:223], v[36:39], v[176:191]
    buffer_load_dwordx4 v[68:71], v2, s[36:39], s68 offen offset:1024
    ds_read_b64_tr_b16 v[208:209], v4 offset:14336
    ds_read_b64_tr_b16 v[210:211], v4 offset:14848
    ds_read_b64_tr_b16 v[212:213], v5 offset:14336
    ds_read_b64_tr_b16 v[214:215], v5 offset:14848
    ds_read_b64_tr_b16 v[216:217], v6 offset:14336
    ds_read_b64_tr_b16 v[218:219], v6 offset:14848
    ds_read_b64_tr_b16 v[220:221], v7 offset:14336
    ds_read_b64_tr_b16 v[222:223], v7 offset:14848
    s_waitcnt lgkmcnt(8)
    v_mfma_f32_32x32x16_bf16 v[128:143], v[192:195], v[40:43], v[128:143]
    v_mfma_f32_32x32x16_bf16 v[144:159], v[196:199], v[40:43], v[144:159]
    buffer_load_dwordx4 v[72:75], v2, s[36:39], s68 offen offset:2048
    v_mfma_f32_32x32x16_bf16 v[160:175], v[200:203], v[40:43], v[160:175]
    v_mfma_f32_32x32x16_bf16 v[176:191], v[204:207], v[40:43], v[176:191]
    s_waitcnt vmcnt(5)
    s_barrier
    ds_read_b64_tr_b16 v[192:193], v4 offset:16384
    ds_read_b64_tr_b16 v[194:195], v4 offset:16896
    ds_read_b64_tr_b16 v[196:197], v5 offset:16384
    ds_read_b64_tr_b16 v[198:199], v5 offset:16896
    ds_read_b64_tr_b16 v[200:201], v6 offset:16384
    ds_read_b64_tr_b16 v[202:203], v6 offset:16896
    ds_read_b64_tr_b16 v[204:205], v7 offset:16384
    ds_read_b64_tr_b16 v[206:207], v7 offset:16896
    s_waitcnt lgkmcnt(8)
    v_mfma_f32_32x32x16_bf16 v[128:143], v[208:211], v[44:47], v[128:143]
    v_mfma_f32_32x32x16_bf16 v[144:159], v[212:215], v[44:47], v[144:159]
    buffer_load_dwordx4 v[76:79], v2, s[36:39], s68 offen offset:3072
    s_add_u32 s68, s68, 4096
    v_mfma_f32_32x32x16_bf16 v[160:175], v[216:219], v[44:47], v[160:175]
    v_mfma_f32_32x32x16_bf16 v[176:191], v[220:223], v[44:47], v[176:191]
    ds_read_b64_tr_b16 v[208:209], v4 offset:18432
    ds_read_b64_tr_b16 v[210:211], v4 offset:18944
    ds_read_b64_tr_b16 v[212:213], v5 offset:18432
    ds_read_b64_tr_b16 v[214:215], v5 offset:18944
    ds_read_b64_tr_b16 v[216:217], v6 offset:18432
    ds_read_b64_tr_b16 v[218:219], v6 offset:18944
    ds_read_b64_tr_b16 v[220:221], v7 offset:18432
    ds_read_b64_tr_b16 v[222:223], v7 offset:18944
    s_waitcnt lgkmcnt(8)
    v_mfma_f32_32x32x16_bf16 v[128:143], v[192:195], v[48:51], v[128:143]
    v_mfma_f32_32x32x16_bf16 v[144:159], v[196:199], v[48:51], v[144:159]
    s_mov_b32 m0, s65
    s_add_u32 s65, s65, 4096
    buffer_load_dwordx4 v3, s[28:31], s67 offen lds
    s_add_u32 s67, s67, 114688
    v_mfma_f32_32x32x16_bf16 v[160:175], v[200:203], v[48:51], v[160:175]
    v_mfma_f32_32x32x16_bf16 v[176:191], v[204:207], v[48:51], v[176:191]
    s_mov_b32 m0, s65
    s_add_u32 s65, s65, 4096
    buffer_load_dwordx4 v3, s[28:31], s67 offen lds
    s_add_u32 s67, s67, 114688
    ds_read_b64_tr_b16 v[192:193], v4 offset:20480
    ds_read_b64_tr_b16 v[194:195], v4 offset:20992
    ds_read_b64_tr_b16 v[196:197], v5 offset:20480
    ds_read_b64_tr_b16 v[198:199], v5 offset:20992
    ds_read_b64_tr_b16 v[200:201], v6 offset:20480
    ds_read_b64_tr_b16 v[202:203], v6 offset:20992
    ds_read_b64_tr_b16 v[204:205], v7 offset:20480
    ds_read_b64_tr_b16 v[206:207], v7 offset:20992
    s_waitcnt lgkmcnt(8)
    v_mfma_f32_32x32x16_bf16 v[128:143], v[208:211], v[52:55], v[128:143]
    v_mfma_f32_32x32x16_bf16 v[144:159], v[212:215], v[52:55], v[144:159]
    buffer_load_dwordx4 v[80:83], v2, s[36:39], s68 offen offset:0
    v_mfma_f32_32x32x16_bf16 v[160:175], v[216:219], v[52:55], v[160:175]
    v_mfma_f32_32x32x16_bf16 v[176:191], v[220:223], v[52:55], v[176:191]
    buffer_load_dwordx4 v[84:87], v2, s[36:39], s68 offen offset:1024
    ds_read_b64_tr_b16 v[208:209], v4 offset:22528
    ds_read_b64_tr_b16 v[210:211], v4 offset:23040
    ds_read_b64_tr_b16 v[212:213], v5 offset:22528
    ds_read_b64_tr_b16 v[214:215], v5 offset:23040
    ds_read_b64_tr_b16 v[216:217], v6 offset:22528
    ds_read_b64_tr_b16 v[218:219], v6 offset:23040
    ds_read_b64_tr_b16 v[220:221], v7 offset:22528
    ds_read_b64_tr_b16 v[222:223], v7 offset:23040
    s_waitcnt lgkmcnt(8)
    v_mfma_f32_32x32x16_bf16 v[128:143], v[192:195], v[56:59], v[128:143]
    v_mfma_f32_32x32x16_bf16 v[144:159], v[196:199], v[56:59], v[144:159]
    buffer_load_dwordx4 v[88:91], v2, s[36:39], s68 offen offset:2048
    v_mfma_f32_32x32x16_bf16 v[160:175], v[200:203], v[56:59], v[160:175]
    v_mfma_f32_32x32x16_bf16 v[176:191], v[204:207], v[56:59], v[176:191]
    s_waitcnt vmcnt(5)
    s_barrier
    ds_read_b64_tr_b16 v[192:193], v4 offset:24576
    ds_read_b64_tr_b16 v[194:195], v4 offset:25088
    ds_read_b64_tr_b16 v[196:197], v5 offset:24576
    ds_read_b64_tr_b16 v[198:199], v5 offset:25088
    ds_read_b64_tr_b16 v[200:201], v6 offset:24576
    ds_read_b64_tr_b16 v[202:203], v6 offset:25088
    ds_read_b64_tr_b16 v[204:205], v7 offset:24576
    ds_read_b64_tr_b16 v[206:207], v7 offset:25088
    s_waitcnt lgkmcnt(8)
    v_mfma_f32_32x32x16_bf16 v[128:143], v[208:211], v[60:63], v[128:143]
    v_mfma_f32_32x32x16_bf16 v[144:159], v[212:215], v[60:63], v[144:159]
    buffer_load_dwordx4 v[92:95], v2, s[36:39], s68 offen offset:3072
    s_add_u32 s68, s68, 4096
    v_mfma_f32_32x32x16_bf16 v[160:175], v[216:219], v[60:63], v[160:175]
    v_mfma_f32_32x32x16_bf16 v[176:191], v[220:223], v[60:63], v[176:191]
    ds_read_b64_tr_b16 v[208:209], v4 offset:26624
    ds_read_b64_tr_b16 v[210:211], v4 offset:27136
    ds_read_b64_tr_b16 v[212:213], v5 offset:26624
    ds_read_b64_tr_b16 v[214:215], v5 offset:27136
    ds_read_b64_tr_b16 v[216:217], v6 offset:26624
    ds_read_b64_tr_b16 v[218:219], v6 offset:27136
    ds_read_b64_tr_b16 v[220:221], v7 offset:26624
    ds_read_b64_tr_b16 v[222:223], v7 offset:27136
    s_waitcnt lgkmcnt(8)
    v_mfma_f32_32x32x16_bf16 v[128:143], v[192:195], v[64:67], v[128:143]
    v_mfma_f32_32x32x16_bf16 v[144:159], v[196:199], v[64:67], v[144:159]
    s_mov_b32 m0, s65
    s_add_u32 s65, s65, 4096
    buffer_load_dwordx4 v3, s[28:31], s67 offen lds
    s_add_u32 s67, s67, 114688
    v_mfma_f32_32x32x16_bf16 v[160:175], v[200:203], v[64:67], v[160:175]
    v_mfma_f32_32x32x16_bf16 v[176:191], v[204:207], v[64:67], v[176:191]
    s_mov_b32 m0, s65
    s_add_u32 s65, s65, 4096
    buffer_load_dwordx4 v3, s[28:31], s67 offen lds
    s_add_u32 s67, s67, 114688
    ds_read_b64_tr_b16 v[192:193], v4 offset:28672
    ds_read_b64_tr_b16 v[194:195], v4 offset:29184
    ds_read_b64_tr_b16 v[196:197], v5 offset:28672
    ds_read_b64_tr_b16 v[198:199], v5 offset:29184
    ds_read_b64_tr_b16 v[200:201], v6 offset:28672
    ds_read_b64_tr_b16 v[202:203], v6 offset:29184
    ds_read_b64_tr_b16 v[204:205], v7 offset:28672
    ds_read_b64_tr_b16 v[206:207], v7 offset:29184
    s_waitcnt lgkmcnt(8)
    v_mfma_f32_32x32x16_bf16 v[128:143], v[208:211], v[68:71], v[128:143]
    v_mfma_f32_32x32x16_bf16 v[144:159], v[212:215], v[68:71], v[144:159]
    buffer_load_dwordx4 v[96:99], v2, s[36:39], s68 offen offset:0
    v_mfma_f32_32x32x16_bf16 v[160:175], v[216:219], v[68:71], v[160:175]
    v_mfma_f32_32x32x16_bf16 v[176:191], v[220:223], v[68:71], v[176:191]
    buffer_load_dwordx4 v[100:103], v2, s[36:39], s68 offen offset:1024
    ds_read_b64_tr_b16 v[208:209], v4 offset:30720
    ds_read_b64_tr_b16 v[210:211], v4 offset:31232
    ds_read_b64_tr_b16 v[212:213], v5 offset:30720
    ds_read_b64_tr_b16 v[214:215], v5 offset:31232
    ds_read_b64_tr_b16 v[216:217], v6 offset:30720
    ds_read_b64_tr_b16 v[218:219], v6 offset:31232
    ds_read_b64_tr_b16 v[220:221], v7 offset:30720
    ds_read_b64_tr_b16 v[222:223], v7 offset:31232
    s_waitcnt lgkmcnt(8)
    v_mfma_f32_32x32x16_bf16 v[128:143], v[192:195], v[72:75], v[128:143]
    v_mfma_f32_32x32x16_bf16 v[144:159], v[196:199], v[72:75], v[144:159]
    buffer_load_dwordx4 v[104:107], v2, s[36:39], s68 offen offset:2048
    v_mfma_f32_32x32x16_bf16 v[160:175], v[200:203], v[72:75], v[160:175]
    v_mfma_f32_32x32x16_bf16 v[176:191], v[204:207], v[72:75], v[176:191]
    s_waitcnt vmcnt(5)
    s_barrier
    ds_read_b64_tr_b16 v[192:193], v4 offset:32768
    ds_read_b64_tr_b16 v[194:195], v4 offset:33280
    ds_read_b64_tr_b16 v[196:197], v5 offset:32768
    ds_read_b64_tr_b16 v[198:199], v5 offset:33280
    ds_read_b64_tr_b16 v[200:201], v6 offset:32768
    ds_read_b64_tr_b16 v[202:203], v6 offset:33280
    ds_read_b64_tr_b16 v[204:205], v7 offset:32768
    ds_read_b64_tr_b16 v[206:207], v7 offset:33280
    s_waitcnt lgkmcnt(8)
    v_mfma_f32_32x32x16_bf16 v[128:143], v[208:211], v[76:79], v[128:143]
    v_mfma_f32_32x32x16_bf16 v[144:159], v[212:215], v[76:79], v[144:159]
    buffer_load_dwordx4 v[108:111], v2, s[36:39], s68 offen offset:3072
    s_add_u32 s68, s68, 4096
    v_mfma_f32_32x32x16_bf16 v[160:175], v[216:219], v[76:79], v[160:175]
    v_mfma_f32_32x32x16_bf16 v[176:191], v[220:223], v[76:79], v[176:191]
    ds_read_b64_tr_b16 v[208:209], v4 offset:34816
    ds_read_b64_tr_b16 v[210:211], v4 offset:35328
    ds_read_b64_tr_b16 v[212:213], v5 offset:34816
    ds_read_b64_tr_b16 v[214:215], v5 offset:35328
    ds_read_b64_tr_b16 v[216:217], v6 offset:34816
    ds_read_b64_tr_b16 v[218:219], v6 offset:35328
    ds_read_b64_tr_b16 v[220:221], v7 offset:34816
    ds_read_b64_tr_b16 v[222:223], v7 offset:35328
    s_waitcnt lgkmcnt(8)
    v_mfma_f32_32x32x16_bf16 v[128:143], v[192:195], v[80:83], v[128:143]
    v_mfma_f32_32x32x16_bf16 v[144:159], v[196:199], v[80:83], v[144:159]
    s_mov_b32 m0, s65
    s_add_u32 s65, s65, 4096
    buffer_load_dwordx4 v3, s[28:31], s67 offen lds
    s_add_u32 s67, s67, 114688
    v_mfma_f32_32x32x16_bf16 v[160:175], v[200:203], v[80:83], v[160:175]
    v_mfma_f32_32x32x16_bf16 v[176:191], v[204:207], v[80:83], v[176:191]
    s_mov_b32 m0, s65
    s_add_u32 s65, s65, 4096
    buffer_load_dwordx4 v3, s[28:31], s67 offen lds
    s_add_u32 s67, s67, 114688
    ds_read_b64_tr_b16 v[192:193], v4 offset:36864
    ds_read_b64_tr_b16 v[194:195], v4 offset:37376
    ds_read_b64_tr_b16 v[196:197], v5 offset:36864
    ds_read_b64_tr_b16 v[198:199], v5 offset:37376
    ds_read_b64_tr_b16 v[200:201], v6 offset:36864
    ds_read_b64_tr_b16 v[202:203], v6 offset:37376
    ds_read_b64_tr_b16 v[204:205], v7 offset:36864
    ds_read_b64_tr_b16 v[206:207], v7 offset:37376
    s_waitcnt lgkmcnt(8)
    v_mfma_f32_32x32x16_bf16 v[128:143], v[208:211], v[84:87], v[128:143]
    v_mfma_f32_32x32x16_bf16 v[144:159], v[212:215], v[84:87], v[144:159]
    buffer_load_dwordx4 v[112:115], v2, s[36:39], s68 offen offset:0
    v_mfma_f32_32x32x16_bf16 v[160:175], v[216:219], v[84:87], v[160:175]
    v_mfma_f32_32x32x16_bf16 v[176:191], v[220:223], v[84:87], v[176:191]
    buffer_load_dwordx4 v[116:119], v2, s[36:39], s68 offen offset:1024
    ds_read_b64_tr_b16 v[208:209], v4 offset:38912
    ds_read_b64_tr_b16 v[210:211], v4 offset:39424
    ds_read_b64_tr_b16 v[212:213], v5 offset:38912
    ds_read_b64_tr_b16 v[214:215], v5 offset:39424
    ds_read_b64_tr_b16 v[216:217], v6 offset:38912
    ds_read_b64_tr_b16 v[218:219], v6 offset:39424
    ds_read_b64_tr_b16 v[220:221], v7 offset:38912
    ds_read_b64_tr_b16 v[222:223], v7 offset:39424
    s_waitcnt lgkmcnt(8)
    v_mfma_f32_32x32x16_bf16 v[128:143], v[192:195], v[88:91], v[128:143]
    v_mfma_f32_32x32x16_bf16 v[144:159], v[196:199], v[88:91], v[144:159]
    buffer_load_dwordx4 v[120:123], v2, s[36:39], s68 offen offset:2048
    v_mfma_f32_32x32x16_bf16 v[160:175], v[200:203], v[88:91], v[160:175]
    v_mfma_f32_32x32x16_bf16 v[176:191], v[204:207], v[88:91], v[176:191]
    s_waitcnt vmcnt(5)
    s_barrier
    ds_read_b64_tr_b16 v[192:193], v4 offset:40960
    ds_read_b64_tr_b16 v[194:195], v4 offset:41472
    ds_read_b64_tr_b16 v[196:197], v5 offset:40960
    ds_read_b64_tr_b16 v[198:199], v5 offset:41472
    ds_read_b64_tr_b16 v[200:201], v6 offset:40960
    ds_read_b64_tr_b16 v[202:203], v6 offset:41472
    ds_read_b64_tr_b16 v[204:205], v7 offset:40960
    ds_read_b64_tr_b16 v[206:207], v7 offset:41472
    s_waitcnt lgkmcnt(8)
    v_mfma_f32_32x32x16_bf16 v[128:143], v[208:211], v[92:95], v[128:143]
    v_mfma_f32_32x32x16_bf16 v[144:159], v[212:215], v[92:95], v[144:159]
    buffer_load_dwordx4 v[124:127], v2, s[36:39], s68 offen offset:3072
    s_add_u32 s68, s68, 4096
    v_mfma_f32_32x32x16_bf16 v[160:175], v[216:219], v[92:95], v[160:175]
    v_mfma_f32_32x32x16_bf16 v[176:191], v[220:223], v[92:95], v[176:191]
    ds_read_b64_tr_b16 v[208:209], v4 offset:43008
    ds_read_b64_tr_b16 v[210:211], v4 offset:43520
    ds_read_b64_tr_b16 v[212:213], v5 offset:43008
    ds_read_b64_tr_b16 v[214:215], v5 offset:43520
    ds_read_b64_tr_b16 v[216:217], v6 offset:43008
    ds_read_b64_tr_b16 v[218:219], v6 offset:43520
    ds_read_b64_tr_b16 v[220:221], v7 offset:43008
    ds_read_b64_tr_b16 v[222:223], v7 offset:43520
    s_waitcnt lgkmcnt(8)
    v_mfma_f32_32x32x16_bf16 v[128:143], v[192:195], v[96:99], v[128:143]
    v_mfma_f32_32x32x16_bf16 v[144:159], v[196:199], v[96:99], v[144:159]
    buffer_load_dwordx4 v[16:19], v2, s[48:51], s74 offen
    v_mfma_f32_32x32x16_bf16 v[160:175], v[200:203], v[96:99], v[160:175]
    buffer_load_dwordx4 v[16:19], v2, s[40:43], s77 offen
    v_mfma_f32_32x32x16_bf16 v[176:191], v[204:207], v[96:99], v[176:191]
    buffer_load_dwordx4 v[16:19], v2, s[40:43], s75 offen offset:0
    ds_read_b64_tr_b16 v[192:193], v4 offset:45056
    ds_read_b64_tr_b16 v[194:195], v4 offset:45568
    ds_read_b64_tr_b16 v[196:197], v5 offset:45056
    ds_read_b64_tr_b16 v[198:199], v5 offset:45568
    ds_read_b64_tr_b16 v[200:201], v6 offset:45056
    ds_read_b64_tr_b16 v[202:203], v6 offset:45568
    ds_read_b64_tr_b16 v[204:205], v7 offset:45056
    ds_read_b64_tr_b16 v[206:207], v7 offset:45568
    s_waitcnt lgkmcnt(8)
    v_mfma_f32_32x32x16_bf16 v[128:143], v[208:211], v[100:103], v[128:143]
    v_mfma_f32_32x32x16_bf16 v[144:159], v[212:215], v[100:103], v[144:159]
    buffer_load_dwordx4 v[16:19], v2, s[40:43], s75 offen offset:1024
    v_mfma_f32_32x32x16_bf16 v[160:175], v[216:219], v[100:103], v[160:175]
    buffer_load_dwordx4 v[16:19], v2, s[44:47], s77 offen
    v_mfma_f32_32x32x16_bf16 v[176:191], v[220:223], v[100:103], v[176:191]
    buffer_load_dwordx4 v[16:19], v2, s[40:43], s75 offen offset:2048
    ds_read_b64_tr_b16 v[208:209], v4 offset:47104
    ds_read_b64_tr_b16 v[210:211], v4 offset:47616
    ds_read_b64_tr_b16 v[212:213], v5 offset:47104
    ds_read_b64_tr_b16 v[214:215], v5 offset:47616
    ds_read_b64_tr_b16 v[216:217], v6 offset:47104
    ds_read_b64_tr_b16 v[218:219], v6 offset:47616
    ds_read_b64_tr_b16 v[220:221], v7 offset:47104
    ds_read_b64_tr_b16 v[222:223], v7 offset:47616
    s_waitcnt lgkmcnt(8)
    v_mfma_f32_32x32x16_bf16 v[128:143], v[192:195], v[104:107], v[128:143]
    v_mfma_f32_32x32x16_bf16 v[144:159], v[196:199], v[104:107], v[144:159]
    buffer_load_dwordx4 v[16:19], v2, s[40:43], s75 offen offset:3072
    s_add_u32 s75, s75, 4096
    v_mfma_f32_32x32x16_bf16 v[160:175], v[200:203], v[104:107], v[160:175]
    v_mfma_f32_32x32x16_bf16 v[176:191], v[204:207], v[104:107], v[176:191]
    buffer_load_dwordx4 v[16:19], v2, s[44:47], s76 offen
    s_waitcnt vmcnt(8)
    s_barrier
    ds_read_b64_tr_b16 v[192:193], v4 offset:49152
    ds_read_b64_tr_b16 v[194:195], v4 offset:49664
    ds_read_b64_tr_b16 v[196:197], v5 offset:49152
    ds_read_b64_tr_b16 v[198:199], v5 offset:49664
    ds_read_b64_tr_b16 v[200:201], v6 offset:49152
    ds_read_b64_tr_b16 v[202:203], v6 offset:49664
    ds_read_b64_tr_b16 v[204:205], v7 offset:49152
    ds_read_b64_tr_b16 v[206:207], v7 offset:49664
    s_waitcnt lgkmcnt(8)
    v_mfma_f32_32x32x16_bf16 v[128:143], v[208:211], v[108:111], v[128:143]
    v_mfma_f32_32x32x16_bf16 v[144:159], v[212:215], v[108:111], v[144:159]
    v_mfma_f32_32x32x16_bf16 v[160:175], v[216:219], v[108:111], v[160:175]
    v_mfma_f32_32x32x16_bf16 v[176:191], v[220:223], v[108:111], v[176:191]
    ds_read_b64_tr_b16 v[208:209], v4 offset:51200
    ds_read_b64_tr_b16 v[210:211], v4 offset:51712
    ds_read_b64_tr_b16 v[212:213], v5 offset:51200
    ds_read_b64_tr_b16 v[214:215], v5 offset:51712
    ds_read_b64_tr_b16 v[216:217], v6 offset:51200
    ds_read_b64_tr_b16 v[218:219], v6 offset:51712
    ds_read_b64_tr_b16 v[220:221], v7 offset:51200
    ds_read_b64_tr_b16 v[222:223], v7 offset:51712
    s_waitcnt lgkmcnt(8)
    v_mfma_f32_32x32x16_bf16 v[128:143], v[192:195], v[112:115], v[128:143]
    v_mfma_f32_32x32x16_bf16 v[144:159], v[196:199], v[112:115], v[144:159]
    v_mfma_f32_32x32x16_bf16 v[160:175], v[200:203], v[112:115], v[160:175]
    v_mfma_f32_32x32x16_bf16 v[176:191], v[204:207], v[112:115], v[176:191]
    ds_read_b64_tr_b16 v[192:193], v4 offset:53248
    ds_read_b64_tr_b16 v[194:195], v4 offset:53760
    ds_read_b64_tr_b16 v[196:197], v5 offset:53248
    ds_read_b64_tr_b16 v[198:199], v5 offset:53760
    ds_read_b64_tr_b16 v[200:201], v6 offset:53248
    ds_read_b64_tr_b16 v[202:203], v6 offset:53760
    ds_read_b64_tr_b16 v[204:205], v7 offset:53248
    ds_read_b64_tr_b16 v[206:207], v7 offset:53760
    s_waitcnt lgkmcnt(8)
    v_mfma_f32_32x32x16_bf16 v[128:143], v[208:211], v[116:119], v[128:143]
    v_mfma_f32_32x32x16_bf16 v[144:159], v[212:215], v[116:119], v[144:159]
    v_mfma_f32_32x32x16_bf16 v[160:175], v[216:219], v[116:119], v[160:175]
    v_mfma_f32_32x32x16_bf16 v[176:191], v[220:223], v[116:119], v[176:191]
    ds_read_b64_tr_b16 v[208:209], v4 offset:55296
    ds_read_b64_tr_b16 v[210:211], v4 offset:55808
    ds_read_b64_tr_b16 v[212:213], v5 offset:55296
    ds_read_b64_tr_b16 v[214:215], v5 offset:55808
    ds_read_b64_tr_b16 v[216:217], v6 offset:55296
    ds_read_b64_tr_b16 v[218:219], v6 offset:55808
    ds_read_b64_tr_b16 v[220:221], v7 offset:55296
    ds_read_b64_tr_b16 v[222:223], v7 offset:55808
    s_waitcnt lgkmcnt(8)
    v_mfma_f32_32x32x16_bf16 v[128:143], v[192:195], v[120:123], v[128:143]
    v_mfma_f32_32x32x16_bf16 v[144:159], v[196:199], v[120:123], v[144:159]
    v_mfma_f32_32x32x16_bf16 v[160:175], v[200:203], v[120:123], v[160:175]
    v_mfma_f32_32x32x16_bf16 v[176:191], v[204:207], v[120:123], v[176:191]
    s_waitcnt lgkmcnt(0)
    v_mfma_f32_32x32x16_bf16 v[128:143], v[208:211], v[124:127], v[128:143]
    v_mfma_f32_32x32x16_bf16 v[144:159], v[212:215], v[124:127], v[144:159]
    v_mfma_f32_32x32x16_bf16 v[160:175], v[216:219], v[124:127], v[160:175]
    v_mfma_f32_32x32x16_bf16 v[176:191], v[220:223], v[124:127], v[176:191]
    s_mov_b32 s61, 0xc0135761
    s_mov_b32 s62, 0xbdd2d3e8
    s_mul_i32 s63, s55, 141
    s_lshl_b32 s64, s53, 2
    s_add_u32 s63, s63, s64
    s_lshl_b32 s63, s63, 10
    s_add_u32 s63, s63, 0
    v_mov_b32 v15, s61
    s_nop 7
    v_mul_f32 v8, v128, v128
    v_mul_f32 v9, v129, v129
    v_mul_f32 v10, v130, v130
    v_mul_f32 v11, v131, v131
    v_fma_f32 v8, v8, s62, v15
    v_fma_f32 v9, v9, s62, v15
    v_fma_f32 v10, v10, s62, v15
    v_fma_f32 v11, v11, s62, v15
    v_mul_f32 v8, v8, v128
    v_mul_f32 v9, v9, v129
    v_mul_f32 v10, v10, v130
    v_mul_f32 v11, v11, v131
    v_exp_f32 v8, v8
    v_exp_f32 v9, v9
    v_exp_f32 v10, v10
    v_exp_f32 v11, v11
    v_mul_f32 v128, v128, v160
    v_mul_f32 v129, v129, v161
    v_mul_f32 v130, v130, v162
    v_mul_f32 v131, v131, v163
    v_add_f32 v8, 1.0, v8
    v_add_f32 v9, 1.0, v9
    v_add_f32 v10, 1.0, v10
    v_add_f32 v11, 1.0, v11
    v_rcp_f32 v8, v8
    v_rcp_f32 v9, v9
    v_rcp_f32 v10, v10
    v_rcp_f32 v11, v11
    s_nop 0
    v_mul_f32 v8, v8, v128
    v_mul_f32 v9, v9, v129
    v_mul_f32 v10, v10, v130
    v_mul_f32 v11, v11, v131
    v_cvt_pk_bf16_f32 v192, v8, v9
    v_cvt_pk_bf16_f32 v193, v10, v11
    v_mul_f32 v8, v132, v132
    v_mul_f32 v9, v133, v133
    v_mul_f32 v10, v134, v134
    v_mul_f32 v11, v135, v135
    v_fma_f32 v8, v8, s62, v15
    v_fma_f32 v9, v9, s62, v15
    v_fma_f32 v10, v10, s62, v15
    v_fma_f32 v11, v11, s62, v15
    v_mul_f32 v8, v8, v132
    v_mul_f32 v9, v9, v133
    v_mul_f32 v10, v10, v134
    v_mul_f32 v11, v11, v135
    v_exp_f32 v8, v8
    v_exp_f32 v9, v9
    v_exp_f32 v10, v10
    v_exp_f32 v11, v11
    v_mul_f32 v132, v132, v164
    v_mul_f32 v133, v133, v165
    v_mul_f32 v134, v134, v166
    v_mul_f32 v135, v135, v167
    v_add_f32 v8, 1.0, v8
    v_add_f32 v9, 1.0, v9
    v_add_f32 v10, 1.0, v10
    v_add_f32 v11, 1.0, v11
    v_rcp_f32 v8, v8
    v_rcp_f32 v9, v9
    v_rcp_f32 v10, v10
    v_rcp_f32 v11, v11
    s_nop 0
    v_mul_f32 v8, v8, v132
    v_mul_f32 v9, v9, v133
    v_mul_f32 v10, v10, v134
    v_mul_f32 v11, v11, v135
    v_cvt_pk_bf16_f32 v194, v8, v9
    v_cvt_pk_bf16_f32 v195, v10, v11
    v_mul_f32 v8, v136, v136
    v_mul_f32 v9, v137, v137
    v_mul_f32 v10, v138, v138
    v_mul_f32 v11, v139, v139
    v_fma_f32 v8, v8, s62, v15
    v_fma_f32 v9, v9, s62, v15
    v_fma_f32 v10, v10, s62, v15
    v_fma_f32 v11, v11, s62, v15
    v_mul_f32 v8, v8, v136
    v_mul_f32 v9, v9, v137
    v_mul_f32 v10, v10, v138
    v_mul_f32 v11, v11, v139
    v_exp_f32 v8, v8
    v_exp_f32 v9, v9
    v_exp_f32 v10, v10
    v_exp_f32 v11, v11
    v_mul_f32 v136, v136, v168
    v_mul_f32 v137, v137, v169
    v_mul_f32 v138, v138, v170
    v_mul_f32 v139, v139, v171
    v_add_f32 v8, 1.0, v8
    v_add_f32 v9, 1.0, v9
    v_add_f32 v10, 1.0, v10
    v_add_f32 v11, 1.0, v11
    v_rcp_f32 v8, v8
    v_rcp_f32 v9, v9
    v_rcp_f32 v10, v10
    v_rcp_f32 v11, v11
    s_nop 0
    v_mul_f32 v8, v8, v136
    v_mul_f32 v9, v9, v137
    v_mul_f32 v10, v10, v138
    v_mul_f32 v11, v11, v139
    v_cvt_pk_bf16_f32 v196, v8, v9
    v_cvt_pk_bf16_f32 v197, v10, v11
    v_mul_f32 v8, v140, v140
    v_mul_f32 v9, v141, v141
    v_mul_f32 v10, v142, v142
    v_mul_f32 v11, v143, v143
    v_fma_f32 v8, v8, s62, v15
    v_fma_f32 v9, v9, s62, v15
    v_fma_f32 v10, v10, s62, v15
    v_fma_f32 v11, v11, s62, v15
    v_mul_f32 v8, v8, v140
    v_mul_f32 v9, v9, v141
    v_mul_f32 v10, v10, v142
    v_mul_f32 v11, v11, v143
    v_exp_f32 v8, v8
    v_exp_f32 v9, v9
    v_exp_f32 v10, v10
    v_exp_f32 v11, v11
    v_mul_f32 v140, v140, v172
    v_mul_f32 v141, v141, v173
    v_mul_f32 v142, v142, v174
    v_mul_f32 v143, v143, v175
    v_add_f32 v8, 1.0, v8
    v_add_f32 v9, 1.0, v9
    v_add_f32 v10, 1.0, v10
    v_add_f32 v11, 1.0, v11
    v_rcp_f32 v8, v8
    v_rcp_f32 v9, v9
    v_rcp_f32 v10, v10
    v_rcp_f32 v11, v11
    s_nop 0
    v_mul_f32 v8, v8, v140
    v_mul_f32 v9, v9, v141
    v_mul_f32 v10, v10, v142
    v_mul_f32 v11, v11, v143
    v_cvt_pk_bf16_f32 v198, v8, v9
    v_cvt_pk_bf16_f32 v199, v10, v11
    buffer_store_dwordx4 v[192:195], v2, s[36:39], s63 offen offset:0 sc1
    buffer_store_dwordx4 v[196:199], v2, s[36:39], s63 offen offset:1024 sc1
    v_mul_f32 v8, v144, v144
    v_mul_f32 v9, v145, v145
    v_mul_f32 v10, v146, v146
    v_mul_f32 v11, v147, v147
    v_fma_f32 v8, v8, s62, v15
    v_fma_f32 v9, v9, s62, v15
    v_fma_f32 v10, v10, s62, v15
    v_fma_f32 v11, v11, s62, v15
    v_mul_f32 v8, v8, v144
    v_mul_f32 v9, v9, v145
    v_mul_f32 v10, v10, v146
    v_mul_f32 v11, v11, v147
    v_exp_f32 v8, v8
    v_exp_f32 v9, v9
    v_exp_f32 v10, v10
    v_exp_f32 v11, v11
    v_mul_f32 v144, v144, v176
    v_mul_f32 v145, v145, v177
    v_mul_f32 v146, v146, v178
    v_mul_f32 v147, v147, v179
    v_add_f32 v8, 1.0, v8
    v_add_f32 v9, 1.0, v9
    v_add_f32 v10, 1.0, v10
    v_add_f32 v11, 1.0, v11
    v_rcp_f32 v8, v8
    v_rcp_f32 v9, v9
    v_rcp_f32 v10, v10
    v_rcp_f32 v11, v11
    s_nop 0
    v_mul_f32 v8, v8, v144
    v_mul_f32 v9, v9, v145
    v_mul_f32 v10, v10, v146
    v_mul_f32 v11, v11, v147
    v_cvt_pk_bf16_f32 v200, v8, v9
    v_cvt_pk_bf16_f32 v201, v10, v11
    v_mul_f32 v8, v148, v148
    v_mul_f32 v9, v149, v149
    v_mul_f32 v10, v150, v150
    v_mul_f32 v11, v151, v151
    v_fma_f32 v8, v8, s62, v15
    v_fma_f32 v9, v9, s62, v15
    v_fma_f32 v10, v10, s62, v15
    v_fma_f32 v11, v11, s62, v15
    v_mul_f32 v8, v8, v148
    v_mul_f32 v9, v9, v149
    v_mul_f32 v10, v10, v150
    v_mul_f32 v11, v11, v151
    v_exp_f32 v8, v8
    v_exp_f32 v9, v9
    v_exp_f32 v10, v10
    v_exp_f32 v11, v11
    v_mul_f32 v148, v148, v180
    v_mul_f32 v149, v149, v181
    v_mul_f32 v150, v150, v182
    v_mul_f32 v151, v151, v183
    v_add_f32 v8, 1.0, v8
    v_add_f32 v9, 1.0, v9
    v_add_f32 v10, 1.0, v10
    v_add_f32 v11, 1.0, v11
    v_rcp_f32 v8, v8
    v_rcp_f32 v9, v9
    v_rcp_f32 v10, v10
    v_rcp_f32 v11, v11
    s_nop 0
    v_mul_f32 v8, v8, v148
    v_mul_f32 v9, v9, v149
    v_mul_f32 v10, v10, v150
    v_mul_f32 v11, v11, v151
    v_cvt_pk_bf16_f32 v202, v8, v9
    v_cvt_pk_bf16_f32 v203, v10, v11
    v_mul_f32 v8, v152, v152
    v_mul_f32 v9, v153, v153
    v_mul_f32 v10, v154, v154
    v_mul_f32 v11, v155, v155
    v_fma_f32 v8, v8, s62, v15
    v_fma_f32 v9, v9, s62, v15
    v_fma_f32 v10, v10, s62, v15
    v_fma_f32 v11, v11, s62, v15
    v_mul_f32 v8, v8, v152
    v_mul_f32 v9, v9, v153
    v_mul_f32 v10, v10, v154
    v_mul_f32 v11, v11, v155
    v_exp_f32 v8, v8
    v_exp_f32 v9, v9
    v_exp_f32 v10, v10
    v_exp_f32 v11, v11
    v_mul_f32 v152, v152, v184
    v_mul_f32 v153, v153, v185
    v_mul_f32 v154, v154, v186
    v_mul_f32 v155, v155, v187
    v_add_f32 v8, 1.0, v8
    v_add_f32 v9, 1.0, v9
    v_add_f32 v10, 1.0, v10
    v_add_f32 v11, 1.0, v11
    v_rcp_f32 v8, v8
    v_rcp_f32 v9, v9
    v_rcp_f32 v10, v10
    v_rcp_f32 v11, v11
    s_nop 0
    v_mul_f32 v8, v8, v152
    v_mul_f32 v9, v9, v153
    v_mul_f32 v10, v10, v154
    v_mul_f32 v11, v11, v155
    v_cvt_pk_bf16_f32 v204, v8, v9
    v_cvt_pk_bf16_f32 v205, v10, v11
    v_mul_f32 v8, v156, v156
    v_mul_f32 v9, v157, v157
    v_mul_f32 v10, v158, v158
    v_mul_f32 v11, v159, v159
    v_fma_f32 v8, v8, s62, v15
    v_fma_f32 v9, v9, s62, v15
    v_fma_f32 v10, v10, s62, v15
    v_fma_f32 v11, v11, s62, v15
    v_mul_f32 v8, v8, v156
    v_mul_f32 v9, v9, v157
    v_mul_f32 v10, v10, v158
    v_mul_f32 v11, v11, v159
    v_exp_f32 v8, v8
    v_exp_f32 v9, v9
    v_exp_f32 v10, v10
    v_exp_f32 v11, v11
    v_mul_f32 v156, v156, v188
    v_mul_f32 v157, v157, v189
    v_mul_f32 v158, v158, v190
    v_mul_f32 v159, v159, v191
    v_add_f32 v8, 1.0, v8
    v_add_f32 v9, 1.0, v9
    v_add_f32 v10, 1.0, v10
    v_add_f32 v11, 1.0, v11
    v_rcp_f32 v8, v8
    v_rcp_f32 v9, v9
    v_rcp_f32 v10, v10
    v_rcp_f32 v11, v11
    s_nop 0
    v_mul_f32 v8, v8, v156
    v_mul_f32 v9, v9, v157
    v_mul_f32 v10, v10, v158
    v_mul_f32 v11, v11, v159
    v_cvt_pk_bf16_f32 v206, v8, v9
    v_cvt_pk_bf16_f32 v207, v10, v11
    buffer_store_dwordx4 v[200:203], v2, s[36:39], s63 offen offset:2048 sc1
    buffer_store_dwordx4 v[204:207], v2, s[36:39], s63 offen offset:3072 sc1
K1_fin:
K1_fin2:
K1_end:
    s_endpgm
.globl k3_kernel
.p2align 8
.type k3_kernel,@function
k3_kernel:
    s_cmp_ge_u32 s2, 224
    s_cbranch_scc1 K3_end
    s_load_dwordx2 s[4:5], s[0:1], 0
    s_load_dwordx2 s[6:7], s[0:1], 56
    s_load_dwordx2 s[8:9], s[0:1], 72
    s_load_dwordx2 s[44:45], s[0:1], 48
    s_getpc_b64 s[10:11]
    s_add_u32 s10, s10, gdftab@rel32@lo+4
    s_addc_u32 s11, s11, gdftab@rel32@hi+12
    v_lshrrev_b32 v1, 6, v0
    s_nop 0
    v_readfirstlane_b32 s30, v1
    v_and_b32 v1, 63, v0
    s_and_b32 s31, s2, 7
    s_lshr_b32 s32, s2, 3
    s_mul_i32 s33, s32, 37
    s_lshr_b32 s33, s33, 8
    s_mul_i32 s34, s33, 7
    s_sub_u32 s34, s32, s34
    s_lshl_b32 s31, s31, 2
    s_add_u32 s33, s33, s31
    s_mul_i32 s40, s30, 33
    s_mul_i32 s41, s40, 14336
    s_lshl_b32 s40, s40, 10
    s_mul_i32 s42, s30, 20480
    s_waitcnt lgkmcnt(0)
    s_mov_b32 s12, s4
    s_and_b32 s13, s5, 0xffff
    s_mov_b32 s14, 1835008
    s_mov_b32 s15, 0x00020000
    s_mov_b32 s16, s6
    s_and_b32 s17, s7, 0xffff
    s_mov_b32 s18, 1835008
    s_mov_b32 s19, 0x00020000
    s_mov_b32 s20, s8
    s_and_b32 s21, s9, 0xffff
    s_mov_b32 s22, 268435456
    s_mov_b32 s23, 0x00020000
    s_mov_b32 s24, s10
    s_and_b32 s25, s11, 0xffff
    s_mov_b32 s26, 415744
    s_mov_b32 s27, 0x00020000
    s_mov_b32 s48, s44
    s_and_b32 s49, s45, 0xffff
    s_mov_b32 s50, 1605632
    s_mov_b32 s51, 0x00020000
    v_lshlrev_b32 v2, 4, v1
    s_mul_i32 s35, s33, 288768
    s_add_u32 s35, s35, 0
    v_add_u32 v5, s35, v2
    v_add_u32 v6, 144384, v5
    v_lshrrev_b32 v9, 5, v1
    s_mul_i32 s35, s34, 59392
    v_add_u32 v7, s35, v2
    v_add_u32 v8, 29696, v7
    v_lshrrev_b32 v3, 3, v1
    v_and_b32 v4, 7, v1
    v_bfe_u32 v11, v3, 1, 1
    v_lshlrev_b32 v11, 2, v11
    v_xor_b32 v4, v4, v11
    s_movk_i32 s35, 896
    v_mul_lo_u32 v3, v3, s35
    v_lshl_add_u32 v3, v4, 4, v3
    s_lshl_b32 s35, s34, 7
    v_add_u32 v3, s35, v3
    v_bfe_u32 v11, v1, 2, 2
    v_lshl_add_u32 v4, v9, 2, v11
    v_lshlrev_b32 v4, 7, v4
    v_bfe_u32 v12, v1, 4, 1
    v_bfe_u32 v13, v1, 1, 1
    v_lshl_add_u32 v12, v12, 1, v13
    v_lshrrev_b32 v13, 1, v11
    v_lshlrev_b32 v13, 2, v13
    v_xor_b32 v12, v12, v13
    v_lshl_add_u32 v4, v12, 4, v4
    v_and_b32 v13, 1, v1
    v_lshl_add_u32 v4, v13, 3, v4
    v_add_u32 v4, s42, v4
    v_xor_b32 v14, 64, v4
    v_lshrrev_b32 v10, 2, v1
    v_lshlrev_b32 v15, 4, v10
    v_lshlrev_b32 v10, 6, v10
    s_lshl_b32 s35, s33, 1
    s_and_b32 s36, s30, 1
    s_add_u32 s35, s35, s36
    v_add_u32 v10, s35, v10
    s_movk_i32 s35, 896
    v_mul_lo_u32 v10, v10, s35
    s_lshl_b32 s35, s34, 7
    s_lshr_b32 s36, s30, 1
    s_lshl_b32 s36, s36, 6
    s_add_u32 s35, s35, s36
    v_add_u32 v10, s35, v10
    v_and_b32 v11, 3, v1
    v_lshl_add_u32 v10, v11, 4, v10
    v_mul_u32_u24 v11, 1088, v11
    v_add_u32 v15, v15, v11
    s_mul_i32 s35, s30, 17408
    s_add_u32 s35, s35, 81920
    v_add_u32 v15, s35, v15
    s_mov_b32 s37, 917504
    s_cmp_eq_u32 s30, 3
    s_cbranch_scc1 K3_m3
    s_add_u32 s43, s42, 0
    s_mov_b32 m0, s43
    buffer_load_dwordx4 v3, s[48:51], s41 offen lds
    s_add_u32 s41, s41, 6144
    buffer_load_dwordx4 v3, s[48:51], s41 offen offset:1024 lds
    s_add_u32 s41, s41, 8192
    buffer_load_dwordx4 v[88:91], v5, s[20:23], s40 offen
    buffer_load_dwordx4 v[92:95], v6, s[20:23], s40 offen
    s_add_u32 s40, s40, 1024
    s_add_u32 s43, s42, 2048
    s_mov_b32 m0, s43
    buffer_load_dwordx4 v3, s[48:51], s41 offen lds
    s_add_u32 s41, s41, 6144
    buffer_load_dwordx4 v3, s[48:51], s41 offen offset:1024 lds
    s_add_u32 s41, s41, 8192
    buffer_load_dwordx4 v[104:107], v5, s[20:23], s40 offen
    buffer_load_dwordx4 v[108:111], v6, s[20:23], s40 offen
    s_add_u32 s40, s40, 1024
    s_add_u32 s43, s42, 4096
    s_mov_b32 m0, s43
    buffer_load_dwordx4 v3, s[48:51], s41 offen lds
    s_add_u32 s41, s41, 6144
    buffer_load_dwordx4 v3, s[48:51], s41 offen offset:1024 lds
    s_add_u32 s41, s41, 8192
    buffer_load_dwordx4 v[120:123], v5, s[20:23], s40 offen
    buffer_load_dwordx4 v[124:127], v6, s[20:23], s40 offen
    s_add_u32 s40, s40, 1024
    s_add_u32 s43, s42, 6144
    s_mov_b32 m0, s43
    buffer_load_dwordx4 v3, s[48:51], s41 offen lds
    s_add_u32 s41, s41, 6144
    buffer_load_dwordx4 v3, s[48:51], s41 offen offset:1024 lds
    s_add_u32 s41, s41, 8192
    buffer_load_dwordx4 v[136:139], v5, s[20:23], s40 offen
    buffer_load_dwordx4 v[140:143], v6, s[20:23], s40 offen
    s_add_u32 s40, s40, 1024
    s_add_u32 s43, s42, 8192
    s_mov_b32 m0, s43
    buffer_load_dwordx4 v3, s[48:51], s41 offen lds
    s_add_u32 s41, s41, 6144
    buffer_load_dwordx4 v3, s[48:51], s41 offen offset:1024 lds
    s_add_u32 s41, s41, 8192
    buffer_load_dwordx4 v[152:155], v5, s[20:23], s40 offen
    buffer_load_dwordx4 v[156:159], v6, s[20:23], s40 offen
    s_add_u32 s40, s40, 1024
    s_add_u32 s43, s42, 10240
    s_mov_b32 m0, s43
    buffer_load_dwordx4 v3, s[48:51], s41 offen lds
    s_add_u32 s41, s41, 6144
    buffer_load_dwordx4 v3, s[48:51], s41 offen offset:1024 lds
    s_add_u32 s41, s41, 8192
    buffer_load_dwordx4 v[168:171], v5, s[20:23], s40 offen
    buffer_load_dwordx4 v[172:175], v6, s[20:23], s40 offen
    s_add_u32 s40, s40, 1024
    s_add_u32 s43, s42, 12288
    s_mov_b32 m0, s43
    buffer_load_dwordx4 v3, s[48:51], s41 offen lds
    s_add_u32 s41, s41, 6144
    buffer_load_dwordx4 v3, s[48:51], s41 offen offset:1024 lds
    s_add_u32 s41, s41, 8192
    buffer_load_dwordx4 v[184:187], v5, s[20:23], s40 offen
    buffer_load_dwordx4 v[188:191], v6, s[20:23], s40 offen
    s_add_u32 s40, s40, 1024
    s_add_u32 s43, s42, 14336
    s_mov_b32 m0, s43
    buffer_load_dwordx4 v3, s[48:51], s41 offen lds
    s_add_u32 s41, s41, 6144
    buffer_load_dwordx4 v3, s[48:51], s41 offen offset:1024 lds
    s_add_u32 s41, s41, 8192
    buffer_load_dwordx4 v[200:203], v5, s[20:23], s40 offen
    buffer_load_dwordx4 v[204:207], v6, s[20:23], s40 offen
    s_add_u32 s40, s40, 1024
    s_add_u32 s43, s42, 16384
    s_mov_b32 m0, s43
    buffer_load_dwordx4 v3, s[48:51], s41 offen lds
    s_add_u32 s41, s41, 6144
    buffer_load_dwordx4 v3, s[48:51], s41 offen offset:1024 lds
    s_add_u32 s41, s41, 8192
    buffer_load_dwordx4 v[216:219], v5, s[20:23], s40 offen
    buffer_load_dwordx4 v[220:223], v6, s[20:23], s40 offen
    s_add_u32 s40, s40, 1024
    s_add_u32 s43, s42, 18432
    s_mov_b32 m0, s43
    buffer_load_dwordx4 v3, s[48:51], s41 offen lds
    s_add_u32 s41, s41, 6144
    buffer_load_dwordx4 v3, s[48:51], s41 offen offset:1024 lds
    s_add_u32 s41, s41, 8192
    buffer_load_dwordx4 v[232:235], v5, s[20:23], s40 offen
    buffer_load_dwordx4 v[236:239], v6, s[20:23], s40 offen
    s_add_u32 s40, s40, 1024
    s_waitcnt vmcnt(36)
    ds_read_b64_tr_b16 v[80:81], v4 offset:0
    ds_read_b64_tr_b16 v[82:83], v4 offset:1024
    ds_read_b64_tr_b16 v[84:85], v14 offset:0
    ds_read_b64_tr_b16 v[86:87], v14 offset:1024
    s_waitcnt vmcnt(32)
    ds_read_b64_tr_b16 v[96:97], v4 offset:2048
    ds_read_b64_tr_b16 v[98:99], v4 offset:3072
    ds_read_b64_tr_b16 v[100:101], v14 offset:2048
    ds_read_b64_tr_b16 v[102:103], v14 offset:3072
    s_waitcnt lgkmcnt(4)
    v_mfma_f32_32x32x16_bf16 v[16:31], v[80:83], v[88:91], 0
    v_mfma_f32_32x32x16_bf16 v[32:47], v[80:83], v[92:95], 0
    v_mfma_f32_32x32x16_bf16 v[48:63], v[84:87], v[88:91], 0
    v_mfma_f32_32x32x16_bf16 v[64:79], v[84:87], v[92:95], 0
    s_add_u32 s43, s42, 0
    s_mov_b32 m0, s43
    buffer_load_dwordx4 v3, s[48:51], s41 offen lds
    s_add_u32 s41, s41, 6144
    buffer_load_dwordx4 v3, s[48:51], s41 offen offset:1024 lds
    s_add_u32 s41, s41, 8192
    buffer_load_dwordx4 v[88:91], v5, s[20:23], s40 offen
    buffer_load_dwordx4 v[92:95], v6, s[20:23], s40 offen
    s_add_u32 s40, s40, 1024
    s_waitcnt vmcnt(32)
    ds_read_b64_tr_b16 v[112:113], v4 offset:4096
    ds_read_b64_tr_b16 v[114:115], v4 offset:5120
    ds_read_b64_tr_b16 v[116:117], v14 offset:4096
    ds_read_b64_tr_b16 v[118:119], v14 offset:5120
    s_waitcnt lgkmcnt(4)
    v_mfma_f32_32x32x16_bf16 v[16:31], v[96:99], v[104:107], v[16:31]
    v_mfma_f32_32x32x16_bf16 v[32:47], v[96:99], v[108:111], v[32:47]
    v_mfma_f32_32x32x16_bf16 v[48:63], v[100:103], v[104:107], v[48:63]
    v_mfma_f32_32x32x16_bf16 v[64:79], v[100:103], v[108:111], v[64:79]
    s_add_u32 s43, s42, 2048
    s_mov_b32 m0, s43
    buffer_load_dwordx4 v3, s[48:51], s41 offen lds
    s_add_u32 s41, s41, 6144
    buffer_load_dwordx4 v3, s[48:51], s41 offen offset:1024 lds
    s_add_u32 s41, s41, 8192
    buffer_load_dwordx4 v[104:107], v5, s[20:23], s40 offen
    buffer_load_dwordx4 v[108:111], v6, s[20:23], s40 offen
    s_add_u32 s40, s40, 1024
    s_waitcnt vmcnt(32)
    ds_read_b64_tr_b16 v[128:129], v4 offset:6144
    ds_read_b64_tr_b16 v[130:131], v4 offset:7168
    ds_read_b64_tr_b16 v[132:133], v14 offset:6144
    ds_read_b64_tr_b16 v[134:135], v14 offset:7168
    s_waitcnt lgkmcnt(4)
    v_mfma_f32_32x32x16_bf16 v[16:31], v[112:115], v[120:123], v[16:31]
    v_mfma_f32_32x32x16_bf16 v[32:47], v[112:115], v[124:127], v[32:47]
    v_mfma_f32_32x32x16_bf16 v[48:63], v[116:119], v[120:123], v[48:63]
    v_mfma_f32_32x32x16_bf16 v[64:79], v[116:119], v[124:127], v[64:79]
    s_add_u32 s43, s42, 4096
    s_mov_b32 m0, s43
    buffer_load_dwordx4 v3, s[48:51], s41 offen lds
    s_add_u32 s41, s41, 6144
    buffer_load_dwordx4 v3, s[48:51], s41 offen offset:1024 lds
    s_add_u32 s41, s41, 8192
    buffer_load_dwordx4 v[120:123], v5, s[20:23], s40 offen
    buffer_load_dwordx4 v[124:127], v6, s[20:23], s40 offen
    s_add_u32 s40, s40, 1024
    s_waitcnt vmcnt(32)
    ds_read_b64_tr_b16 v[144:145], v4 offset:8192
    ds_read_b64_tr_b16 v[146:147], v4 offset:9216
    ds_read_b64_tr_b16 v[148:149], v14 offset:8192
    ds_read_b64_tr_b16 v[150:151], v14 offset:9216
    s_waitcnt lgkmcnt(4)
    v_mfma_f32_32x32x16_bf16 v[16:31], v[128:131], v[136:139], v[16:31]
    v_mfma_f32_32x32x16_bf16 v[32:47], v[128:131], v[140:143], v[32:47]
    v_mfma_f32_32x32x16_bf16 v[48:63], v[132:135], v[136:139], v[48:63]
    v_mfma_f32_32x32x16_bf16 v[64:79], v[132:135], v[140:143], v[64:79]
    s_add_u32 s43, s42, 6144
    s_mov_b32 m0, s43
    buffer_load_dwordx4 v3, s[48:51], s41 offen lds
    s_add_u32 s41, s41, 6144
    buffer_load_dwordx4 v3, s[48:51], s41 offen offset:1024 lds
    s_add_u32 s41, s41, 8192
    buffer_load_dwordx4 v[136:139], v5, s[20:23], s40 offen
    buffer_load_dwordx4 v[140:143], v6, s[20:23], s40 offen
    s_add_u32 s40, s40, 1024
    s_waitcnt vmcnt(32)
    ds_read_b64_tr_b16 v[160:161], v4 offset:10240
    ds_read_b64_tr_b16 v[162:163], v4 offset:11264
    ds_read_b64_tr_b16 v[164:165], v14 offset:10240
    ds_read_b64_tr_b16 v[166:167], v14 offset:11264
    s_waitcnt lgkmcnt(4)
    v_mfma_f32_32x32x16_bf16 v[16:31], v[144:147], v[152:155], v[16:31]
    v_mfma_f32_32x32x16_bf16 v[32:47], v[144:147], v[156:159], v[32:47]
    v_mfma_f32_32x32x16_bf16 v[48:63], v[148:151], v[152:155], v[48:63]
    v_mfma_f32_32x32x16_bf16 v[64:79], v[148:151], v[156:159], v[64:79]
    s_add_u32 s43, s42, 8192
    s_mov_b32 m0, s43
    buffer_load_dwordx4 v3, s[48:51], s41 offen lds
    s_add_u32 s41, s41, 6144
    buffer_load_dwordx4 v3, s[48:51], s41 offen offset:1024 lds
    s_add_u32 s41, s41, 8192
    buffer_load_dwordx4 v[152:155], v5, s[20:23], s40 offen
    buffer_load_dwordx4 v[156:159], v6, s[20:23], s40 offen
    s_add_u32 s40, s40, 1024
    s_waitcnt vmcnt(32)
    ds_read_b64_tr_b16 v[176:177], v4 offset:12288
    ds_read_b64_tr_b16 v[178:179], v4 offset:13312
    ds_read_b64_tr_b16 v[180:181], v14 offset:12288
    ds_read_b64_tr_b16 v[182:183], v14 offset:13312
    s_waitcnt lgkmcnt(4)
    v_mfma_f32_32x32x16_bf16 v[16:31], v[160:163], v[168:171], v[16:31]
    v_mfma_f32_32x32x16_bf16 v[32:47], v[160:163], v[172:175], v[32:47]
    v_mfma_f32_32x32x16_bf16 v[48:63], v[164:167], v[168:171], v[48:63]
    v_mfma_f32_32x32x16_bf16 v[64:79], v[164:167], v[172:175], v[64:79]
    s_add_u32 s43, s42, 10240
    s_mov_b32 m0, s43
    buffer_load_dwordx4 v3, s[48:51], s41 offen lds
    s_add_u32 s41, s41, 6144
    buffer_load_dwordx4 v3, s[48:51], s41 offen offset:1024 lds
    s_add_u32 s41, s41, 8192
    buffer_load_dwordx4 v[168:171], v5, s[20:23], s40 offen
    buffer_load_dwordx4 v[172:175], v6, s[20:23], s40 offen
    s_add_u32 s40, s40, 1024
    s_waitcnt vmcnt(32)
    ds_read_b64_tr_b16 v[192:193], v4 offset:14336
    ds_read_b64_tr_b16 v[194:195], v4 offset:15360
    ds_read_b64_tr_b16 v[196:197], v14 offset:14336
    ds_read_b64_tr_b16 v[198:199], v14 offset:15360
    s_waitcnt lgkmcnt(4)
    v_mfma_f32_32x32x16_bf16 v[16:31], v[176:179], v[184:187], v[16:31]
    v_mfma_f32_32x32x16_bf16 v[32:47], v[176:179], v[188:191], v[32:47]
    v_mfma_f32_32x32x16_bf16 v[48:63], v[180:183], v[184:187], v[48:63]
    v_mfma_f32_32x32x16_bf16 v[64:79], v[180:183], v[188:191], v[64:79]
    s_add_u32 s43, s42, 12288
    s_mov_b32 m0, s43
    buffer_load_dwordx4 v3, s[48:51], s41 offen lds
    s_add_u32 s41, s41, 6144
    buffer_load_dwordx4 v3, s[48:51], s41 offen offset:1024 lds
    s_add_u32 s41, s41, 8192
    buffer_load_dwordx4 v[184:187], v5, s[20:23], s40 offen
    buffer_load_dwordx4 v[188:191], v6, s[20:23], s40 offen
    s_add_u32 s40, s40, 1024
    s_waitcnt vmcnt(32)
    ds_read_b64_tr_b16 v[208:209], v4 offset:16384
    ds_read_b64_tr_b16 v[210:211], v4 offset:17408
    ds_read_b64_tr_b16 v[212:213], v14 offset:16384
    ds_read_b64_tr_b16 v[214:215], v14 offset:17408
    s_waitcnt lgkmcnt(4)
    v_mfma_f32_32x32x16_bf16 v[16:31], v[192:195], v[200:203], v[16:31]
    v_mfma_f32_32x32x16_bf16 v[32:47], v[192:195], v[204:207], v[32:47]
    v_mfma_f32_32x32x16_bf16 v[48:63], v[196:199], v[200:203], v[48:63]
    v_mfma_f32_32x32x16_bf16 v[64:79], v[196:199], v[204:207], v[64:79]
    s_add_u32 s43, s42, 14336
    s_mov_b32 m0, s43
    buffer_load_dwordx4 v3, s[48:51], s41 offen lds
    s_add_u32 s41, s41, 6144
    buffer_load_dwordx4 v3, s[48:51], s41 offen offset:1024 lds
    s_add_u32 s41, s41, 8192
    buffer_load_dwordx4 v[200:203], v5, s[20:23], s40 offen
    buffer_load_dwordx4 v[204:207], v6, s[20:23], s40 offen
    s_add_u32 s40, s40, 1024
    s_waitcnt vmcnt(32)
    ds_read_b64_tr_b16 v[224:225], v4 offset:18432
    ds_read_b64_tr_b16 v[226:227], v4 offset:19456
    ds_read_b64_tr_b16 v[228:229], v14 offset:18432
    ds_read_b64_tr_b16 v[230:231], v14 offset:19456
    s_waitcnt lgkmcnt(4)
    v_mfma_f32_32x32x16_bf16 v[16:31], v[208:211], v[216:219], v[16:31]
    v_mfma_f32_32x32x16_bf16 v[32:47], v[208:211], v[220:223], v[32:47]
    v_mfma_f32_32x32x16_bf16 v[48:63], v[212:215], v[216:219], v[48:63]
    v_mfma_f32_32x32x16_bf16 v[64:79], v[212:215], v[220:223], v[64:79]
    s_add_u32 s43, s42, 16384
    s_mov_b32 m0, s43
    buffer_load_dwordx4 v3, s[48:51], s41 offen lds
    s_add_u32 s41, s41, 6144
    buffer_load_dwordx4 v3, s[48:51], s41 offen offset:1024 lds
    s_add_u32 s41, s41, 8192
    buffer_load_dwordx4 v[216:219], v5, s[20:23], s40 offen
    buffer_load_dwordx4 v[220:223], v6, s[20:23], s40 offen
    s_add_u32 s40, s40, 1024
    s_waitcnt vmcnt(32)
    ds_read_b64_tr_b16 v[80:81], v4 offset:0
    ds_read_b64_tr_b16 v[82:83], v4 offset:1024
    ds_read_b64_tr_b16 v[84:85], v14 offset:0
    ds_read_b64_tr_b16 v[86:87], v14 offset:1024
    s_waitcnt lgkmcnt(4)
    v_mfma_f32_32x32x16_bf16 v[16:31], v[224:227], v[232:235], v[16:31]
    v_mfma_f32_32x32x16_bf16 v[32:47], v[224:227], v[236:239], v[32:47]
    v_mfma_f32_32x32x16_bf16 v[48:63], v[228:231], v[232:235], v[48:63]
    v_mfma_f32_32x32x16_bf16 v[64:79], v[228:231], v[236:239], v[64:79]
    s_add_u32 s43, s42, 18432
    s_mov_b32 m0, s43
    buffer_load_dwordx4 v3, s[48:51], s41 offen lds
    s_add_u32 s41, s41, 6144
    buffer_load_dwordx4 v3, s[48:51], s41 offen offset:1024 lds
    s_add_u32 s41, s41, 8192
    buffer_load_dwordx4 v[232:235], v5, s[20:23], s40 offen
    buffer_load_dwordx4 v[236:239], v6, s[20:23], s40 offen
    s_add_u32 s40, s40, 1024
    s_waitcnt vmcnt(32)
    ds_read_b64_tr_b16 v[96:97], v4 offset:2048
    ds_read_b64_tr_b16 v[98:99], v4 offset:3072
    ds_read_b64_tr_b16 v[100:101], v14 offset:2048
    ds_read_b64_tr_b16 v[102:103], v14 offset:3072
    s_waitcnt lgkmcnt(4)
    v_mfma_f32_32x32x16_bf16 v[16:31], v[80:83], v[88:91], v[16:31]
    v_mfma_f32_32x32x16_bf16 v[32:47], v[80:83], v[92:95], v[32:47]
    v_mfma_f32_32x32x16_bf16 v[48:63], v[84:87], v[88:91], v[48:63]
    v_mfma_f32_32x32x16_bf16 v[64:79], v[84:87], v[92:95], v[64:79]
    s_add_u32 s43, s42, 0
    s_mov_b32 m0, s43
    buffer_load_dwordx4 v3, s[48:51], s41 offen lds
    s_add_u32 s41, s41, 6144
    buffer_load_dwordx4 v3, s[48:51], s41 offen offset:1024 lds
    s_add_u32 s41, s41, 8192
    buffer_load_dwordx4 v[88:91], v5, s[20:23], s40 offen
    buffer_load_dwordx4 v[92:95], v6, s[20:23], s40 offen
    s_add_u32 s40, s40, 1024
    s_waitcnt vmcnt(32)
    ds_read_b64_tr_b16 v[112:113], v4 offset:4096
    ds_read_b64_tr_b16 v[114:115], v4 offset:5120
    ds_read_b64_tr_b16 v[116:117], v14 offset:4096
    ds_read_b64_tr_b16 v[118:119], v14 offset:5120
    s_waitcnt lgkmcnt(4)
    v_mfma_f32_32x32x16_bf16 v[16:31], v[96:99], v[104:107], v[16:31]
    v_mfma_f32_32x32x16_bf16 v[32:47], v[96:99], v[108:111], v[32:47]
    v_mfma_f32_32x32x16_bf16 v[48:63], v[100:103], v[104:107], v[48:63]
    v_mfma_f32_32x32x16_bf16 v[64:79], v[100:103], v[108:111], v[64:79]
    s_add_u32 s43, s42, 2048
    s_mov_b32 m0, s43
    buffer_load_dwordx4 v3, s[48:51], s41 offen lds
    s_add_u32 s41, s41, 6144
    buffer_load_dwordx4 v3, s[48:51], s41 offen offset:1024 lds
    s_add_u32 s41, s41, 8192
    buffer_load_dwordx4 v[104:107], v5, s[20:23], s40 offen
    buffer_load_dwordx4 v[108:111], v6, s[20:23], s40 offen
    s_add_u32 s40, s40, 1024
    s_waitcnt vmcnt(32)
    ds_read_b64_tr_b16 v[128:129], v4 offset:6144
    ds_read_b64_tr_b16 v[130:131], v4 offset:7168
    ds_read_b64_tr_b16 v[132:133], v14 offset:6144
    ds_read_b64_tr_b16 v[134:135], v14 offset:7168
    s_waitcnt lgkmcnt(4)
    v_mfma_f32_32x32x16_bf16 v[16:31], v[112:115], v[120:123], v[16:31]
    v_mfma_f32_32x32x16_bf16 v[32:47], v[112:115], v[124:127], v[32:47]
    v_mfma_f32_32x32x16_bf16 v[48:63], v[116:119], v[120:123], v[48:63]
    v_mfma_f32_32x32x16_bf16 v[64:79], v[116:119], v[124:127], v[64:79]
    s_add_u32 s43, s42, 4096
    s_mov_b32 m0, s43
    buffer_load_dwordx4 v3, s[48:51], s41 offen lds
    s_add_u32 s41, s41, 6144
    buffer_load_dwordx4 v3, s[48:51], s41 offen offset:1024 lds
    s_add_u32 s41, s41, 8192
    buffer_load_dwordx4 v[120:123], v5, s[20:23], s40 offen
    buffer_load_dwordx4 v[124:127], v6, s[20:23], s40 offen
    s_add_u32 s40, s40, 1024
    s_waitcnt vmcnt(32)
    ds_read_b64_tr_b16 v[144:145], v4 offset:8192
    ds_read_b64_tr_b16 v[146:147], v4 offset:9216
    ds_read_b64_tr_b16 v[148:149], v14 offset:8192
    ds_read_b64_tr_b16 v[150:151], v14 offset:9216
    s_waitcnt lgkmcnt(4)
    v_mfma_f32_32x32x16_bf16 v[16:31], v[128:131], v[136:139], v[16:31]
    v_mfma_f32_32x32x16_bf16 v[32:47], v[128:131], v[140:143], v[32:47]
    v_mfma_f32_32x32x16_bf16 v[48:63], v[132:135], v[136:139], v[48:63]
    v_mfma_f32_32x32x16_bf16 v[64:79], v[132:135], v[140:143], v[64:79]
    s_add_u32 s43, s42, 6144
    s_mov_b32 m0, s43
    buffer_load_dwordx4 v3, s[48:51], s41 offen lds
    s_add_u32 s41, s41, 6144
    buffer_load_dwordx4 v3, s[48:51], s41 offen offset:1024 lds
    s_add_u32 s41, s41, 8192
    buffer_load_dwordx4 v[136:139], v5, s[20:23], s40 offen
    buffer_load_dwordx4 v[140:143], v6, s[20:23], s40 offen
    s_add_u32 s40, s40, 1024
    s_waitcnt vmcnt(32)
    ds_read_b64_tr_b16 v[160:161], v4 offset:10240
    ds_read_b64_tr_b16 v[162:163], v4 offset:11264
    ds_read_b64_tr_b16 v[164:165], v14 offset:10240
    ds_read_b64_tr_b16 v[166:167], v14 offset:11264
    s_waitcnt lgkmcnt(4)
    v_mfma_f32_32x32x16_bf16 v[16:31], v[144:147], v[152:155], v[16:31]
    v_mfma_f32_32x32x16_bf16 v[32:47], v[144:147], v[156:159], v[32:47]
    v_mfma_f32_32x32x16_bf16 v[48:63], v[148:151], v[152:155], v[48:63]
    v_mfma_f32_32x32x16_bf16 v[64:79], v[148:151], v[156:159], v[64:79]
    s_add_u32 s43, s42, 8192
    s_mov_b32 m0, s43
    buffer_load_dwordx4 v3, s[48:51], s41 offen lds
    s_add_u32 s41, s41, 6144
    buffer_load_dwordx4 v3, s[48:51], s41 offen offset:1024 lds
    s_add_u32 s41, s41, 8192
    buffer_load_dwordx4 v[152:155], v5, s[20:23], s40 offen
    buffer_load_dwordx4 v[156:159], v6, s[20:23], s40 offen
    s_add_u32 s40, s40, 1024
    s_waitcnt vmcnt(32)
    ds_read_b64_tr_b16 v[176:177], v4 offset:12288
    ds_read_b64_tr_b16 v[178:179], v4 offset:13312
    ds_read_b64_tr_b16 v[180:181], v14 offset:12288
    ds_read_b64_tr_b16 v[182:183], v14 offset:13312
    s_waitcnt lgkmcnt(4)
    v_mfma_f32_32x32x16_bf16 v[16:31], v[160:163], v[168:171], v[16:31]
    v_mfma_f32_32x32x16_bf16 v[32:47], v[160:163], v[172:175], v[32:47]
    v_mfma_f32_32x32x16_bf16 v[48:63], v[164:167], v[168:171], v[48:63]
    v_mfma_f32_32x32x16_bf16 v[64:79], v[164:167], v[172:175], v[64:79]
    s_add_u32 s43, s42, 10240
    s_mov_b32 m0, s43
    buffer_load_dwordx4 v3, s[48:51], s41 offen lds
    s_add_u32 s41, s41, 6144
    buffer_load_dwordx4 v3, s[48:51], s41 offen offset:1024 lds
    s_add_u32 s41, s41, 8192
    buffer_load_dwordx4 v[168:171], v5, s[20:23], s40 offen
    buffer_load_dwordx4 v[172:175], v6, s[20:23], s40 offen
    s_add_u32 s40, s40, 1024
    s_waitcnt vmcnt(32)
    ds_read_b64_tr_b16 v[192:193], v4 offset:14336
    ds_read_b64_tr_b16 v[194:195], v4 offset:15360
    ds_read_b64_tr_b16 v[196:197], v14 offset:14336
    ds_read_b64_tr_b16 v[198:199], v14 offset:15360
    s_waitcnt lgkmcnt(4)
    v_mfma_f32_32x32x16_bf16 v[16:31], v[176:179], v[184:187], v[16:31]
    v_mfma_f32_32x32x16_bf16 v[32:47], v[176:179], v[188:191], v[32:47]
    v_mfma_f32_32x32x16_bf16 v[48:63], v[180:183], v[184:187], v[48:63]
    v_mfma_f32_32x32x16_bf16 v[64:79], v[180:183], v[188:191], v[64:79]
    s_add_u32 s43, s42, 12288
    s_mov_b32 m0, s43
    buffer_load_dwordx4 v3, s[48:51], s41 offen lds
    s_add_u32 s41, s41, 6144
    buffer_load_dwordx4 v3, s[48:51], s41 offen offset:1024 lds
    s_add_u32 s41, s41, 8192
    buffer_load_dwordx4 v[184:187], v5, s[20:23], s40 offen
    buffer_load_dwordx4 v[188:191], v6, s[20:23], s40 offen
    s_add_u32 s40, s40, 1024
    s_waitcnt vmcnt(32)
    ds_read_b64_tr_b16 v[208:209], v4 offset:16384
    ds_read_b64_tr_b16 v[210:211], v4 offset:17408
    ds_read_b64_tr_b16 v[212:213], v14 offset:16384
    ds_read_b64_tr_b16 v[214:215], v14 offset:17408
    s_waitcnt lgkmcnt(4)
    v_mfma_f32_32x32x16_bf16 v[16:31], v[192:195], v[200:203], v[16:31]
    v_mfma_f32_32x32x16_bf16 v[32:47], v[192:195], v[204:207], v[32:47]
    v_mfma_f32_32x32x16_bf16 v[48:63], v[196:199], v[200:203], v[48:63]
    v_mfma_f32_32x32x16_bf16 v[64:79], v[196:199], v[204:207], v[64:79]
    s_add_u32 s43, s42, 14336
    s_mov_b32 m0, s43
    buffer_load_dwordx4 v3, s[48:51], s41 offen lds
    s_add_u32 s41, s41, 6144
    buffer_load_dwordx4 v3, s[48:51], s41 offen offset:1024 lds
    s_add_u32 s41, s41, 8192
    buffer_load_dwordx4 v[200:203], v5, s[20:23], s40 offen
    buffer_load_dwordx4 v[204:207], v6, s[20:23], s40 offen
    s_add_u32 s40, s40, 1024
    s_waitcnt vmcnt(32)
    ds_read_b64_tr_b16 v[224:225], v4 offset:18432
    ds_read_b64_tr_b16 v[226:227], v4 offset:19456
    ds_read_b64_tr_b16 v[228:229], v14 offset:18432
    ds_read_b64_tr_b16 v[230:231], v14 offset:19456
    s_waitcnt lgkmcnt(4)
    v_mfma_f32_32x32x16_bf16 v[16:31], v[208:211], v[216:219], v[16:31]
    v_mfma_f32_32x32x16_bf16 v[32:47], v[208:211], v[220:223], v[32:47]
    v_mfma_f32_32x32x16_bf16 v[48:63], v[212:215], v[216:219], v[48:63]
    v_mfma_f32_32x32x16_bf16 v[64:79], v[212:215], v[220:223], v[64:79]
    s_add_u32 s43, s42, 16384
    s_mov_b32 m0, s43
    buffer_load_dwordx4 v3, s[48:51], s41 offen lds
    s_add_u32 s41, s41, 6144
    buffer_load_dwordx4 v3, s[48:51], s41 offen offset:1024 lds
    s_add_u32 s41, s41, 8192
    buffer_load_dwordx4 v[216:219], v5, s[20:23], s40 offen
    buffer_load_dwordx4 v[220:223], v6, s[20:23], s40 offen
    s_add_u32 s40, s40, 1024
    s_waitcnt vmcnt(32)
    ds_read_b64_tr_b16 v[80:81], v4 offset:0
    ds_read_b64_tr_b16 v[82:83], v4 offset:1024
    ds_read_b64_tr_b16 v[84:85], v14 offset:0
    ds_read_b64_tr_b16 v[86:87], v14 offset:1024
    s_waitcnt lgkmcnt(4)
    v_mfma_f32_32x32x16_bf16 v[16:31], v[224:227], v[232:235], v[16:31]
    v_mfma_f32_32x32x16_bf16 v[32:47], v[224:227], v[236:239], v[32:47]
    v_mfma_f32_32x32x16_bf16 v[48:63], v[228:231], v[232:235], v[48:63]
    v_mfma_f32_32x32x16_bf16 v[64:79], v[228:231], v[236:239], v[64:79]
    s_add_u32 s43, s42, 18432
    s_mov_b32 m0, s43
    buffer_load_dwordx4 v3, s[48:51], s41 offen lds
    s_add_u32 s41, s41, 6144
    buffer_load_dwordx4 v3, s[48:51], s41 offen offset:1024 lds
    s_add_u32 s41, s41, 8192
    buffer_load_dwordx4 v[232:235], v5, s[20:23], s40 offen
    buffer_load_dwordx4 v[236:239], v6, s[20:23], s40 offen
    s_add_u32 s40, s40, 1024
    s_waitcnt vmcnt(32)
    ds_read_b64_tr_b16 v[96:97], v4 offset:2048
    ds_read_b64_tr_b16 v[98:99], v4 offset:3072
    ds_read_b64_tr_b16 v[100:101], v14 offset:2048
    ds_read_b64_tr_b16 v[102:103], v14 offset:3072
    s_waitcnt lgkmcnt(4)
    v_mfma_f32_32x32x16_bf16 v[16:31], v[80:83], v[88:91], v[16:31]
    v_mfma_f32_32x32x16_bf16 v[32:47], v[80:83], v[92:95], v[32:47]
    v_mfma_f32_32x32x16_bf16 v[48:63], v[84:87], v[88:91], v[48:63]
    v_mfma_f32_32x32x16_bf16 v[64:79], v[84:87], v[92:95], v[64:79]
    s_add_u32 s43, s42, 0
    s_mov_b32 m0, s43
    buffer_load_dwordx4 v3, s[48:51], s41 offen lds
    s_add_u32 s41, s41, 6144
    buffer_load_dwordx4 v3, s[48:51], s41 offen offset:1024 lds
    s_add_u32 s41, s41, 8192
    buffer_load_dwordx4 v[88:91], v5, s[20:23], s40 offen
    buffer_load_dwordx4 v[92:95], v6, s[20:23], s40 offen
    s_add_u32 s40, s40, 1024
    s_waitcnt vmcnt(32)
    ds_read_b64_tr_b16 v[112:113], v4 offset:4096
    ds_read_b64_tr_b16 v[114:115], v4 offset:5120
    ds_read_b64_tr_b16 v[116:117], v14 offset:4096
    ds_read_b64_tr_b16 v[118:119], v14 offset:5120
    s_waitcnt lgkmcnt(4)
    v_mfma_f32_32x32x16_bf16 v[16:31], v[96:99], v[104:107], v[16:31]
    v_mfma_f32_32x32x16_bf16 v[32:47], v[96:99], v[108:111], v[32:47]
    v_mfma_f32_32x32x16_bf16 v[48:63], v[100:103], v[104:107], v[48:63]
    v_mfma_f32_32x32x16_bf16 v[64:79], v[100:103], v[108:111], v[64:79]
    s_add_u32 s43, s42, 2048
    s_mov_b32 m0, s43
    buffer_load_dwordx4 v3, s[48:51], s41 offen lds
    s_add_u32 s41, s41, 6144
    buffer_load_dwordx4 v3, s[48:51], s41 offen offset:1024 lds
    s_add_u32 s41, s41, 8192
    buffer_load_dwordx4 v[104:107], v5, s[20:23], s40 offen
    buffer_load_dwordx4 v[108:111], v6, s[20:23], s40 offen
    s_add_u32 s40, s40, 1024
    s_waitcnt vmcnt(32)
    ds_read_b64_tr_b16 v[128:129], v4 offset:6144
    ds_read_b64_tr_b16 v[130:131], v4 offset:7168
    ds_read_b64_tr_b16 v[132:133], v14 offset:6144
    ds_read_b64_tr_b16 v[134:135], v14 offset:7168
    s_waitcnt lgkmcnt(4)
    v_mfma_f32_32x32x16_bf16 v[16:31], v[112:115], v[120:123], v[16:31]
    v_mfma_f32_32x32x16_bf16 v[32:47], v[112:115], v[124:127], v[32:47]
    v_mfma_f32_32x32x16_bf16 v[48:63], v[116:119], v[120:123], v[48:63]
    v_mfma_f32_32x32x16_bf16 v[64:79], v[116:119], v[124:127], v[64:79]
    s_add_u32 s43, s42, 4096
    s_mov_b32 m0, s43
    buffer_load_dwordx4 v3, s[48:51], s41 offen lds
    s_add_u32 s41, s41, 6144
    buffer_load_dwordx4 v3, s[48:51], s41 offen offset:1024 lds
    s_add_u32 s41, s41, 8192
    buffer_load_dwordx4 v[120:123], v5, s[20:23], s40 offen
    buffer_load_dwordx4 v[124:127], v6, s[20:23], s40 offen
    s_add_u32 s40, s40, 1024
    s_waitcnt vmcnt(32)
    ds_read_b64_tr_b16 v[144:145], v4 offset:8192
    ds_read_b64_tr_b16 v[146:147], v4 offset:9216
    ds_read_b64_tr_b16 v[148:149], v14 offset:8192
    ds_read_b64_tr_b16 v[150:151], v14 offset:9216
    s_waitcnt lgkmcnt(4)
    v_mfma_f32_32x32x16_bf16 v[16:31], v[128:131], v[136:139], v[16:31]
    v_mfma_f32_32x32x16_bf16 v[32:47], v[128:131], v[140:143], v[32:47]
    v_mfma_f32_32x32x16_bf16 v[48:63], v[132:135], v[136:139], v[48:63]
    v_mfma_f32_32x32x16_bf16 v[64:79], v[132:135], v[140:143], v[64:79]
    buffer_load_dwordx4 v[248:251], v10, s[12:15], 0 offen
    buffer_load_dwordx4 v[252:255], v10, s[12:15], s37 offen
    s_waitcnt vmcnt(30)
    ds_read_b64_tr_b16 v[160:161], v4 offset:10240
    ds_read_b64_tr_b16 v[162:163], v4 offset:11264
    ds_read_b64_tr_b16 v[164:165], v14 offset:10240
    ds_read_b64_tr_b16 v[166:167], v14 offset:11264
    s_waitcnt lgkmcnt(4)
    v_mfma_f32_32x32x16_bf16 v[16:31], v[144:147], v[152:155], v[16:31]
    v_mfma_f32_32x32x16_bf16 v[32:47], v[144:147], v[156:159], v[32:47]
    v_mfma_f32_32x32x16_bf16 v[48:63], v[148:151], v[152:155], v[48:63]
    v_mfma_f32_32x32x16_bf16 v[64:79], v[148:151], v[156:159], v[64:79]
    s_waitcnt vmcnt(26)
    ds_read_b64_tr_b16 v[176:177], v4 offset:12288
    ds_read_b64_tr_b16 v[178:179], v4 offset:13312
    ds_read_b64_tr_b16 v[180:181], v14 offset:12288
    ds_read_b64_tr_b16 v[182:183], v14 offset:13312
    s_waitcnt lgkmcnt(4)
    v_mfma_f32_32x32x16_bf16 v[16:31], v[160:163], v[168:171], v[16:31]
    v_mfma_f32_32x32x16_bf16 v[32:47], v[160:163], v[172:175], v[32:47]
    v_mfma_f32_32x32x16_bf16 v[48:63], v[164:167], v[168:171], v[48:63]
    v_mfma_f32_32x32x16_bf16 v[64:79], v[164:167], v[172:175], v[64:79]
    s_waitcnt vmcnt(22)
    ds_read_b64_tr_b16 v[192:193], v4 offset:14336
    ds_read_b64_tr_b16 v[194:195], v4 offset:15360
    ds_read_b64_tr_b16 v[196:197], v14 offset:14336
    ds_read_b64_tr_b16 v[198:199], v14 offset:15360
    s_waitcnt lgkmcnt(4)
    v_mfma_f32_32x32x16_bf16 v[16:31], v[176:179], v[184:187], v[16:31]
    v_mfma_f32_32x32x16_bf16 v[32:47], v[176:179], v[188:191], v[32:47]
    v_mfma_f32_32x32x16_bf16 v[48:63], v[180:183], v[184:187], v[48:63]
    v_mfma_f32_32x32x16_bf16 v[64:79], v[180:183], v[188:191], v[64:79]
    s_waitcnt vmcnt(18)
    ds_read_b64_tr_b16 v[208:209], v4 offset:16384
    ds_read_b64_tr_b16 v[210:211], v4 offset:17408
    ds_read_b64_tr_b16 v[212:213], v14 offset:16384
    ds_read_b64_tr_b16 v[214:215], v14 offset:17408
    s_waitcnt lgkmcnt(4)
    v_mfma_f32_32x32x16_bf16 v[16:31], v[192:195], v[200:203], v[16:31]
    v_mfma_f32_32x32x16_bf16 v[32:47], v[192:195], v[204:207], v[32:47]
    v_mfma_f32_32x32x16_bf16 v[48:63], v[196:199], v[200:203], v[48:63]
    v_mfma_f32_32x32x16_bf16 v[64:79], v[196:199], v[204:207], v[64:79]
    s_waitcnt vmcnt(14)
    ds_read_b64_tr_b16 v[224:225], v4 offset:18432
    ds_read_b64_tr_b16 v[226:227], v4 offset:19456
    ds_read_b64_tr_b16 v[228:229], v14 offset:18432
    ds_read_b64_tr_b16 v[230:231], v14 offset:19456
    s_waitcnt lgkmcnt(4)
    v_mfma_f32_32x32x16_bf16 v[16:31], v[208:211], v[216:219], v[16:31]
    v_mfma_f32_32x32x16_bf16 v[32:47], v[208:211], v[220:223], v[32:47]
    v_mfma_f32_32x32x16_bf16 v[48:63], v[212:215], v[216:219], v[48:63]
    v_mfma_f32_32x32x16_bf16 v[64:79], v[212:215], v[220:223], v[64:79]
    s_waitcnt vmcnt(10)
    ds_read_b64_tr_b16 v[80:81], v4 offset:0
    ds_read_b64_tr_b16 v[82:83], v4 offset:1024
    ds_read_b64_tr_b16 v[84:85], v14 offset:0
    ds_read_b64_tr_b16 v[86:87], v14 offset:1024
    s_waitcnt lgkmcnt(4)
    v_mfma_f32_32x32x16_bf16 v[16:31], v[224:227], v[232:235], v[16:31]
    v_mfma_f32_32x32x16_bf16 v[32:47], v[224:227], v[236:239], v[32:47]
    v_mfma_f32_32x32x16_bf16 v[48:63], v[228:231], v[232:235], v[48:63]
    v_mfma_f32_32x32x16_bf16 v[64:79], v[228:231], v[236:239], v[64:79]
    s_waitcnt vmcnt(6)
    ds_read_b64_tr_b16 v[96:97], v4 offset:2048
    ds_read_b64_tr_b16 v[98:99], v4 offset:3072
    ds_read_b64_tr_b16 v[100:101], v14 offset:2048
    ds_read_b64_tr_b16 v[102:103], v14 offset:3072
    s_waitcnt lgkmcnt(4)
    v_mfma_f32_32x32x16_bf16 v[16:31], v[80:83], v[88:91], v[16:31]
    v_mfma_f32_32x32x16_bf16 v[32:47], v[80:83], v[92:95], v[32:47]
    v_mfma_f32_32x32x16_bf16 v[48:63], v[84:87], v[88:91], v[48:63]
    v_mfma_f32_32x32x16_bf16 v[64:79], v[84:87], v[92:95], v[64:79]
    s_waitcnt vmcnt(2)
    ds_read_b64_tr_b16 v[112:113], v4 offset:4096
    ds_read_b64_tr_b16 v[114:115], v4 offset:5120
    ds_read_b64_tr_b16 v[116:117], v14 offset:4096
    ds_read_b64_tr_b16 v[118:119], v14 offset:5120
    s_waitcnt lgkmcnt(4)
    v_mfma_f32_32x32x16_bf16 v[16:31], v[96:99], v[104:107], v[16:31]
    v_mfma_f32_32x32x16_bf16 v[32:47], v[96:99], v[108:111], v[32:47]
    v_mfma_f32_32x32x16_bf16 v[48:63], v[100:103], v[104:107], v[48:63]
    v_mfma_f32_32x32x16_bf16 v[64:79], v[100:103], v[108:111], v[64:79]
    s_waitcnt lgkmcnt(0)
    v_mfma_f32_32x32x16_bf16 v[16:31], v[112:115], v[120:123], v[16:31]
    v_mfma_f32_32x32x16_bf16 v[32:47], v[112:115], v[124:127], v[32:47]
    v_mfma_f32_32x32x16_bf16 v[48:63], v[116:119], v[120:123], v[48:63]
    v_mfma_f32_32x32x16_bf16 v[64:79], v[116:119], v[124:127], v[64:79]
    s_branch K3_red
K3_m3:
    s_add_u32 s43, s42, 0
    s_mov_b32 m0, s43
    buffer_load_dwordx4 v3, s[48:51], s41 offen lds
    s_add_u32 s41, s41, 6144
    buffer_load_dwordx4 v3, s[48:51], s41 offen offset:1024 lds
    s_add_u32 s41, s41, 8192
    buffer_load_dwordx4 v[88:91], v5, s[20:23], s40 offen
    buffer_load_dwordx4 v[92:95], v6, s[20:23], s40 offen
    s_add_u32 s40, s40, 1024
    s_add_u32 s43, s42, 2048
    s_mov_b32 m0, s43
    buffer_load_dwordx4 v3, s[48:51], s41 offen lds
    s_add_u32 s41, s41, 6144
    buffer_load_dwordx4 v3, s[48:51], s41 offen offset:1024 lds
    s_add_u32 s41, s41, 8192
    buffer_load_dwordx4 v[104:107], v5, s[20:23], s40 offen
    buffer_load_dwordx4 v[108:111], v6, s[20:23], s40 offen
    s_add_u32 s40, s40, 1024
    s_add_u32 s43, s42, 4096
    s_mov_b32 m0, s43
    buffer_load_dwordx4 v3, s[48:51], s41 offen lds
    s_add_u32 s41, s41, 6144
    buffer_load_dwordx4 v3, s[48:51], s41 offen offset:1024 lds
    s_add_u32 s41, s41, 8192
    buffer_load_dwordx4 v[120:123], v5, s[20:23], s40 offen
    buffer_load_dwordx4 v[124:127], v6, s[20:23], s40 offen
    s_add_u32 s40, s40, 1024
    s_add_u32 s43, s42, 6144
    s_mov_b32 m0, s43
    buffer_load_dwordx4 v3, s[48:51], s41 offen lds
    s_add_u32 s41, s41, 6144
    buffer_load_dwordx4 v3, s[48:51], s41 offen offset:1024 lds
    s_add_u32 s41, s41, 8192
    buffer_load_dwordx4 v[136:139], v5, s[20:23], s40 offen
    buffer_load_dwordx4 v[140:143], v6, s[20:23], s40 offen
    s_add_u32 s40, s40, 1024
    s_add_u32 s43, s42, 8192
    s_mov_b32 m0, s43
    buffer_load_dwordx4 v3, s[48:51], s41 offen lds
    s_add_u32 s41, s41, 6144
    buffer_load_dwordx4 v3, s[48:51], s41 offen offset:1024 lds
    s_add_u32 s41, s41, 8192
    buffer_load_dwordx4 v[152:155], v5, s[20:23], s40 offen
    buffer_load_dwordx4 v[156:159], v6, s[20:23], s40 offen
    s_add_u32 s40, s40, 1024
    s_add_u32 s43, s42, 10240
    s_mov_b32 m0, s43
    buffer_load_dwordx4 v3, s[48:51], s41 offen lds
    s_add_u32 s41, s41, 6144
    buffer_load_dwordx4 v3, s[48:51], s41 offen offset:1024 lds
    s_add_u32 s41, s41, 8192
    buffer_load_dwordx4 v[168:171], v5, s[20:23], s40 offen
    buffer_load_dwordx4 v[172:175], v6, s[20:23], s40 offen
    s_add_u32 s40, s40, 1024
    s_add_u32 s43, s42, 12288
    s_mov_b32 m0, s43
    buffer_load_dwordx4 v3, s[48:51], s41 offen lds
    s_add_u32 s41, s41, 6144
    buffer_load_dwordx4 v3, s[48:51], s41 offen offset:1024 lds
    s_add_u32 s41, s41, 8192
    buffer_load_dwordx4 v[184:187], v5, s[20:23], s40 offen
    buffer_load_dwordx4 v[188:191], v6, s[20:23], s40 offen
    s_add_u32 s40, s40, 1024
    s_add_u32 s43, s42, 14336
    s_mov_b32 m0, s43
    buffer_load_dwordx4 v3, s[48:51], s41 offen lds
    s_add_u32 s41, s41, 6144
    buffer_load_dwordx4 v3, s[48:51], s41 offen offset:1024 lds
    s_add_u32 s41, s41, 8192
    buffer_load_dwordx4 v[200:203], v5, s[20:23], s40 offen
    buffer_load_dwordx4 v[204:207], v6, s[20:23], s40 offen
    s_add_u32 s40, s40, 1024
    s_add_u32 s43, s42, 16384
    s_mov_b32 m0, s43
    buffer_load_dwordx4 v3, s[48:51], s41 offen lds
    s_add_u32 s41, s41, 6144
    buffer_load_dwordx4 v3, s[48:51], s41 offen offset:1024 lds
    s_add_u32 s41, s41, 8192
    buffer_load_dwordx4 v[216:219], v5, s[20:23], s40 offen
    buffer_load_dwordx4 v[220:223], v6, s[20:23], s40 offen
    s_add_u32 s40, s40, 1024
    s_add_u32 s43, s42, 18432
    s_mov_b32 m0, s43
    buffer_load_dwordx4 v3, s[48:51], s41 offen lds
    s_add_u32 s41, s41, 6144
    buffer_load_dwordx4 v3, s[48:51], s41 offen offset:1024 lds
    s_add_u32 s41, s41, 8192
    buffer_load_dwordx4 v[232:235], v5, s[20:23], s40 offen
    buffer_load_dwordx4 v[236:239], v6, s[20:23], s40 offen
    s_add_u32 s40, s40, 1024
    s_waitcnt vmcnt(36)
    ds_read_b64_tr_b16 v[80:81], v4 offset:0
    ds_read_b64_tr_b16 v[82:83], v4 offset:1024
    ds_read_b64_tr_b16 v[84:85], v14 offset:0
    ds_read_b64_tr_b16 v[86:87], v14 offset:1024
    s_waitcnt vmcnt(32)
    ds_read_b64_tr_b16 v[96:97], v4 offset:2048
    ds_read_b64_tr_b16 v[98:99], v4 offset:3072
    ds_read_b64_tr_b16 v[100:101], v14 offset:2048
    ds_read_b64_tr_b16 v[102:103], v14 offset:3072
    s_waitcnt lgkmcnt(4)
    v_mfma_f32_32x32x16_bf16 v[16:31], v[80:83], v[88:91], 0
    v_mfma_f32_32x32x16_bf16 v[32:47], v[80:83], v[92:95], 0
    v_mfma_f32_32x32x16_bf16 v[48:63], v[84:87], v[88:91], 0
    v_mfma_f32_32x32x16_bf16 v[64:79], v[84:87], v[92:95], 0
    s_add_u32 s43, s42, 0
    s_mov_b32 m0, s43
    buffer_load_dwordx4 v3, s[48:51], s41 offen lds
    s_add_u32 s41, s41, 6144
    buffer_load_dwordx4 v3, s[48:51], s41 offen offset:1024 lds
    s_add_u32 s41, s41, 8192
    buffer_load_dwordx4 v[88:91], v5, s[20:23], s40 offen
    buffer_load_dwordx4 v[92:95], v6, s[20:23], s40 offen
    s_add_u32 s40, s40, 1024
    s_waitcnt vmcnt(32)
    ds_read_b64_tr_b16 v[112:113], v4 offset:4096
    ds_read_b64_tr_b16 v[114:115], v4 offset:5120
    ds_read_b64_tr_b16 v[116:117], v14 offset:4096
    ds_read_b64_tr_b16 v[118:119], v14 offset:5120
    s_waitcnt lgkmcnt(4)
    v_mfma_f32_32x32x16_bf16 v[16:31], v[96:99], v[104:107], v[16:31]
    v_mfma_f32_32x32x16_bf16 v[32:47], v[96:99], v[108:111], v[32:47]
    v_mfma_f32_32x32x16_bf16 v[48:63], v[100:103], v[104:107], v[48:63]
    v_mfma_f32_32x32x16_bf16 v[64:79], v[100:103], v[108:111], v[64:79]
    s_add_u32 s43, s42, 2048
    s_mov_b32 m0, s43
    buffer_load_dwordx4 v3, s[48:51], s41 offen lds
    s_add_u32 s41, s41, 6144
    buffer_load_dwordx4 v3, s[48:51], s41 offen offset:1024 lds
    s_add_u32 s41, s41, 8192
    buffer_load_dwordx4 v[104:107], v5, s[20:23], s40 offen
    buffer_load_dwordx4 v[108:111], v6, s[20:23], s40 offen
    s_add_u32 s40, s40, 1024
    s_waitcnt vmcnt(32)
    ds_read_b64_tr_b16 v[128:129], v4 offset:6144
    ds_read_b64_tr_b16 v[130:131], v4 offset:7168
    ds_read_b64_tr_b16 v[132:133], v14 offset:6144
    ds_read_b64_tr_b16 v[134:135], v14 offset:7168
    s_waitcnt lgkmcnt(4)
    v_mfma_f32_32x32x16_bf16 v[16:31], v[112:115], v[120:123], v[16:31]
    v_mfma_f32_32x32x16_bf16 v[32:47], v[112:115], v[124:127], v[32:47]
    v_mfma_f32_32x32x16_bf16 v[48:63], v[116:119], v[120:123], v[48:63]
    v_mfma_f32_32x32x16_bf16 v[64:79], v[116:119], v[124:127], v[64:79]
    s_add_u32 s43, s42, 4096
    s_mov_b32 m0, s43
    buffer_load_dwordx4 v3, s[48:51], s41 offen lds
    s_add_u32 s41, s41, 6144
    buffer_load_dwordx4 v3, s[48:51], s41 offen offset:1024 lds
    s_add_u32 s41, s41, 8192
    buffer_load_dwordx4 v[120:123], v5, s[20:23], s40 offen
    buffer_load_dwordx4 v[124:127], v6, s[20:23], s40 offen
    s_add_u32 s40, s40, 1024
    s_waitcnt vmcnt(32)
    ds_read_b64_tr_b16 v[144:145], v4 offset:8192
    ds_read_b64_tr_b16 v[146:147], v4 offset:9216
    ds_read_b64_tr_b16 v[148:149], v14 offset:8192
    ds_read_b64_tr_b16 v[150:151], v14 offset:9216
    s_waitcnt lgkmcnt(4)
    v_mfma_f32_32x32x16_bf16 v[16:31], v[128:131], v[136:139], v[16:31]
    v_mfma_f32_32x32x16_bf16 v[32:47], v[128:131], v[140:143], v[32:47]
    v_mfma_f32_32x32x16_bf16 v[48:63], v[132:135], v[136:139], v[48:63]
    v_mfma_f32_32x32x16_bf16 v[64:79], v[132:135], v[140:143], v[64:79]
    s_mov_b32 s43, 0
    buffer_load_dwordx4 v[128:131], v7, s[24:27], s43 offen
    buffer_load_dwordx4 v[132:135], v8, s[24:27], s43 offen
    buffer_load_dwordx4 v[136:139], v5, s[20:23], s40 offen
    buffer_load_dwordx4 v[140:143], v6, s[20:23], s40 offen
    s_add_u32 s40, s40, 1024
    s_waitcnt vmcnt(32)
    ds_read_b64_tr_b16 v[160:161], v4 offset:10240
    ds_read_b64_tr_b16 v[162:163], v4 offset:11264
    ds_read_b64_tr_b16 v[164:165], v14 offset:10240
    ds_read_b64_tr_b16 v[166:167], v14 offset:11264
    s_waitcnt lgkmcnt(4)
    v_mfma_f32_32x32x16_bf16 v[16:31], v[144:147], v[152:155], v[16:31]
    v_mfma_f32_32x32x16_bf16 v[32:47], v[144:147], v[156:159], v[32:47]
    v_mfma_f32_32x32x16_bf16 v[48:63], v[148:151], v[152:155], v[48:63]
    v_mfma_f32_32x32x16_bf16 v[64:79], v[148:151], v[156:159], v[64:79]
    s_mov_b32 s43, 1024
    buffer_load_dwordx4 v[144:147], v7, s[24:27], s43 offen
    buffer_load_dwordx4 v[148:151], v8, s[24:27], s43 offen
    buffer_load_dwordx4 v[152:155], v5, s[20:23], s40 offen
    buffer_load_dwordx4 v[156:159], v6, s[20:23], s40 offen
    s_add_u32 s40, s40, 1024
    s_waitcnt vmcnt(32)
    ds_read_b64_tr_b16 v[176:177], v4 offset:12288
    ds_read_b64_tr_b16 v[178:179], v4 offset:13312
    ds_read_b64_tr_b16 v[180:181], v14 offset:12288
    ds_read_b64_tr_b16 v[182:183], v14 offset:13312
    s_waitcnt lgkmcnt(4)
    v_mfma_f32_32x32x16_bf16 v[16:31], v[160:163], v[168:171], v[16:31]
    v_mfma_f32_32x32x16_bf16 v[32:47], v[160:163], v[172:175], v[32:47]
    v_mfma_f32_32x32x16_bf16 v[48:63], v[164:167], v[168:171], v[48:63]
    v_mfma_f32_32x32x16_bf16 v[64:79], v[164:167], v[172:175], v[64:79]
    s_mov_b32 s43, 2048
    buffer_load_dwordx4 v[160:163], v7, s[24:27], s43 offen
    buffer_load_dwordx4 v[164:167], v8, s[24:27], s43 offen
    buffer_load_dwordx4 v[168:171], v5, s[20:23], s40 offen
    buffer_load_dwordx4 v[172:175], v6, s[20:23], s40 offen
    s_add_u32 s40, s40, 1024
    s_waitcnt vmcnt(32)
    ds_read_b64_tr_b16 v[192:193], v4 offset:14336
    ds_read_b64_tr_b16 v[194:195], v4 offset:15360
    ds_read_b64_tr_b16 v[196:197], v14 offset:14336
    ds_read_b64_tr_b16 v[198:199], v14 offset:15360
    s_waitcnt lgkmcnt(4)
    v_mfma_f32_32x32x16_bf16 v[16:31], v[176:179], v[184:187], v[16:31]
    v_mfma_f32_32x32x16_bf16 v[32:47], v[176:179], v[188:191], v[32:47]
    v_mfma_f32_32x32x16_bf16 v[48:63], v[180:183], v[184:187], v[48:63]
    v_mfma_f32_32x32x16_bf16 v[64:79], v[180:183], v[188:191], v[64:79]
    s_mov_b32 s43, 3072
    buffer_load_dwordx4 v[176:179], v7, s[24:27], s43 offen
    buffer_load_dwordx4 v[180:183], v8, s[24:27], s43 offen
    buffer_load_dwordx4 v[184:187], v5, s[20:23], s40 offen
    buffer_load_dwordx4 v[188:191], v6, s[20:23], s40 offen
    s_add_u32 s40, s40, 1024
    s_waitcnt vmcnt(32)
    ds_read_b64_tr_b16 v[208:209], v4 offset:16384
    ds_read_b64_tr_b16 v[210:211], v4 offset:17408
    ds_read_b64_tr_b16 v[212:213], v14 offset:16384
    ds_read_b64_tr_b16 v[214:215], v14 offset:17408
    s_waitcnt lgkmcnt(4)
    v_mfma_f32_32x32x16_bf16 v[16:31], v[192:195], v[200:203], v[16:31]
    v_mfma_f32_32x32x16_bf16 v[32:47], v[192:195], v[204:207], v[32:47]
    v_mfma_f32_32x32x16_bf16 v[48:63], v[196:199], v[200:203], v[48:63]
    v_mfma_f32_32x32x16_bf16 v[64:79], v[196:199], v[204:207], v[64:79]
    s_mov_b32 s43, 4096
    buffer_load_dwordx4 v[192:195], v7, s[24:27], s43 offen
    buffer_load_dwordx4 v[196:199], v8, s[24:27], s43 offen
    buffer_load_dwordx4 v[200:203], v5, s[20:23], s40 offen
    buffer_load_dwordx4 v[204:207], v6, s[20:23], s40 offen
    s_add_u32 s40, s40, 1024
    s_waitcnt vmcnt(32)
    ds_read_b64_tr_b16 v[224:225], v4 offset:18432
    ds_read_b64_tr_b16 v[226:227], v4 offset:19456
    ds_read_b64_tr_b16 v[228:229], v14 offset:18432
    ds_read_b64_tr_b16 v[230:231], v14 offset:19456
    s_waitcnt lgkmcnt(4)
    v_mfma_f32_32x32x16_bf16 v[16:31], v[208:211], v[216:219], v[16:31]
    v_mfma_f32_32x32x16_bf16 v[32:47], v[208:211], v[220:223], v[32:47]
    v_mfma_f32_32x32x16_bf16 v[48:63], v[212:215], v[216:219], v[48:63]
    v_mfma_f32_32x32x16_bf16 v[64:79], v[212:215], v[220:223], v[64:79]
    s_mov_b32 s43, 5120
    buffer_load_dwordx4 v[208:211], v7, s[24:27], s43 offen
    buffer_load_dwordx4 v[212:215], v8, s[24:27], s43 offen
    buffer_load_dwordx4 v[216:219], v5, s[20:23], s40 offen
    buffer_load_dwordx4 v[220:223], v6, s[20:23], s40 offen
    s_add_u32 s40, s40, 1024
    s_waitcnt vmcnt(32)
    ds_read_b64_tr_b16 v[80:81], v4 offset:0
    ds_read_b64_tr_b16 v[82:83], v4 offset:1024
    ds_read_b64_tr_b16 v[84:85], v14 offset:0
    ds_read_b64_tr_b16 v[86:87], v14 offset:1024
    s_waitcnt lgkmcnt(4)
    v_mfma_f32_32x32x16_bf16 v[16:31], v[224:227], v[232:235], v[16:31]
    v_mfma_f32_32x32x16_bf16 v[32:47], v[224:227], v[236:239], v[32:47]
    v_mfma_f32_32x32x16_bf16 v[48:63], v[228:231], v[232:235], v[48:63]
    v_mfma_f32_32x32x16_bf16 v[64:79], v[228:231], v[236:239], v[64:79]
    s_mov_b32 s43, 6144
    buffer_load_dwordx4 v[224:227], v7, s[24:27], s43 offen
    buffer_load_dwordx4 v[228:231], v8, s[24:27], s43 offen
    buffer_load_dwordx4 v[232:235], v5, s[20:23], s40 offen
    buffer_load_dwordx4 v[236:239], v6, s[20:23], s40 offen
    s_add_u32 s40, s40, 1024
    s_waitcnt vmcnt(32)
    ds_read_b64_tr_b16 v[96:97], v4 offset:2048
    ds_read_b64_tr_b16 v[98:99], v4 offset:3072
    ds_read_b64_tr_b16 v[100:101], v14 offset:2048
    ds_read_b64_tr_b16 v[102:103], v14 offset:3072
    s_waitcnt lgkmcnt(4)
    v_mfma_f32_32x32x16_bf16 v[16:31], v[80:83], v[88:91], v[16:31]
    v_mfma_f32_32x32x16_bf16 v[32:47], v[80:83], v[92:95], v[32:47]
    v_mfma_f32_32x32x16_bf16 v[48:63], v[84:87], v[88:91], v[48:63]
    v_mfma_f32_32x32x16_bf16 v[64:79], v[84:87], v[92:95], v[64:79]
    s_mov_b32 s43, 7168
    buffer_load_dwordx4 v[80:83], v7, s[24:27], s43 offen
    buffer_load_dwordx4 v[84:87], v8, s[24:27], s43 offen
    buffer_load_dwordx4 v[88:91], v5, s[20:23], s40 offen
    buffer_load_dwordx4 v[92:95], v6, s[20:23], s40 offen
    s_add_u32 s40, s40, 1024
    s_waitcnt vmcnt(32)
    ds_read_b64_tr_b16 v[112:113], v4 offset:4096
    ds_read_b64_tr_b16 v[114:115], v4 offset:5120
    ds_read_b64_tr_b16 v[116:117], v14 offset:4096
    ds_read_b64_tr_b16 v[118:119], v14 offset:5120
    s_waitcnt lgkmcnt(4)
    v_mfma_f32_32x32x16_bf16 v[16:31], v[96:99], v[104:107], v[16:31]
    v_mfma_f32_32x32x16_bf16 v[32:47], v[96:99], v[108:111], v[32:47]
    v_mfma_f32_32x32x16_bf16 v[48:63], v[100:103], v[104:107], v[48:63]
    v_mfma_f32_32x32x16_bf16 v[64:79], v[100:103], v[108:111], v[64:79]
    s_mov_b32 s43, 8192
    buffer_load_dwordx4 v[96:99], v7, s[24:27], s43 offen
    buffer_load_dwordx4 v[100:103], v8, s[24:27], s43 offen
    buffer_load_dwordx4 v[104:107], v5, s[20:23], s40 offen
    buffer_load_dwordx4 v[108:111], v6, s[20:23], s40 offen
    s_add_u32 s40, s40, 1024
    s_waitcnt vmcnt(32)
    s_waitcnt lgkmcnt(0)
    v_mfma_f32_32x32x16_bf16 v[16:31], v[112:115], v[120:123], v[16:31]
    v_mfma_f32_32x32x16_bf16 v[32:47], v[112:115], v[124:127], v[32:47]
    v_mfma_f32_32x32x16_bf16 v[48:63], v[116:119], v[120:123], v[48:63]
    v_mfma_f32_32x32x16_bf16 v[64:79], v[116:119], v[124:127], v[64:79]
    s_mov_b32 s43, 9216
    buffer_load_dwordx4 v[112:115], v7, s[24:27], s43 offen
    buffer_load_dwordx4 v[116:119], v8, s[24:27], s43 offen
    buffer_load_dwordx4 v[120:123], v5, s[20:23], s40 offen
    buffer_load_dwordx4 v[124:127], v6, s[20:23], s40 offen
    s_add_u32 s40, s40, 1024
    s_waitcnt vmcnt(32)
    s_waitcnt lgkmcnt(0)
    v_mfma_f32_32x32x16_bf16 v[16:31], v[128:131], v[136:139], v[16:31]
    v_mfma_f32_32x32x16_bf16 v[32:47], v[128:131], v[140:143], v[32:47]
    v_mfma_f32_32x32x16_bf16 v[48:63], v[132:135], v[136:139], v[48:63]
    v_mfma_f32_32x32x16_bf16 v[64:79], v[132:135], v[140:143], v[64:79]
    s_mov_b32 s43, 10240
    buffer_load_dwordx4 v[128:131], v7, s[24:27], s43 offen
    buffer_load_dwordx4 v[132:135], v8, s[24:27], s43 offen
    buffer_load_dwordx4 v[136:139], v5, s[20:23], s40 offen
    buffer_load_dwordx4 v[140:143], v6, s[20:23], s40 offen
    s_add_u32 s40, s40, 1024
    s_waitcnt vmcnt(32)
    s_waitcnt lgkmcnt(0)
    v_mfma_f32_32x32x16_bf16 v[16:31], v[144:147], v[152:155], v[16:31]
    v_mfma_f32_32x32x16_bf16 v[32:47], v[144:147], v[156:159], v[32:47]
    v_mfma_f32_32x32x16_bf16 v[48:63], v[148:151], v[152:155], v[48:63]
    v_mfma_f32_32x32x16_bf16 v[64:79], v[148:151], v[156:159], v[64:79]
    s_mov_b32 s43, 11264
    buffer_load_dwordx4 v[144:147], v7, s[24:27], s43 offen
    buffer_load_dwordx4 v[148:151], v8, s[24:27], s43 offen
    buffer_load_dwordx4 v[152:155], v5, s[20:23], s40 offen
    buffer_load_dwordx4 v[156:159], v6, s[20:23], s40 offen
    s_add_u32 s40, s40, 1024
    s_waitcnt vmcnt(32)
    s_waitcnt lgkmcnt(0)
    v_mfma_f32_32x32x16_bf16 v[16:31], v[160:163], v[168:171], v[16:31]
    v_mfma_f32_32x32x16_bf16 v[32:47], v[160:163], v[172:175], v[32:47]
    v_mfma_f32_32x32x16_bf16 v[48:63], v[164:167], v[168:171], v[48:63]
    v_mfma_f32_32x32x16_bf16 v[64:79], v[164:167], v[172:175], v[64:79]
    s_mov_b32 s43, 12288
    buffer_load_dwordx4 v[160:163], v7, s[24:27], s43 offen
    buffer_load_dwordx4 v[164:167], v8, s[24:27], s43 offen
    buffer_load_dwordx4 v[168:171], v5, s[20:23], s40 offen
    buffer_load_dwordx4 v[172:175], v6, s[20:23], s40 offen
    s_add_u32 s40, s40, 1024
    s_waitcnt vmcnt(32)
    s_waitcnt lgkmcnt(0)
    v_mfma_f32_32x32x16_bf16 v[16:31], v[176:179], v[184:187], v[16:31]
    v_mfma_f32_32x32x16_bf16 v[32:47], v[176:179], v[188:191], v[32:47]
    v_mfma_f32_32x32x16_bf16 v[48:63], v[180:183], v[184:187], v[48:63]
    v_mfma_f32_32x32x16_bf16 v[64:79], v[180:183], v[188:191], v[64:79]
    s_mov_b32 s43, 13312
    buffer_load_dwordx4 v[176:179], v7, s[24:27], s43 offen
    buffer_load_dwordx4 v[180:183], v8, s[24:27], s43 offen
    buffer_load_dwordx4 v[184:187], v5, s[20:23], s40 offen
    buffer_load_dwordx4 v[188:191], v6, s[20:23], s40 offen
    s_add_u32 s40, s40, 1024
    s_waitcnt vmcnt(32)
    s_waitcnt lgkmcnt(0)
    v_mfma_f32_32x32x16_bf16 v[16:31], v[192:195], v[200:203], v[16:31]
    v_mfma_f32_32x32x16_bf16 v[32:47], v[192:195], v[204:207], v[32:47]
    v_mfma_f32_32x32x16_bf16 v[48:63], v[196:199], v[200:203], v[48:63]
    v_mfma_f32_32x32x16_bf16 v[64:79], v[196:199], v[204:207], v[64:79]
    s_mov_b32 s43, 14336
    buffer_load_dwordx4 v[192:195], v7, s[24:27], s43 offen
    buffer_load_dwordx4 v[196:199], v8, s[24:27], s43 offen
    buffer_load_dwordx4 v[200:203], v5, s[20:23], s40 offen
    buffer_load_dwordx4 v[204:207], v6, s[20:23], s40 offen
    s_add_u32 s40, s40, 1024
    s_waitcnt vmcnt(32)
    s_waitcnt lgkmcnt(0)
    v_mfma_f32_32x32x16_bf16 v[16:31], v[208:211], v[216:219], v[16:31]
    v_mfma_f32_32x32x16_bf16 v[32:47], v[208:211], v[220:223], v[32:47]
    v_mfma_f32_32x32x16_bf16 v[48:63], v[212:215], v[216:219], v[48:63]
    v_mfma_f32_32x32x16_bf16 v[64:79], v[212:215], v[220:223], v[64:79]
    s_mov_b32 s43, 15360
    buffer_load_dwordx4 v[208:211], v7, s[24:27], s43 offen
    buffer_load_dwordx4 v[212:215], v8, s[24:27], s43 offen
    buffer_load_dwordx4 v[216:219], v5, s[20:23], s40 offen
    buffer_load_dwordx4 v[220:223], v6, s[20:23], s40 offen
    s_add_u32 s40, s40, 1024
    s_waitcnt vmcnt(32)
    s_waitcnt lgkmcnt(0)
    v_mfma_f32_32x32x16_bf16 v[16:31], v[224:227], v[232:235], v[16:31]
    v_mfma_f32_32x32x16_bf16 v[32:47], v[224:227], v[236:239], v[32:47]
    v_mfma_f32_32x32x16_bf16 v[48:63], v[228:231], v[232:235], v[48:63]
    v_mfma_f32_32x32x16_bf16 v[64:79], v[228:231], v[236:239], v[64:79]
    s_mov_b32 s43, 16384
    buffer_load_dwordx4 v[224:227], v7, s[24:27], s43 offen
    buffer_load_dwordx4 v[228:231], v8, s[24:27], s43 offen
    buffer_load_dwordx4 v[232:235], v5, s[20:23], s40 offen
    buffer_load_dwordx4 v[236:239], v6, s[20:23], s40 offen
    s_add_u32 s40, s40, 1024
    s_waitcnt vmcnt(32)
    s_waitcnt lgkmcnt(0)
    v_mfma_f32_32x32x16_bf16 v[16:31], v[80:83], v[88:91], v[16:31]
    v_mfma_f32_32x32x16_bf16 v[32:47], v[80:83], v[92:95], v[32:47]
    v_mfma_f32_32x32x16_bf16 v[48:63], v[84:87], v[88:91], v[48:63]
    v_mfma_f32_32x32x16_bf16 v[64:79], v[84:87], v[92:95], v[64:79]
    s_mov_b32 s43, 17408
    buffer_load_dwordx4 v[80:83], v7, s[24:27], s43 offen
    buffer_load_dwordx4 v[84:87], v8, s[24:27], s43 offen
    buffer_load_dwordx4 v[88:91], v5, s[20:23], s40 offen
    buffer_load_dwordx4 v[92:95], v6, s[20:23], s40 offen
    s_add_u32 s40, s40, 1024
    s_waitcnt vmcnt(32)
    s_waitcnt lgkmcnt(0)
    v_mfma_f32_32x32x16_bf16 v[16:31], v[96:99], v[104:107], v[16:31]
    v_mfma_f32_32x32x16_bf16 v[32:47], v[96:99], v[108:111], v[32:47]
    v_mfma_f32_32x32x16_bf16 v[48:63], v[100:103], v[104:107], v[48:63]
    v_mfma_f32_32x32x16_bf16 v[64:79], v[100:103], v[108:111], v[64:79]
    s_mov_b32 s43, 18432
    buffer_load_dwordx4 v[96:99], v7, s[24:27], s43 offen
    buffer_load_dwordx4 v[100:103], v8, s[24:27], s43 offen
    buffer_load_dwordx4 v[104:107], v5, s[20:23], s40 offen
    buffer_load_dwordx4 v[108:111], v6, s[20:23], s40 offen
    s_add_u32 s40, s40, 1024
    s_waitcnt vmcnt(32)
    s_waitcnt lgkmcnt(0)
    v_mfma_f32_32x32x16_bf16 v[16:31], v[112:115], v[120:123], v[16:31]
    v_mfma_f32_32x32x16_bf16 v[32:47], v[112:115], v[124:127], v[32:47]
    v_mfma_f32_32x32x16_bf16 v[48:63], v[116:119], v[120:123], v[48:63]
    v_mfma_f32_32x32x16_bf16 v[64:79], v[116:119], v[124:127], v[64:79]
    s_mov_b32 s43, 19456
    buffer_load_dwordx4 v[112:115], v7, s[24:27], s43 offen
    buffer_load_dwordx4 v[116:119], v8, s[24:27], s43 offen
    buffer_load_dwordx4 v[120:123], v5, s[20:23], s40 offen
    buffer_load_dwordx4 v[124:127], v6, s[20:23], s40 offen
    s_add_u32 s40, s40, 1024
    s_waitcnt vmcnt(32)
    s_waitcnt lgkmcnt(0)
    v_mfma_f32_32x32x16_bf16 v[16:31], v[128:131], v[136:139], v[16:31]
    v_mfma_f32_32x32x16_bf16 v[32:47], v[128:131], v[140:143], v[32:47]
    v_mfma_f32_32x32x16_bf16 v[48:63], v[132:135], v[136:139], v[48:63]
    v_mfma_f32_32x32x16_bf16 v[64:79], v[132:135], v[140:143], v[64:79]
    s_mov_b32 s43, 20480
    buffer_load_dwordx4 v[128:131], v7, s[24:27], s43 offen
    buffer_load_dwordx4 v[132:135], v8, s[24:27], s43 offen
    buffer_load_dwordx4 v[136:139], v5, s[20:23], s40 offen
    buffer_load_dwordx4 v[140:143], v6, s[20:23], s40 offen
    s_add_u32 s40, s40, 1024
    s_waitcnt vmcnt(32)
    s_waitcnt lgkmcnt(0)
    v_mfma_f32_32x32x16_bf16 v[16:31], v[144:147], v[152:155], v[16:31]
    v_mfma_f32_32x32x16_bf16 v[32:47], v[144:147], v[156:159], v[32:47]
    v_mfma_f32_32x32x16_bf16 v[48:63], v[148:151], v[152:155], v[48:63]
    v_mfma_f32_32x32x16_bf16 v[64:79], v[148:151], v[156:159], v[64:79]
    s_mov_b32 s43, 21504
    buffer_load_dwordx4 v[144:147], v7, s[24:27], s43 offen
    buffer_load_dwordx4 v[148:151], v8, s[24:27], s43 offen
    buffer_load_dwordx4 v[152:155], v5, s[20:23], s40 offen
    buffer_load_dwordx4 v[156:159], v6, s[20:23], s40 offen
    s_add_u32 s40, s40, 1024
    s_waitcnt vmcnt(32)
    s_waitcnt lgkmcnt(0)
    v_mfma_f32_32x32x16_bf16 v[16:31], v[160:163], v[168:171], v[16:31]
    v_mfma_f32_32x32x16_bf16 v[32:47], v[160:163], v[172:175], v[32:47]
    v_mfma_f32_32x32x16_bf16 v[48:63], v[164:167], v[168:171], v[48:63]
    v_mfma_f32_32x32x16_bf16 v[64:79], v[164:167], v[172:175], v[64:79]
    s_mov_b32 s43, 22528
    buffer_load_dwordx4 v[160:163], v7, s[24:27], s43 offen
    buffer_load_dwordx4 v[164:167], v8, s[24:27], s43 offen
    buffer_load_dwordx4 v[168:171], v5, s[20:23], s40 offen
    buffer_load_dwordx4 v[172:175], v6, s[20:23], s40 offen
    s_add_u32 s40, s40, 1024
    s_waitcnt vmcnt(32)
    s_waitcnt lgkmcnt(0)
    v_mfma_f32_32x32x16_bf16 v[16:31], v[176:179], v[184:187], v[16:31]
    v_mfma_f32_32x32x16_bf16 v[32:47], v[176:179], v[188:191], v[32:47]
    v_mfma_f32_32x32x16_bf16 v[48:63], v[180:183], v[184:187], v[48:63]
    v_mfma_f32_32x32x16_bf16 v[64:79], v[180:183], v[188:191], v[64:79]
    s_mov_b32 s43, 23552
    buffer_load_dwordx4 v[176:179], v7, s[24:27], s43 offen
    buffer_load_dwordx4 v[180:183], v8, s[24:27], s43 offen
    buffer_load_dwordx4 v[184:187], v5, s[20:23], s40 offen
    buffer_load_dwordx4 v[188:191], v6, s[20:23], s40 offen
    s_add_u32 s40, s40, 1024
    s_waitcnt vmcnt(32)
    s_waitcnt lgkmcnt(0)
    v_mfma_f32_32x32x16_bf16 v[16:31], v[192:195], v[200:203], v[16:31]
    v_mfma_f32_32x32x16_bf16 v[32:47], v[192:195], v[204:207], v[32:47]
    v_mfma_f32_32x32x16_bf16 v[48:63], v[196:199], v[200:203], v[48:63]
    v_mfma_f32_32x32x16_bf16 v[64:79], v[196:199], v[204:207], v[64:79]
    s_mov_b32 s43, 24576
    buffer_load_dwordx4 v[192:195], v7, s[24:27], s43 offen
    buffer_load_dwordx4 v[196:199], v8, s[24:27], s43 offen
    buffer_load_dwordx4 v[200:203], v5, s[20:23], s40 offen
    buffer_load_dwordx4 v[204:207], v6, s[20:23], s40 offen
    s_add_u32 s40, s40, 1024
    s_waitcnt vmcnt(32)
    s_waitcnt lgkmcnt(0)
    v_mfma_f32_32x32x16_bf16 v[16:31], v[208:211], v[216:219], v[16:31]
    v_mfma_f32_32x32x16_bf16 v[32:47], v[208:211], v[220:223], v[32:47]
    v_mfma_f32_32x32x16_bf16 v[48:63], v[212:215], v[216:219], v[48:63]
    v_mfma_f32_32x32x16_bf16 v[64:79], v[212:215], v[220:223], v[64:79]
    s_mov_b32 s43, 25600
    buffer_load_dwordx4 v[208:211], v7, s[24:27], s43 offen
    buffer_load_dwordx4 v[212:215], v8, s[24:27], s43 offen
    buffer_load_dwordx4 v[216:219], v5, s[20:23], s40 offen
    buffer_load_dwordx4 v[220:223], v6, s[20:23], s40 offen
    s_add_u32 s40, s40, 1024
    s_waitcnt vmcnt(32)
    s_waitcnt lgkmcnt(0)
    v_mfma_f32_32x32x16_bf16 v[16:31], v[224:227], v[232:235], v[16:31]
    v_mfma_f32_32x32x16_bf16 v[32:47], v[224:227], v[236:239], v[32:47]
    v_mfma_f32_32x32x16_bf16 v[48:63], v[228:231], v[232:235], v[48:63]
    v_mfma_f32_32x32x16_bf16 v[64:79], v[228:231], v[236:239], v[64:79]
    s_mov_b32 s43, 26624
    buffer_load_dwordx4 v[224:227], v7, s[24:27], s43 offen
    buffer_load_dwordx4 v[228:231], v8, s[24:27], s43 offen
    buffer_load_dwordx4 v[232:235], v5, s[20:23], s40 offen
    buffer_load_dwordx4 v[236:239], v6, s[20:23], s40 offen
    s_add_u32 s40, s40, 1024
    s_waitcnt vmcnt(32)
    s_waitcnt lgkmcnt(0)
    v_mfma_f32_32x32x16_bf16 v[16:31], v[80:83], v[88:91], v[16:31]
    v_mfma_f32_32x32x16_bf16 v[32:47], v[80:83], v[92:95], v[32:47]
    v_mfma_f32_32x32x16_bf16 v[48:63], v[84:87], v[88:91], v[48:63]
    v_mfma_f32_32x32x16_bf16 v[64:79], v[84:87], v[92:95], v[64:79]
    s_mov_b32 s43, 27648
    buffer_load_dwordx4 v[80:83], v7, s[24:27], s43 offen
    buffer_load_dwordx4 v[84:87], v8, s[24:27], s43 offen
    buffer_load_dwordx4 v[88:91], v5, s[20:23], s40 offen
    buffer_load_dwordx4 v[92:95], v6, s[20:23], s40 offen
    s_add_u32 s40, s40, 1024
    s_waitcnt vmcnt(32)
    s_waitcnt lgkmcnt(0)
    v_mfma_f32_32x32x16_bf16 v[16:31], v[96:99], v[104:107], v[16:31]
    v_mfma_f32_32x32x16_bf16 v[32:47], v[96:99], v[108:111], v[32:47]
    v_mfma_f32_32x32x16_bf16 v[48:63], v[100:103], v[104:107], v[48:63]
    v_mfma_f32_32x32x16_bf16 v[64:79], v[100:103], v[108:111], v[64:79]
    s_mov_b32 s43, 28672
    buffer_load_dwordx4 v[96:99], v7, s[24:27], s43 offen
    buffer_load_dwordx4 v[100:103], v8, s[24:27], s43 offen
    buffer_load_dwordx4 v[104:107], v5, s[20:23], s40 offen
    buffer_load_dwordx4 v[108:111], v6, s[20:23], s40 offen
    s_add_u32 s40, s40, 1024
    s_waitcnt vmcnt(32)
    s_waitcnt lgkmcnt(0)
    v_mfma_f32_32x32x16_bf16 v[16:31], v[112:115], v[120:123], v[16:31]
    v_mfma_f32_32x32x16_bf16 v[32:47], v[112:115], v[124:127], v[32:47]
    v_mfma_f32_32x32x16_bf16 v[48:63], v[116:119], v[120:123], v[48:63]
    v_mfma_f32_32x32x16_bf16 v[64:79], v[116:119], v[124:127], v[64:79]
    buffer_load_dwordx4 v[248:251], v10, s[12:15], 0 offen
    buffer_load_dwordx4 v[252:255], v10, s[12:15], s37 offen
    s_waitcnt vmcnt(30)
    s_waitcnt lgkmcnt(0)
    v_mfma_f32_32x32x16_bf16 v[16:31], v[128:131], v[136:139], v[16:31]
    v_mfma_f32_32x32x16_bf16 v[32:47], v[128:131], v[140:143], v[32:47]
    v_mfma_f32_32x32x16_bf16 v[48:63], v[132:135], v[136:139], v[48:63]
    v_mfma_f32_32x32x16_bf16 v[64:79], v[132:135], v[140:143], v[64:79]
    s_waitcnt vmcnt(26)
    s_waitcnt lgkmcnt(0)
    v_mfma_f32_32x32x16_bf16 v[16:31], v[144:147], v[152:155], v[16:31]
    v_mfma_f32_32x32x16_bf16 v[32:47], v[144:147], v[156:159], v[32:47]
    v_mfma_f32_32x32x16_bf16 v[48:63], v[148:151], v[152:155], v[48:63]
    v_mfma_f32_32x32x16_bf16 v[64:79], v[148:151], v[156:159], v[64:79]
    s_waitcnt vmcnt(22)
    s_waitcnt lgkmcnt(0)
    v_mfma_f32_32x32x16_bf16 v[16:31], v[160:163], v[168:171], v[16:31]
    v_mfma_f32_32x32x16_bf16 v[32:47], v[160:163], v[172:175], v[32:47]
    v_mfma_f32_32x32x16_bf16 v[48:63], v[164:167], v[168:171], v[48:63]
    v_mfma_f32_32x32x16_bf16 v[64:79], v[164:167], v[172:175], v[64:79]
    s_waitcnt vmcnt(18)
    s_waitcnt lgkmcnt(0)
    v_mfma_f32_32x32x16_bf16 v[16:31], v[176:179], v[184:187], v[16:31]
    v_mfma_f32_32x32x16_bf16 v[32:47], v[176:179], v[188:191], v[32:47]
    v_mfma_f32_32x32x16_bf16 v[48:63], v[180:183], v[184:187], v[48:63]
    v_mfma_f32_32x32x16_bf16 v[64:79], v[180:183], v[188:191], v[64:79]
    s_waitcnt vmcnt(14)
    s_waitcnt lgkmcnt(0)
    v_mfma_f32_32x32x16_bf16 v[16:31], v[192:195], v[200:203], v[16:31]
    v_mfma_f32_32x32x16_bf16 v[32:47], v[192:195], v[204:207], v[32:47]
    v_mfma_f32_32x32x16_bf16 v[48:63], v[196:199], v[200:203], v[48:63]
    v_mfma_f32_32x32x16_bf16 v[64:79], v[196:199], v[204:207], v[64:79]
    s_waitcnt vmcnt(10)
    s_waitcnt lgkmcnt(0)
    v_mfma_f32_32x32x16_bf16 v[16:31], v[208:211], v[216:219], v[16:31]
    v_mfma_f32_32x32x16_bf16 v[32:47], v[208:211], v[220:223], v[32:47]
    v_mfma_f32_32x32x16_bf16 v[48:63], v[212:215], v[216:219], v[48:63]
    v_mfma_f32_32x32x16_bf16 v[64:79], v[212:215], v[220:223], v[64:79]
    s_waitcnt vmcnt(6)
    s_waitcnt lgkmcnt(0)
    v_mfma_f32_32x32x16_bf16 v[16:31], v[224:227], v[232:235], v[16:31]
    v_mfma_f32_32x32x16_bf16 v[32:47], v[224:227], v[236:239], v[32:47]
    v_mfma_f32_32x32x16_bf16 v[48:63], v[228:231], v[232:235], v[48:63]
    v_mfma_f32_32x32x16_bf16 v[64:79], v[228:231], v[236:239], v[64:79]
    s_waitcnt vmcnt(2)
    s_waitcnt lgkmcnt(0)
    v_mfma_f32_32x32x16_bf16 v[16:31], v[80:83], v[88:91], v[16:31]
    v_mfma_f32_32x32x16_bf16 v[32:47], v[80:83], v[92:95], v[32:47]
    v_mfma_f32_32x32x16_bf16 v[48:63], v[84:87], v[88:91], v[48:63]
    v_mfma_f32_32x32x16_bf16 v[64:79], v[84:87], v[92:95], v[64:79]
    s_waitcnt lgkmcnt(0)
    v_mfma_f32_32x32x16_bf16 v[16:31], v[96:99], v[104:107], v[16:31]
    v_mfma_f32_32x32x16_bf16 v[32:47], v[96:99], v[108:111], v[32:47]
    v_mfma_f32_32x32x16_bf16 v[48:63], v[100:103], v[104:107], v[48:63]
    v_mfma_f32_32x32x16_bf16 v[64:79], v[100:103], v[108:111], v[64:79]
K3_red:
    s_mul_i32 s35, s30, 4352
    s_add_u32 s35, s35, 81920
    v_add_u32 v2, s35, v2
    s_nop 15
    ds_write_b128 v2, v[16:19] offset:0
    ds_write_b128 v2, v[20:23] offset:1088
    ds_write_b128 v2, v[24:27] offset:2176
    ds_write_b128 v2, v[28:31] offset:3264
    ds_write_b128 v2, v[32:35] offset:17408
    ds_write_b128 v2, v[36:39] offset:18496
    ds_write_b128 v2, v[40:43] offset:19584
    ds_write_b128 v2, v[44:47] offset:20672
    ds_write_b128 v2, v[48:51] offset:34816
    ds_write_b128 v2, v[52:55] offset:35904
    ds_write_b128 v2, v[56:59] offset:36992
    ds_write_b128 v2, v[60:63] offset:38080
    ds_write_b128 v2, v[64:67] offset:52224
    ds_write_b128 v2, v[68:71] offset:53312
    ds_write_b128 v2, v[72:75] offset:54400
    ds_write_b128 v2, v[76:79] offset:55488
    s_waitcnt lgkmcnt(0)
    s_barrier
    ds_read_b128 v[80:83], v15 offset:0
    ds_read_b128 v[84:87], v15 offset:512
    ds_read_b128 v[88:91], v15 offset:4352
    ds_read_b128 v[92:95], v15 offset:4864
    ds_read_b128 v[96:99], v15 offset:8704
    ds_read_b128 v[100:103], v15 offset:9216
    ds_read_b128 v[104:107], v15 offset:13056
    ds_read_b128 v[108:111], v15 offset:13568
    ds_read_b128 v[112:115], v15 offset:256
    ds_read_b128 v[116:119], v15 offset:768
    ds_read_b128 v[120:123], v15 offset:4608
    ds_read_b128 v[124:127], v15 offset:5120
    ds_read_b128 v[128:131], v15 offset:8960
    ds_read_b128 v[132:135], v15 offset:9472
    ds_read_b128 v[136:139], v15 offset:13312
    ds_read_b128 v[140:143], v15 offset:13824
    s_waitcnt vmcnt(0)
    s_waitcnt lgkmcnt(12)
    v_add_f32 v80, v80, v88
    v_add_f32 v81, v81, v89
    v_add_f32 v82, v82, v90
    v_add_f32 v83, v83, v91
    v_add_f32 v84, v84, v92
    v_add_f32 v85, v85, v93
    v_add_f32 v86, v86, v94
    v_add_f32 v87, v87, v95
    s_waitcnt lgkmcnt(8)
    v_add_f32 v96, v96, v104
    v_add_f32 v97, v97, v105
    v_add_f32 v98, v98, v106
    v_add_f32 v99, v99, v107
    v_add_f32 v100, v100, v108
    v_add_f32 v101, v101, v109
    v_add_f32 v102, v102, v110
    v_add_f32 v103, v103, v111
    v_lshlrev_b32 v11, 16, v248
    v_and_b32 v12, 0xffff0000, v248
    v_add_f32 v80, v80, v96
    v_add_f32 v81, v81, v97
    v_add_f32 v11, v11, v80
    v_add_f32 v12, v12, v81
    v_cvt_pk_bf16_f32 v248, v11, v12
    v_lshlrev_b32 v11, 16, v249
    v_and_b32 v12, 0xffff0000, v249
    v_add_f32 v82, v82, v98
    v_add_f32 v83, v83, v99
    v_add_f32 v11, v11, v82
    v_add_f32 v12, v12, v83
    v_cvt_pk_bf16_f32 v249, v11, v12
    v_lshlrev_b32 v11, 16, v250
    v_and_b32 v12, 0xffff0000, v250
    v_add_f32 v84, v84, v100
    v_add_f32 v85, v85, v101
    v_add_f32 v11, v11, v84
    v_add_f32 v12, v12, v85
    v_cvt_pk_bf16_f32 v250, v11, v12
    v_lshlrev_b32 v11, 16, v251
    v_and_b32 v12, 0xffff0000, v251
    v_add_f32 v86, v86, v102
    v_add_f32 v87, v87, v103
    v_add_f32 v11, v11, v86
    v_add_f32 v12, v12, v87
    v_cvt_pk_bf16_f32 v251, v11, v12
    buffer_store_dwordx4 v[248:251], v10, s[16:19], 0 offen sc1
    s_waitcnt lgkmcnt(4)
    v_add_f32 v112, v112, v120
    v_add_f32 v113, v113, v121
    v_add_f32 v114, v114, v122
    v_add_f32 v115, v115, v123
    v_add_f32 v116, v116, v124
    v_add_f32 v117, v117, v125
    v_add_f32 v118, v118, v126
    v_add_f32 v119, v119, v127
    s_waitcnt lgkmcnt(0)
    v_add_f32 v128, v128, v136
    v_add_f32 v129, v129, v137
    v_add_f32 v130, v130, v138
    v_add_f32 v131, v131, v139
    v_add_f32 v132, v132, v140
    v_add_f32 v133, v133, v141
    v_add_f32 v134, v134, v142
    v_add_f32 v135, v135, v143
    v_lshlrev_b32 v11, 16, v252
    v_and_b32 v12, 0xffff0000, v252
    v_add_f32 v112, v112, v128
    v_add_f32 v113, v113, v129
    v_add_f32 v11, v11, v112
    v_add_f32 v12, v12, v113
    v_cvt_pk_bf16_f32 v252, v11, v12
    v_lshlrev_b32 v11, 16, v253
    v_and_b32 v12, 0xffff0000, v253
    v_add_f32 v114, v114, v130
    v_add_f32 v115, v115, v131
    v_add_f32 v11, v11, v114
    v_add_f32 v12, v12, v115
    v_cvt_pk_bf16_f32 v253, v11, v12
    v_lshlrev_b32 v11, 16, v254
    v_and_b32 v12, 0xffff0000, v254
    v_add_f32 v116, v116, v132
    v_add_f32 v117, v117, v133
    v_add_f32 v11, v11, v116
    v_add_f32 v12, v12, v117
    v_cvt_pk_bf16_f32 v254, v11, v12
    v_lshlrev_b32 v11, 16, v255
    v_and_b32 v12, 0xffff0000, v255
    v_add_f32 v118, v118, v134
    v_add_f32 v119, v119, v135
    v_add_f32 v11, v11, v118
    v_add_f32 v12, v12, v119
    v_cvt_pk_bf16_f32 v255, v11, v12
    buffer_store_dwordx4 v[252:255], v10, s[16:19], s37 offen sc1
K3_fin:
K3_end:
    s_endpgm
.section .rodata,"a"
.p2align 6
.amdhsa_kernel k0_kernel
  .amdhsa_next_free_vgpr 168
  .amdhsa_next_free_sgpr 96
  .amdhsa_accum_offset 168
  .amdhsa_group_segment_fixed_size 0
  .amdhsa_kernarg_size 80
  .amdhsa_user_sgpr_count 2
  .amdhsa_user_sgpr_kernarg_segment_ptr 1
  .amdhsa_system_sgpr_workgroup_id_x 1
.end_amdhsa_kernel

.amdhsa_kernel k1_kernel
  .amdhsa_next_free_vgpr 256
  .amdhsa_next_free_sgpr 96
  .amdhsa_accum_offset 256
  .amdhsa_group_segment_fixed_size 0
  .amdhsa_kernarg_size 80
  .amdhsa_user_sgpr_count 2
  .amdhsa_user_sgpr_kernarg_segment_ptr 1
  .amdhsa_system_sgpr_workgroup_id_x 1
.end_amdhsa_kernel

.amdhsa_kernel k3_kernel
  .amdhsa_next_free_vgpr 256
  .amdhsa_next_free_sgpr 96
  .amdhsa_accum_offset 256
  .amdhsa_group_segment_fixed_size 0
  .amdhsa_kernarg_size 80
  .amdhsa_user_sgpr_count 2
  .amdhsa_user_sgpr_kernarg_segment_ptr 1
  .amdhsa_system_sgpr_workgroup_id_x 1
.end_amdhsa_kernel

.p2align 8
.set tc0, 0x3f80
.set tc1, 0x3f80
.set tc2, 0x3f80
.set tc3, 0x3f80
.set tc4, 0x3f80
.set tc5, 0x3f7f
.set tc6, 0x3f7f
.set tc7, 0x3f7f
.set tc8, 0x3f7e
.set tc9, 0x3f7e
.set tc10, 0x3f7d
.set tc11, 0x3f7d
.set tc12, 0x3f7c
.set tc13, 0x3f7c
.set tc14, 0x3f7b
.set tc15, 0x3f7a
.set tc16, 0x3f7a
.set tc17, 0x3f79
.set tc18, 0x3f78
.set tc19, 0x3f77
.set tc20, 0x3f76
.set tc21, 0x3f75
.set tc22, 0x3f74
.set tc23, 0x3f73
.set tc24, 0x3f72
.set tc25, 0x3f70
.set tc26, 0x3f6f
.set tc27, 0x3f6e
.set tc28, 0x3f6d
.set tc29, 0x3f6b
.set tc30, 0x3f6a
.set tc31, 0x3f68
.set tc32, 0x3f67
.set tc33, 0x3f65
.set tc34, 0x3f63
.set tc35, 0x3f62
.set tc36, 0x3f60
.set tc37, 0x3f5e
.set tc38, 0x3f5c
.set tc39, 0x3f5b
.set tc40, 0x3f59
.set tc41, 0x3f57
.set tc42, 0x3f55
.set tc43, 0x3f53
.set tc44, 0x3f51
.set tc45, 0x3f4f
.set tc46, 0x3f4d
.set tc47, 0x3f4a
.set tc48, 0x3f48
.set tc49, 0x3f46
.set tc50, 0x3f44
.set tc51, 0x3f41
.set tc52, 0x3f3f
.set tc53, 0x3f3c
.set tc54, 0x3f3a
.set tc55, 0x3f38
.set tc56, 0x3f35
.set tc57, 0x3f32
.set tc58, 0x3f30
.set tc59, 0x3f2d
.set tc60, 0x3f2b
.set tc61, 0x3f28
.set tc62, 0x3f25
.set tc63, 0x3f22
.set tc64, 0x3f20
.set tc65, 0x3f1d
.set tc66, 0x3f1a
.set tc67, 0x3f17
.set tc68, 0x3f14
.set tc69, 0x3f11
.set tc70, 0x3f0e
.set tc71, 0x3f0b
.set tc72, 0x3f08
.set tc73, 0x3f05
.set tc74, 0x3f02
.set tc75, 0x3efe
.set tc76, 0x3ef8
.set tc77, 0x3ef1
.set tc78, 0x3eeb
.set tc79, 0x3ee5
.set tc80, 0x3ede
.set tc81, 0x3ed8
.set tc82, 0x3ed1
.set tc83, 0x3ecb
.set tc84, 0x3ec4
.set tc85, 0x3ebd
.set tc86, 0x3eb7
.set tc87, 0x3eb0
.set tc88, 0x3ea9
.set tc89, 0x3ea2
.set tc90, 0x3e9b
.set tc91, 0x3e95
.set tc92, 0x3e8e
.set tc93, 0x3e87
.set tc94, 0x3e80
.set tc95, 0x3e72
.set tc96, 0x3e64
.set tc97, 0x3e56
.set tc98, 0x3e48
.set tc99, 0x3e3a
.set tc100, 0x3e2c
.set tc101, 0x3e1d
.set tc102, 0x3e0f
.set tc103, 0x3e01
.set tc104, 0x3de5
.set tc105, 0x3dc9
.set tc106, 0x3dac
.set tc107, 0x3d8f
.set tc108, 0x3d66
.set tc109, 0x3d2c
.set tc110, 0x3ce6
.set tc111, 0x3c66
.set tc112, 0x248d
.set tc113, 0xbc66
.set tc114, 0xbce6
.set tc115, 0xbd2c
.set tc116, 0xbd66
.set tc117, 0xbd8f
.set tc118, 0xbdac
.set tc119, 0xbdc9
.set tc120, 0xbde5
.set tc121, 0xbe01
.set tc122, 0xbe0f
.set tc123, 0xbe1d
.set tc124, 0xbe2c
.set tc125, 0xbe3a
.set tc126, 0xbe48
.set tc127, 0xbe56
.set tc128, 0xbe64
.set tc129, 0xbe72
.set tc130, 0xbe80
.set tc131, 0xbe87
.set tc132, 0xbe8e
.set tc133, 0xbe95
.set tc134, 0xbe9b
.set tc135, 0xbea2
.set tc136, 0xbea9
.set tc137, 0xbeb0
.set tc138, 0xbeb7
.set tc139, 0xbebd
.set tc140, 0xbec4
.set tc141, 0xbecb
.set tc142, 0xbed1
.set tc143, 0xbed8
.set tc144, 0xbede
.set tc145, 0xbee5
.set tc146, 0xbeeb
.set tc147, 0xbef1
.set tc148, 0xbef8
.set tc149, 0xbefe
.set tc150, 0xbf02
.set tc151, 0xbf05
.set tc152, 0xbf08
.set tc153, 0xbf0b
.set tc154, 0xbf0e
.set tc155, 0xbf11
.set tc156, 0xbf14
.set tc157, 0xbf17
.set tc158, 0xbf1a
.set tc159, 0xbf1d
.set tc160, 0xbf20
.set tc161, 0xbf22
.set tc162, 0xbf25
.set tc163, 0xbf28
.set tc164, 0xbf2b
.set tc165, 0xbf2d
.set tc166, 0xbf30
.set tc167, 0xbf32
.set tc168, 0xbf35
.set tc169, 0xbf38
.set tc170, 0xbf3a
.set tc171, 0xbf3c
.set tc172, 0xbf3f
.set tc173, 0xbf41
.set tc174, 0xbf44
.set tc175, 0xbf46
.set tc176, 0xbf48
.set tc177, 0xbf4a
.set tc178, 0xbf4d
.set tc179, 0xbf4f
.set tc180, 0xbf51
.set tc181, 0xbf53
.set tc182, 0xbf55
.set tc183, 0xbf57
.set tc184, 0xbf59
.set tc185, 0xbf5b
.set tc186, 0xbf5c
.set tc187, 0xbf5e
.set tc188, 0xbf60
.set tc189, 0xbf62
.set tc190, 0xbf63
.set tc191, 0xbf65
.set tc192, 0xbf67
.set tc193, 0xbf68
.set tc194, 0xbf6a
.set tc195, 0xbf6b
.set tc196, 0xbf6d
.set tc197, 0xbf6e
.set tc198, 0xbf6f
.set tc199, 0xbf70
.set tc200, 0xbf72
.set tc201, 0xbf73
.set tc202, 0xbf74
.set tc203, 0xbf75
.set tc204, 0xbf76
.set tc205, 0xbf77
.set tc206, 0xbf78
.set tc207, 0xbf79
.set tc208, 0xbf7a
.set tc209, 0xbf7a
.set tc210, 0xbf7b
.set tc211, 0xbf7c
.set tc212, 0xbf7c
.set tc213, 0xbf7d
.set tc214, 0xbf7d
.set tc215, 0xbf7e
.set tc216, 0xbf7e
.set tc217, 0xbf7f
.set tc218, 0xbf7f
.set tc219, 0xbf7f
.set tc220, 0xbf80
.set tc221, 0xbf80
.set tc222, 0xbf80
.set tc223, 0xbf80
.set tc224, 0xbf80
.set tc225, 0xbf80
.set tc226, 0xbf80
.set tc227, 0xbf80
.set tc228, 0xbf80
.set tc229, 0xbf7f
.set tc230, 0xbf7f
.set tc231, 0xbf7f
.set tc232, 0xbf7e
.set tc233, 0xbf7e
.set tc234, 0xbf7d
.set tc235, 0xbf7d
.set tc236, 0xbf7c
.set tc237, 0xbf7c
.set tc238, 0xbf7b
.set tc239, 0xbf7a
.set tc240, 0xbf7a
.set tc241, 0xbf79
.set tc242, 0xbf78
.set tc243, 0xbf77
.set tc244, 0xbf76
.set tc245, 0xbf75
.set tc246, 0xbf74
.set tc247, 0xbf73
.set tc248, 0xbf72
.set tc249, 0xbf70
.set tc250, 0xbf6f
.set tc251, 0xbf6e
.set tc252, 0xbf6d
.set tc253, 0xbf6b
.set tc254, 0xbf6a
.set tc255, 0xbf68
.set tc256, 0xbf67
.set tc257, 0xbf65
.set tc258, 0xbf63
.set tc259, 0xbf62
.set tc260, 0xbf60
.set tc261, 0xbf5e
.set tc262, 0xbf5c
.set tc263, 0xbf5b
.set tc264, 0xbf59
.set tc265, 0xbf57
.set tc266, 0xbf55
.set tc267, 0xbf53
.set tc268, 0xbf51
.set tc269, 0xbf4f
.set tc270, 0xbf4d
.set tc271, 0xbf4a
.set tc272, 0xbf48
.set tc273, 0xbf46
.set tc274, 0xbf44
.set tc275, 0xbf41
.set tc276, 0xbf3f
.set tc277, 0xbf3c
.set tc278, 0xbf3a
.set tc279, 0xbf38
.set tc280, 0xbf35
.set tc281, 0xbf32
.set tc282, 0xbf30
.set tc283, 0xbf2d
.set tc284, 0xbf2b
.set tc285, 0xbf28
.set tc286, 0xbf25
.set tc287, 0xbf22
.set tc288, 0xbf20
.set tc289, 0xbf1d
.set tc290, 0xbf1a
.set tc291, 0xbf17
.set tc292, 0xbf14
.set tc293, 0xbf11
.set tc294, 0xbf0e
.set tc295, 0xbf0b
.set tc296, 0xbf08
.set tc297, 0xbf05
.set tc298, 0xbf02
.set tc299, 0xbefe
.set tc300, 0xbef8
.set tc301, 0xbef1
.set tc302, 0xbeeb
.set tc303, 0xbee5
.set tc304, 0xbede
.set tc305, 0xbed8
.set tc306, 0xbed1
.set tc307, 0xbecb
.set tc308, 0xbec4
.set tc309, 0xbebd
.set tc310, 0xbeb7
.set tc311, 0xbeb0
.set tc312, 0xbea9
.set tc313, 0xbea2
.set tc314, 0xbe9b
.set tc315, 0xbe95
.set tc316, 0xbe8e
.set tc317, 0xbe87
.set tc318, 0xbe80
.set tc319, 0xbe72
.set tc320, 0xbe64
.set tc321, 0xbe56
.set tc322, 0xbe48
.set tc323, 0xbe3a
.set tc324, 0xbe2c
.set tc325, 0xbe1d
.set tc326, 0xbe0f
.set tc327, 0xbe01
.set tc328, 0xbde5
.set tc329, 0xbdc9
.set tc330, 0xbdac
.set tc331, 0xbd8f
.set tc332, 0xbd66
.set tc333, 0xbd2c
.set tc334, 0xbce6
.set tc335, 0xbc66
.set tc336, 0xa554
.set tc337, 0x3c66
.set tc338, 0x3ce6
.set tc339, 0x3d2c
.set tc340, 0x3d66
.set tc341, 0x3d8f
.set tc342, 0x3dac
.set tc343, 0x3dc9
.set tc344, 0x3de5
.set tc345, 0x3e01
.set tc346, 0x3e0f
.set tc347, 0x3e1d
.set tc348, 0x3e2c
.set tc349, 0x3e3a
.set tc350, 0x3e48
.set tc351, 0x3e56
.set tc352, 0x3e64
.set tc353, 0x3e72
.set tc354, 0x3e80
.set tc355, 0x3e87
.set tc356, 0x3e8e
.set tc357, 0x3e95
.set tc358, 0x3e9b
.set tc359, 0x3ea2
.set tc360, 0x3ea9
.set tc361, 0x3eb0
.set tc362, 0x3eb7
.set tc363, 0x3ebd
.set tc364, 0x3ec4
.set tc365, 0x3ecb
.set tc366, 0x3ed1
.set tc367, 0x3ed8
.set tc368, 0x3ede
.set tc369, 0x3ee5
.set tc370, 0x3eeb
.set tc371, 0x3ef1
.set tc372, 0x3ef8
.set tc373, 0x3efe
.set tc374, 0x3f02
.set tc375, 0x3f05
.set tc376, 0x3f08
.set tc377, 0x3f0b
.set tc378, 0x3f0e
.set tc379, 0x3f11
.set tc380, 0x3f14
.set tc381, 0x3f17
.set tc382, 0x3f1a
.set tc383, 0x3f1d
.set tc384, 0x3f20
.set tc385, 0x3f22
.set tc386, 0x3f25
.set tc387, 0x3f28
.set tc388, 0x3f2b
.set tc389, 0x3f2d
.set tc390, 0x3f30
.set tc391, 0x3f32
.set tc392, 0x3f35
.set tc393, 0x3f38
.set tc394, 0x3f3a
.set tc395, 0x3f3c
.set tc396, 0x3f3f
.set tc397, 0x3f41
.set tc398, 0x3f44
.set tc399, 0x3f46
.set tc400, 0x3f48
.set tc401, 0x3f4a
.set tc402, 0x3f4d
.set tc403, 0x3f4f
.set tc404, 0x3f51
.set tc405, 0x3f53
.set tc406, 0x3f55
.set tc407, 0x3f57
.set tc408, 0x3f59
.set tc409, 0x3f5b
.set tc410, 0x3f5c
.set tc411, 0x3f5e
.set tc412, 0x3f60
.set tc413, 0x3f62
.set tc414, 0x3f63
.set tc415, 0x3f65
.set tc416, 0x3f67
.set tc417, 0x3f68
.set tc418, 0x3f6a
.set tc419, 0x3f6b
.set tc420, 0x3f6d
.set tc421, 0x3f6e
.set tc422, 0x3f6f
.set tc423, 0x3f70
.set tc424, 0x3f72
.set tc425, 0x3f73
.set tc426, 0x3f74
.set tc427, 0x3f75
.set tc428, 0x3f76
.set tc429, 0x3f77
.set tc430, 0x3f78
.set tc431, 0x3f79
.set tc432, 0x3f7a
.set tc433, 0x3f7a
.set tc434, 0x3f7b
.set tc435, 0x3f7c
.set tc436, 0x3f7c
.set tc437, 0x3f7d
.set tc438, 0x3f7d
.set tc439, 0x3f7e
.set tc440, 0x3f7e
.set tc441, 0x3f7f
.set tc442, 0x3f7f
.set tc443, 0x3f7f
.set tc444, 0x3f80
.set tc445, 0x3f80
.set tc446, 0x3f80
.set tc447, 0x3f80
.altmacro
.macro t1emit i
.short tc\i
.endm
.p2align 8
.type t1tab,@object
t1tab:
.set t1_ct, 0
.rept 8
.set t1_p, 0
.rept 2
.set t1_t, 0
.rept 14
.set t1_l, 0
.rept 64
.set t1_n, 32*t1_ct + (t1_l & 31)
.set t1_d, 2*(16*t1_t + 8*(t1_l >> 5)) + t1_p
.rept 8
.if t1_n < 226
t1emit %((t1_d * (t1_n >> 1) + 112 * (t1_n & 1)) % 448)
.else
.short 0
.endif
.set t1_d, t1_d + 2
.endr
.set t1_l, t1_l + 1
.endr
.set t1_t, t1_t + 1
.endr
.set t1_p, t1_p + 1
.endr
.set t1_ct, t1_ct + 1
.endr
.noaltmacro
.set tg2_0, 0x3612
.set tg1_0, 0x3592
.set tg2_1, 0x3612
.set tg1_1, 0x3592
.set tg2_2, 0x3612
.set tg1_2, 0x3592
.set tg2_3, 0x3612
.set tg1_3, 0x3592
.set tg2_4, 0x3612
.set tg1_4, 0x3592
.set tg2_5, 0x3612
.set tg1_5, 0x3592
.set tg2_6, 0x3612
.set tg1_6, 0x3592
.set tg2_7, 0x3612
.set tg1_7, 0x3592
.set tg2_8, 0x3611
.set tg1_8, 0x3591
.set tg2_9, 0x3611
.set tg1_9, 0x3591
.set tg2_10, 0x3611
.set tg1_10, 0x3591
.set tg2_11, 0x3611
.set tg1_11, 0x3591
.set tg2_12, 0x3610
.set tg1_12, 0x3590
.set tg2_13, 0x3610
.set tg1_13, 0x3590
.set tg2_14, 0x360f
.set tg1_14, 0x358f
.set tg2_15, 0x360f
.set tg1_15, 0x358f
.set tg2_16, 0x360f
.set tg1_16, 0x358f
.set tg2_17, 0x360e
.set tg1_17, 0x358e
.set tg2_18, 0x360e
.set tg1_18, 0x358e
.set tg2_19, 0x360d
.set tg1_19, 0x358d
.set tg2_20, 0x360d
.set tg1_20, 0x358d
.set tg2_21, 0x360c
.set tg1_21, 0x358c
.set tg2_22, 0x360b
.set tg1_22, 0x358b
.set tg2_23, 0x360b
.set tg1_23, 0x358b
.set tg2_24, 0x360a
.set tg1_24, 0x358a
.set tg2_25, 0x3609
.set tg1_25, 0x3589
.set tg2_26, 0x3609
.set tg1_26, 0x3589
.set tg2_27, 0x3608
.set tg1_27, 0x3588
.set tg2_28, 0x3607
.set tg1_28, 0x3587
.set tg2_29, 0x3606
.set tg1_29, 0x3586
.set tg2_30, 0x3606
.set tg1_30, 0x3586
.set tg2_31, 0x3605
.set tg1_31, 0x3585
.set tg2_32, 0x3604
.set tg1_32, 0x3584
.set tg2_33, 0x3603
.set tg1_33, 0x3583
.set tg2_34, 0x3602
.set tg1_34, 0x3582
.set tg2_35, 0x3601
.set tg1_35, 0x3581
.set tg2_36, 0x3600
.set tg1_36, 0x3580
.set tg2_37, 0x35fe
.set tg1_37, 0x357e
.set tg2_38, 0x35fc
.set tg1_38, 0x357c
.set tg2_39, 0x35fa
.set tg1_39, 0x357a
.set tg2_40, 0x35f8
.set tg1_40, 0x3578
.set tg2_41, 0x35f6
.set tg1_41, 0x3576
.set tg2_42, 0x35f3
.set tg1_42, 0x3573
.set tg2_43, 0x35f1
.set tg1_43, 0x3571
.set tg2_44, 0x35ef
.set tg1_44, 0x356f
.set tg2_45, 0x35ec
.set tg1_45, 0x356c
.set tg2_46, 0x35ea
.set tg1_46, 0x356a
.set tg2_47, 0x35e7
.set tg1_47, 0x3567
.set tg2_48, 0x35e5
.set tg1_48, 0x3565
.set tg2_49, 0x35e2
.set tg1_49, 0x3562
.set tg2_50, 0x35e0
.set tg1_50, 0x3560
.set tg2_51, 0x35dd
.set tg1_51, 0x355d
.set tg2_52, 0x35da
.set tg1_52, 0x355a
.set tg2_53, 0x35d7
.set tg1_53, 0x3557
.set tg2_54, 0x35d5
.set tg1_54, 0x3555
.set tg2_55, 0x35d2
.set tg1_55, 0x3552
.set tg2_56, 0x35cf
.set tg1_56, 0x354f
.set tg2_57, 0x35cc
.set tg1_57, 0x354c
.set tg2_58, 0x35c9
.set tg1_58, 0x3549
.set tg2_59, 0x35c6
.set tg1_59, 0x3546
.set tg2_60, 0x35c3
.set tg1_60, 0x3543
.set tg2_61, 0x35c0
.set tg1_61, 0x3540
.set tg2_62, 0x35bd
.set tg1_62, 0x353d
.set tg2_63, 0x35ba
.set tg1_63, 0x353a
.set tg2_64, 0x35b6
.set tg1_64, 0x3536
.set tg2_65, 0x35b3
.set tg1_65, 0x3533
.set tg2_66, 0x35b0
.set tg1_66, 0x3530
.set tg2_67, 0x35ad
.set tg1_67, 0x352d
.set tg2_68, 0x35a9
.set tg1_68, 0x3529
.set tg2_69, 0x35a6
.set tg1_69, 0x3526
.set tg2_70, 0x35a3
.set tg1_70, 0x3523
.set tg2_71, 0x359f
.set tg1_71, 0x351f
.set tg2_72, 0x359c
.set tg1_72, 0x351c
.set tg2_73, 0x3598
.set tg1_73, 0x3518
.set tg2_74, 0x3595
.set tg1_74, 0x3515
.set tg2_75, 0x3591
.set tg1_75, 0x3511
.set tg2_76, 0x358e
.set tg1_76, 0x350e
.set tg2_77, 0x358a
.set tg1_77, 0x350a
.set tg2_78, 0x3586
.set tg1_78, 0x3506
.set tg2_79, 0x3583
.set tg1_79, 0x3503
.set tg2_80, 0x357e
.set tg1_80, 0x34fe
.set tg2_81, 0x3576
.set tg1_81, 0x34f6
.set tg2_82, 0x356f
.set tg1_82, 0x34ef
.set tg2_83, 0x3567
.set tg1_83, 0x34e7
.set tg2_84, 0x3560
.set tg1_84, 0x34e0
.set tg2_85, 0x3558
.set tg1_85, 0x34d8
.set tg2_86, 0x3551
.set tg1_86, 0x34d1
.set tg2_87, 0x3549
.set tg1_87, 0x34c9
.set tg2_88, 0x3541
.set tg1_88, 0x34c1
.set tg2_89, 0x3539
.set tg1_89, 0x34b9
.set tg2_90, 0x3532
.set tg1_90, 0x34b2
.set tg2_91, 0x352a
.set tg1_91, 0x34aa
.set tg2_92, 0x3522
.set tg1_92, 0x34a2
.set tg2_93, 0x351a
.set tg1_93, 0x349a
.set tg2_94, 0x3512
.set tg1_94, 0x3492
.set tg2_95, 0x350a
.set tg1_95, 0x348a
.set tg2_96, 0x3502
.set tg1_96, 0x3482
.set tg2_97, 0x34f4
.set tg1_97, 0x3474
.set tg2_98, 0x34e4
.set tg1_98, 0x3464
.set tg2_99, 0x34d4
.set tg1_99, 0x3454
.set tg2_100, 0x34c4
.set tg1_100, 0x3444
.set tg2_101, 0x34b4
.set tg1_101, 0x3434
.set tg2_102, 0x34a4
.set tg1_102, 0x3424
.set tg2_103, 0x3493
.set tg1_103, 0x3413
.set tg2_104, 0x3483
.set tg1_104, 0x3403
.set tg2_105, 0x3465
.set tg1_105, 0x33e5
.set tg2_106, 0x3445
.set tg1_106, 0x33c5
.set tg2_107, 0x3424
.set tg1_107, 0x33a4
.set tg2_108, 0x3403
.set tg1_108, 0x3383
.set tg2_109, 0x33c5
.set tg1_109, 0x3345
.set tg2_110, 0x3383
.set tg1_110, 0x3303
.set tg2_111, 0x3303
.set tg1_111, 0x3283
.set tg2_112, 0x1b21
.set tg1_112, 0x1aa1
.set tg2_113, 0xb303
.set tg1_113, 0xb283
.set tg2_114, 0xb383
.set tg1_114, 0xb303
.set tg2_115, 0xb3c5
.set tg1_115, 0xb345
.set tg2_116, 0xb403
.set tg1_116, 0xb383
.set tg2_117, 0xb424
.set tg1_117, 0xb3a4
.set tg2_118, 0xb445
.set tg1_118, 0xb3c5
.set tg2_119, 0xb465
.set tg1_119, 0xb3e5
.set tg2_120, 0xb483
.set tg1_120, 0xb403
.set tg2_121, 0xb493
.set tg1_121, 0xb413
.set tg2_122, 0xb4a4
.set tg1_122, 0xb424
.set tg2_123, 0xb4b4
.set tg1_123, 0xb434
.set tg2_124, 0xb4c4
.set tg1_124, 0xb444
.set tg2_125, 0xb4d4
.set tg1_125, 0xb454
.set tg2_126, 0xb4e4
.set tg1_126, 0xb464
.set tg2_127, 0xb4f4
.set tg1_127, 0xb474
.set tg2_128, 0xb502
.set tg1_128, 0xb482
.set tg2_129, 0xb50a
.set tg1_129, 0xb48a
.set tg2_130, 0xb512
.set tg1_130, 0xb492
.set tg2_131, 0xb51a
.set tg1_131, 0xb49a
.set tg2_132, 0xb522
.set tg1_132, 0xb4a2
.set tg2_133, 0xb52a
.set tg1_133, 0xb4aa
.set tg2_134, 0xb532
.set tg1_134, 0xb4b2
.set tg2_135, 0xb539
.set tg1_135, 0xb4b9
.set tg2_136, 0xb541
.set tg1_136, 0xb4c1
.set tg2_137, 0xb549
.set tg1_137, 0xb4c9
.set tg2_138, 0xb551
.set tg1_138, 0xb4d1
.set tg2_139, 0xb558
.set tg1_139, 0xb4d8
.set tg2_140, 0xb560
.set tg1_140, 0xb4e0
.set tg2_141, 0xb567
.set tg1_141, 0xb4e7
.set tg2_142, 0xb56f
.set tg1_142, 0xb4ef
.set tg2_143, 0xb576
.set tg1_143, 0xb4f6
.set tg2_144, 0xb57e
.set tg1_144, 0xb4fe
.set tg2_145, 0xb583
.set tg1_145, 0xb503
.set tg2_146, 0xb586
.set tg1_146, 0xb506
.set tg2_147, 0xb58a
.set tg1_147, 0xb50a
.set tg2_148, 0xb58e
.set tg1_148, 0xb50e
.set tg2_149, 0xb591
.set tg1_149, 0xb511
.set tg2_150, 0xb595
.set tg1_150, 0xb515
.set tg2_151, 0xb598
.set tg1_151, 0xb518
.set tg2_152, 0xb59c
.set tg1_152, 0xb51c
.set tg2_153, 0xb59f
.set tg1_153, 0xb51f
.set tg2_154, 0xb5a3
.set tg1_154, 0xb523
.set tg2_155, 0xb5a6
.set tg1_155, 0xb526
.set tg2_156, 0xb5a9
.set tg1_156, 0xb529
.set tg2_157, 0xb5ad
.set tg1_157, 0xb52d
.set tg2_158, 0xb5b0
.set tg1_158, 0xb530
.set tg2_159, 0xb5b3
.set tg1_159, 0xb533
.set tg2_160, 0xb5b6
.set tg1_160, 0xb536
.set tg2_161, 0xb5ba
.set tg1_161, 0xb53a
.set tg2_162, 0xb5bd
.set tg1_162, 0xb53d
.set tg2_163, 0xb5c0
.set tg1_163, 0xb540
.set tg2_164, 0xb5c3
.set tg1_164, 0xb543
.set tg2_165, 0xb5c6
.set tg1_165, 0xb546
.set tg2_166, 0xb5c9
.set tg1_166, 0xb549
.set tg2_167, 0xb5cc
.set tg1_167, 0xb54c
.set tg2_168, 0xb5cf
.set tg1_168, 0xb54f
.set tg2_169, 0xb5d2
.set tg1_169, 0xb552
.set tg2_170, 0xb5d5
.set tg1_170, 0xb555
.set tg2_171, 0xb5d7
.set tg1_171, 0xb557
.set tg2_172, 0xb5da
.set tg1_172, 0xb55a
.set tg2_173, 0xb5dd
.set tg1_173, 0xb55d
.set tg2_174, 0xb5e0
.set tg1_174, 0xb560
.set tg2_175, 0xb5e2
.set tg1_175, 0xb562
.set tg2_176, 0xb5e5
.set tg1_176, 0xb565
.set tg2_177, 0xb5e7
.set tg1_177, 0xb567
.set tg2_178, 0xb5ea
.set tg1_178, 0xb56a
.set tg2_179, 0xb5ec
.set tg1_179, 0xb56c
.set tg2_180, 0xb5ef
.set tg1_180, 0xb56f
.set tg2_181, 0xb5f1
.set tg1_181, 0xb571
.set tg2_182, 0xb5f3
.set tg1_182, 0xb573
.set tg2_183, 0xb5f6
.set tg1_183, 0xb576
.set tg2_184, 0xb5f8
.set tg1_184, 0xb578
.set tg2_185, 0xb5fa
.set tg1_185, 0xb57a
.set tg2_186, 0xb5fc
.set tg1_186, 0xb57c
.set tg2_187, 0xb5fe
.set tg1_187, 0xb57e
.set tg2_188, 0xb600
.set tg1_188, 0xb580
.set tg2_189, 0xb601
.set tg1_189, 0xb581
.set tg2_190, 0xb602
.set tg1_190, 0xb582
.set tg2_191, 0xb603
.set tg1_191, 0xb583
.set tg2_192, 0xb604
.set tg1_192, 0xb584
.set tg2_193, 0xb605
.set tg1_193, 0xb585
.set tg2_194, 0xb606
.set tg1_194, 0xb586
.set tg2_195, 0xb606
.set tg1_195, 0xb586
.set tg2_196, 0xb607
.set tg1_196, 0xb587
.set tg2_197, 0xb608
.set tg1_197, 0xb588
.set tg2_198, 0xb609
.set tg1_198, 0xb589
.set tg2_199, 0xb609
.set tg1_199, 0xb589
.set tg2_200, 0xb60a
.set tg1_200, 0xb58a
.set tg2_201, 0xb60b
.set tg1_201, 0xb58b
.set tg2_202, 0xb60b
.set tg1_202, 0xb58b
.set tg2_203, 0xb60c
.set tg1_203, 0xb58c
.set tg2_204, 0xb60d
.set tg1_204, 0xb58d
.set tg2_205, 0xb60d
.set tg1_205, 0xb58d
.set tg2_206, 0xb60e
.set tg1_206, 0xb58e
.set tg2_207, 0xb60e
.set tg1_207, 0xb58e
.set tg2_208, 0xb60f
.set tg1_208, 0xb58f
.set tg2_209, 0xb60f
.set tg1_209, 0xb58f
.set tg2_210, 0xb60f
.set tg1_210, 0xb58f
.set tg2_211, 0xb610
.set tg1_211, 0xb590
.set tg2_212, 0xb610
.set tg1_212, 0xb590
.set tg2_213, 0xb611
.set tg1_213, 0xb591
.set tg2_214, 0xb611
.set tg1_214, 0xb591
.set tg2_215, 0xb611
.set tg1_215, 0xb591
.set tg2_216, 0xb611
.set tg1_216, 0xb591
.set tg2_217, 0xb612
.set tg1_217, 0xb592
.set tg2_218, 0xb612
.set tg1_218, 0xb592
.set tg2_219, 0xb612
.set tg1_219, 0xb592
.set tg2_220, 0xb612
.set tg1_220, 0xb592
.set tg2_221, 0xb612
.set tg1_221, 0xb592
.set tg2_222, 0xb612
.set tg1_222, 0xb592
.set tg2_223, 0xb612
.set tg1_223, 0xb592
.set tg2_224, 0xb612
.set tg1_224, 0xb592
.set tg2_225, 0xb612
.set tg1_225, 0xb592
.set tg2_226, 0xb612
.set tg1_226, 0xb592
.set tg2_227, 0xb612
.set tg1_227, 0xb592
.set tg2_228, 0xb612
.set tg1_228, 0xb592
.set tg2_229, 0xb612
.set tg1_229, 0xb592
.set tg2_230, 0xb612
.set tg1_230, 0xb592
.set tg2_231, 0xb612
.set tg1_231, 0xb592
.set tg2_232, 0xb611
.set tg1_232, 0xb591
.set tg2_233, 0xb611
.set tg1_233, 0xb591
.set tg2_234, 0xb611
.set tg1_234, 0xb591
.set tg2_235, 0xb611
.set tg1_235, 0xb591
.set tg2_236, 0xb610
.set tg1_236, 0xb590
.set tg2_237, 0xb610
.set tg1_237, 0xb590
.set tg2_238, 0xb60f
.set tg1_238, 0xb58f
.set tg2_239, 0xb60f
.set tg1_239, 0xb58f
.set tg2_240, 0xb60f
.set tg1_240, 0xb58f
.set tg2_241, 0xb60e
.set tg1_241, 0xb58e
.set tg2_242, 0xb60e
.set tg1_242, 0xb58e
.set tg2_243, 0xb60d
.set tg1_243, 0xb58d
.set tg2_244, 0xb60d
.set tg1_244, 0xb58d
.set tg2_245, 0xb60c
.set tg1_245, 0xb58c
.set tg2_246, 0xb60b
.set tg1_246, 0xb58b
.set tg2_247, 0xb60b
.set tg1_247, 0xb58b
.set tg2_248, 0xb60a
.set tg1_248, 0xb58a
.set tg2_249, 0xb609
.set tg1_249, 0xb589
.set tg2_250, 0xb609
.set tg1_250, 0xb589
.set tg2_251, 0xb608
.set tg1_251, 0xb588
.set tg2_252, 0xb607
.set tg1_252, 0xb587
.set tg2_253, 0xb606
.set tg1_253, 0xb586
.set tg2_254, 0xb606
.set tg1_254, 0xb586
.set tg2_255, 0xb605
.set tg1_255, 0xb585
.set tg2_256, 0xb604
.set tg1_256, 0xb584
.set tg2_257, 0xb603
.set tg1_257, 0xb583
.set tg2_258, 0xb602
.set tg1_258, 0xb582
.set tg2_259, 0xb601
.set tg1_259, 0xb581
.set tg2_260, 0xb600
.set tg1_260, 0xb580
.set tg2_261, 0xb5fe
.set tg1_261, 0xb57e
.set tg2_262, 0xb5fc
.set tg1_262, 0xb57c
.set tg2_263, 0xb5fa
.set tg1_263, 0xb57a
.set tg2_264, 0xb5f8
.set tg1_264, 0xb578
.set tg2_265, 0xb5f6
.set tg1_265, 0xb576
.set tg2_266, 0xb5f3
.set tg1_266, 0xb573
.set tg2_267, 0xb5f1
.set tg1_267, 0xb571
.set tg2_268, 0xb5ef
.set tg1_268, 0xb56f
.set tg2_269, 0xb5ec
.set tg1_269, 0xb56c
.set tg2_270, 0xb5ea
.set tg1_270, 0xb56a
.set tg2_271, 0xb5e7
.set tg1_271, 0xb567
.set tg2_272, 0xb5e5
.set tg1_272, 0xb565
.set tg2_273, 0xb5e2
.set tg1_273, 0xb562
.set tg2_274, 0xb5e0
.set tg1_274, 0xb560
.set tg2_275, 0xb5dd
.set tg1_275, 0xb55d
.set tg2_276, 0xb5da
.set tg1_276, 0xb55a
.set tg2_277, 0xb5d7
.set tg1_277, 0xb557
.set tg2_278, 0xb5d5
.set tg1_278, 0xb555
.set tg2_279, 0xb5d2
.set tg1_279, 0xb552
.set tg2_280, 0xb5cf
.set tg1_280, 0xb54f
.set tg2_281, 0xb5cc
.set tg1_281, 0xb54c
.set tg2_282, 0xb5c9
.set tg1_282, 0xb549
.set tg2_283, 0xb5c6
.set tg1_283, 0xb546
.set tg2_284, 0xb5c3
.set tg1_284, 0xb543
.set tg2_285, 0xb5c0
.set tg1_285, 0xb540
.set tg2_286, 0xb5bd
.set tg1_286, 0xb53d
.set tg2_287, 0xb5ba
.set tg1_287, 0xb53a
.set tg2_288, 0xb5b6
.set tg1_288, 0xb536
.set tg2_289, 0xb5b3
.set tg1_289, 0xb533
.set tg2_290, 0xb5b0
.set tg1_290, 0xb530
.set tg2_291, 0xb5ad
.set tg1_291, 0xb52d
.set tg2_292, 0xb5a9
.set tg1_292, 0xb529
.set tg2_293, 0xb5a6
.set tg1_293, 0xb526
.set tg2_294, 0xb5a3
.set tg1_294, 0xb523
.set tg2_295, 0xb59f
.set tg1_295, 0xb51f
.set tg2_296, 0xb59c
.set tg1_296, 0xb51c
.set tg2_297, 0xb598
.set tg1_297, 0xb518
.set tg2_298, 0xb595
.set tg1_298, 0xb515
.set tg2_299, 0xb591
.set tg1_299, 0xb511
.set tg2_300, 0xb58e
.set tg1_300, 0xb50e
.set tg2_301, 0xb58a
.set tg1_301, 0xb50a
.set tg2_302, 0xb586
.set tg1_302, 0xb506
.set tg2_303, 0xb583
.set tg1_303, 0xb503
.set tg2_304, 0xb57e
.set tg1_304, 0xb4fe
.set tg2_305, 0xb576
.set tg1_305, 0xb4f6
.set tg2_306, 0xb56f
.set tg1_306, 0xb4ef
.set tg2_307, 0xb567
.set tg1_307, 0xb4e7
.set tg2_308, 0xb560
.set tg1_308, 0xb4e0
.set tg2_309, 0xb558
.set tg1_309, 0xb4d8
.set tg2_310, 0xb551
.set tg1_310, 0xb4d1
.set tg2_311, 0xb549
.set tg1_311, 0xb4c9
.set tg2_312, 0xb541
.set tg1_312, 0xb4c1
.set tg2_313, 0xb539
.set tg1_313, 0xb4b9
.set tg2_314, 0xb532
.set tg1_314, 0xb4b2
.set tg2_315, 0xb52a
.set tg1_315, 0xb4aa
.set tg2_316, 0xb522
.set tg1_316, 0xb4a2
.set tg2_317, 0xb51a
.set tg1_317, 0xb49a
.set tg2_318, 0xb512
.set tg1_318, 0xb492
.set tg2_319, 0xb50a
.set tg1_319, 0xb48a
.set tg2_320, 0xb502
.set tg1_320, 0xb482
.set tg2_321, 0xb4f4
.set tg1_321, 0xb474
.set tg2_322, 0xb4e4
.set tg1_322, 0xb464
.set tg2_323, 0xb4d4
.set tg1_323, 0xb454
.set tg2_324, 0xb4c4
.set tg1_324, 0xb444
.set tg2_325, 0xb4b4
.set tg1_325, 0xb434
.set tg2_326, 0xb4a4
.set tg1_326, 0xb424
.set tg2_327, 0xb493
.set tg1_327, 0xb413
.set tg2_328, 0xb483
.set tg1_328, 0xb403
.set tg2_329, 0xb465
.set tg1_329, 0xb3e5
.set tg2_330, 0xb445
.set tg1_330, 0xb3c5
.set tg2_331, 0xb424
.set tg1_331, 0xb3a4
.set tg2_332, 0xb403
.set tg1_332, 0xb383
.set tg2_333, 0xb3c5
.set tg1_333, 0xb345
.set tg2_334, 0xb383
.set tg1_334, 0xb303
.set tg2_335, 0xb303
.set tg1_335, 0xb283
.set tg2_336, 0x9bf2
.set tg1_336, 0x9b72
.set tg2_337, 0x3303
.set tg1_337, 0x3283
.set tg2_338, 0x3383
.set tg1_338, 0x3303
.set tg2_339, 0x33c5
.set tg1_339, 0x3345
.set tg2_340, 0x3403
.set tg1_340, 0x3383
.set tg2_341, 0x3424
.set tg1_341, 0x33a4
.set tg2_342, 0x3445
.set tg1_342, 0x33c5
.set tg2_343, 0x3465
.set tg1_343, 0x33e5
.set tg2_344, 0x3483
.set tg1_344, 0x3403
.set tg2_345, 0x3493
.set tg1_345, 0x3413
.set tg2_346, 0x34a4
.set tg1_346, 0x3424
.set tg2_347, 0x34b4
.set tg1_347, 0x3434
.set tg2_348, 0x34c4
.set tg1_348, 0x3444
.set tg2_349, 0x34d4
.set tg1_349, 0x3454
.set tg2_350, 0x34e4
.set tg1_350, 0x3464
.set tg2_351, 0x34f4
.set tg1_351, 0x3474
.set tg2_352, 0x3502
.set tg1_352, 0x3482
.set tg2_353, 0x350a
.set tg1_353, 0x348a
.set tg2_354, 0x3512
.set tg1_354, 0x3492
.set tg2_355, 0x351a
.set tg1_355, 0x349a
.set tg2_356, 0x3522
.set tg1_356, 0x34a2
.set tg2_357, 0x352a
.set tg1_357, 0x34aa
.set tg2_358, 0x3532
.set tg1_358, 0x34b2
.set tg2_359, 0x3539
.set tg1_359, 0x34b9
.set tg2_360, 0x3541
.set tg1_360, 0x34c1
.set tg2_361, 0x3549
.set tg1_361, 0x34c9
.set tg2_362, 0x3551
.set tg1_362, 0x34d1
.set tg2_363, 0x3558
.set tg1_363, 0x34d8
.set tg2_364, 0x3560
.set tg1_364, 0x34e0
.set tg2_365, 0x3567
.set tg1_365, 0x34e7
.set tg2_366, 0x356f
.set tg1_366, 0x34ef
.set tg2_367, 0x3576
.set tg1_367, 0x34f6
.set tg2_368, 0x357e
.set tg1_368, 0x34fe
.set tg2_369, 0x3583
.set tg1_369, 0x3503
.set tg2_370, 0x3586
.set tg1_370, 0x3506
.set tg2_371, 0x358a
.set tg1_371, 0x350a
.set tg2_372, 0x358e
.set tg1_372, 0x350e
.set tg2_373, 0x3591
.set tg1_373, 0x3511
.set tg2_374, 0x3595
.set tg1_374, 0x3515
.set tg2_375, 0x3598
.set tg1_375, 0x3518
.set tg2_376, 0x359c
.set tg1_376, 0x351c
.set tg2_377, 0x359f
.set tg1_377, 0x351f
.set tg2_378, 0x35a3
.set tg1_378, 0x3523
.set tg2_379, 0x35a6
.set tg1_379, 0x3526
.set tg2_380, 0x35a9
.set tg1_380, 0x3529
.set tg2_381, 0x35ad
.set tg1_381, 0x352d
.set tg2_382, 0x35b0
.set tg1_382, 0x3530
.set tg2_383, 0x35b3
.set tg1_383, 0x3533
.set tg2_384, 0x35b6
.set tg1_384, 0x3536
.set tg2_385, 0x35ba
.set tg1_385, 0x353a
.set tg2_386, 0x35bd
.set tg1_386, 0x353d
.set tg2_387, 0x35c0
.set tg1_387, 0x3540
.set tg2_388, 0x35c3
.set tg1_388, 0x3543
.set tg2_389, 0x35c6
.set tg1_389, 0x3546
.set tg2_390, 0x35c9
.set tg1_390, 0x3549
.set tg2_391, 0x35cc
.set tg1_391, 0x354c
.set tg2_392, 0x35cf
.set tg1_392, 0x354f
.set tg2_393, 0x35d2
.set tg1_393, 0x3552
.set tg2_394, 0x35d5
.set tg1_394, 0x3555
.set tg2_395, 0x35d7
.set tg1_395, 0x3557
.set tg2_396, 0x35da
.set tg1_396, 0x355a
.set tg2_397, 0x35dd
.set tg1_397, 0x355d
.set tg2_398, 0x35e0
.set tg1_398, 0x3560
.set tg2_399, 0x35e2
.set tg1_399, 0x3562
.set tg2_400, 0x35e5
.set tg1_400, 0x3565
.set tg2_401, 0x35e7
.set tg1_401, 0x3567
.set tg2_402, 0x35ea
.set tg1_402, 0x356a
.set tg2_403, 0x35ec
.set tg1_403, 0x356c
.set tg2_404, 0x35ef
.set tg1_404, 0x356f
.set tg2_405, 0x35f1
.set tg1_405, 0x3571
.set tg2_406, 0x35f3
.set tg1_406, 0x3573
.set tg2_407, 0x35f6
.set tg1_407, 0x3576
.set tg2_408, 0x35f8
.set tg1_408, 0x3578
.set tg2_409, 0x35fa
.set tg1_409, 0x357a
.set tg2_410, 0x35fc
.set tg1_410, 0x357c
.set tg2_411, 0x35fe
.set tg1_411, 0x357e
.set tg2_412, 0x3600
.set tg1_412, 0x3580
.set tg2_413, 0x3601
.set tg1_413, 0x3581
.set tg2_414, 0x3602
.set tg1_414, 0x3582
.set tg2_415, 0x3603
.set tg1_415, 0x3583
.set tg2_416, 0x3604
.set tg1_416, 0x3584
.set tg2_417, 0x3605
.set tg1_417, 0x3585
.set tg2_418, 0x3606
.set tg1_418, 0x3586
.set tg2_419, 0x3606
.set tg1_419, 0x3586
.set tg2_420, 0x3607
.set tg1_420, 0x3587
.set tg2_421, 0x3608
.set tg1_421, 0x3588
.set tg2_422, 0x3609
.set tg1_422, 0x3589
.set tg2_423, 0x3609
.set tg1_423, 0x3589
.set tg2_424, 0x360a
.set tg1_424, 0x358a
.set tg2_425, 0x360b
.set tg1_425, 0x358b
.set tg2_426, 0x360b
.set tg1_426, 0x358b
.set tg2_427, 0x360c
.set tg1_427, 0x358c
.set tg2_428, 0x360d
.set tg1_428, 0x358d
.set tg2_429, 0x360d
.set tg1_429, 0x358d
.set tg2_430, 0x360e
.set tg1_430, 0x358e
.set tg2_431, 0x360e
.set tg1_431, 0x358e
.set tg2_432, 0x360f
.set tg1_432, 0x358f
.set tg2_433, 0x360f
.set tg1_433, 0x358f
.set tg2_434, 0x360f
.set tg1_434, 0x358f
.set tg2_435, 0x3610
.set tg1_435, 0x3590
.set tg2_436, 0x3610
.set tg1_436, 0x3590
.set tg2_437, 0x3611
.set tg1_437, 0x3591
.set tg2_438, 0x3611
.set tg1_438, 0x3591
.set tg2_439, 0x3611
.set tg1_439, 0x3591
.set tg2_440, 0x3611
.set tg1_440, 0x3591
.set tg2_441, 0x3612
.set tg1_441, 0x3592
.set tg2_442, 0x3612
.set tg1_442, 0x3592
.set tg2_443, 0x3612
.set tg1_443, 0x3592
.set tg2_444, 0x3612
.set tg1_444, 0x3592
.set tg2_445, 0x3612
.set tg1_445, 0x3592
.set tg2_446, 0x3612
.set tg1_446, 0x3592
.set tg2_447, 0x3612
.set tg1_447, 0x3592
.altmacro
.macro gdemit i
.short tg2_\i
.endm
.macro gdemit1 i
.short tg1_\i
.endm
.p2align 8
.type gdftab,@object
gdftab:
.set gd_db, 0
.rept 14
.set gd_t3, 0
.rept 29
.set gd_l, 0
.rept 64
.set gd_d, 32*gd_db + (gd_l & 31)
.set gd_kk, 16*gd_t3 + 8*(gd_l >> 5)
.rept 8
.if (gd_kk < 2) || ((gd_kk >= 448) && (gd_kk < 450))
gdemit1 %((gd_d * (gd_kk >> 1) + 112 * (gd_kk & 1)) % 448)
.elseif gd_kk < 450
gdemit %((gd_d * (gd_kk >> 1) + 112 * (gd_kk & 1)) % 448)
.else
.short 0
.endif
.set gd_kk, gd_kk + 1
.endr
.set gd_l, gd_l + 1
.endr
.set gd_t3, gd_t3 + 1
.endr
.set gd_db, gd_db + 1
.endr
.noaltmacro
.p2align 8
.type ctab,@object
ctab:
.long 0x3f803f80,0x3f803f80,0x3f803f80,0x3f803f80,0x3f7b3f80,0x3f553f6d,0xbe48248d,0xbf0ebec4
.long 0x3f6d3f80,0x3ec43f35,0xbf6dbf80,0xbec4bf35,0x3f553f80,0xbe483ec4,0x3f0ea554,0x3f7b3f6d
.long 0x3f353f80,0xbf35248d,0x3f353f80,0xbf35248d,0x3f0e3f80,0xbf7bbec4,0xbf55248d,0xbe48bf6d
.long 0x3ec43f80,0xbf6dbf35,0xbec4bf80,0x3f6d3f35,0x3e483f80,0xbf0ebf6d,0x3f7ba554,0xbf553ec4
.long 0x248d3f80,0xa554bf80,0x248d3f80,0xa554bf80,0xbe483f80,0x3f0ebf6d,0xbf7b248d,0x3f553ec4
.long 0xbec43f80,0x3f6dbf35,0x3ec4bf80,0xbf6d3f35,0xbf0e3f80,0x3f7bbec4,0x3f55a554,0x3e48bf6d
.long 0xbf353f80,0x3f35a554,0xbf353f80,0x3f35a554,0xbf553f80,0x3e483ec4,0xbf0e248d,0xbf7b3f6d
.long 0xbf6d3f80,0xbec43f35,0x3f6dbf80,0x3ec4bf35,0xbf7b3f80,0xbf553f6d,0x3e48a554,0x3f0ebec4
.long 0xbf803f80,0xbf803f80,0xbf803f80,0xbf803f80,0xbf7b3f80,0xbf553f6d,0x3e48248d,0x3f0ebec4
.long 0xbf6d3f80,0xbec43f35,0x3f6dbf80,0x3ec4bf35,0xbf553f80,0x3e483ec4,0xbf0ea554,0xbf7b3f6d
.long 0xbf353f80,0x3f35248d,0xbf353f80,0x3f35248d,0xbf0e3f80,0x3f7bbec4,0x3f55248d,0x3e48bf6d
.long 0xbec43f80,0x3f6dbf35,0x3ec4bf80,0xbf6d3f35,0xbe483f80,0x3f0ebf6d,0xbf7ba554,0x3f553ec4
.long 0xa5543f80,0x248dbf80,0xa5543f80,0x248dbf80,0x3e483f80,0xbf0ebf6d,0x3f7b248d,0xbf553ec4
.long 0x3ec43f80,0xbf6dbf35,0xbec4bf80,0x3f6d3f35,0x3f0e3f80,0xbf7bbec4,0xbf55a554,0xbe48bf6d
.long 0x3f353f80,0xbf35a554,0x3f353f80,0xbf35a554,0x3f553f80,0xbe483ec4,0x3f0e248d,0x3f7b3f6d
.long 0x3f6d3f80,0x3ec43f35,0xbf6dbf80,0xbec4bf35,0x3f7b3f80,0x3f553f6d,0xbe48a554,0xbf0ebec4
.long 0x3f803f80,0x3f803f80,0x3f803f80,0x3f803f80,0x3f0e3f35,0x3e483ec4,0xbf55bf35,0xbf7bbf6d
.long 0xbec4248d,0xbf6dbf35,0x3ec4a554,0x3f6d3f35,0xbf7bbf35,0xbf0ebf6d,0x3e483f35,0xbf55bec4
.long 0xbf35bf80,0x3f35a554,0xbf35bf80,0x3f35a554,0x3e48bf35,0x3f553f6d,0x3f7b3f35,0xbf0e3ec4
.long 0x3f6da554,0xbec43f35,0xbf6d248d,0x3ec4bf35,0x3f553f35,0xbf7bbec4,0x3f0ebf35,0xbe483f6d
.long 0x248d3f80,0xa554bf80,0x248d3f80,0xa554bf80,0xbf553f35,0x3f7bbec4,0xbf0ebf35,0x3e483f6d
.long 0xbf6d248d,0x3ec43f35,0x3f6da554,0xbec4bf35,0xbe48bf35,0xbf553f6d,0xbf7b3f35,0x3f0e3ec4
.long 0x3f35bf80,0xbf35248d,0x3f35bf80,0xbf35248d,0x3f7bbf35,0x3f0ebf6d,0xbe483f35,0x3f55bec4
.long 0x3ec4a554,0x3f6dbf35,0xbec4248d,0xbf6d3f35,0xbf0e3f35,0xbe483ec4,0x3f55bf35,0x3f7bbf6d
.long 0xbf803f80,0xbf803f80,0xbf803f80,0xbf803f80,0xbf0e3f35,0xbe483ec4,0x3f55bf35,0x3f7bbf6d
.long 0x3ec4248d,0x3f6dbf35,0xbec4a554,0xbf6d3f35,0x3f7bbf35,0x3f0ebf6d,0xbe483f35,0x3f55bec4
.long 0x3f35bf80,0xbf35a554,0x3f35bf80,0xbf35a554,0xbe48bf35,0xbf553f6d,0xbf7b3f35,0x3f0e3ec4
.long 0xbf6da554,0x3ec43f35,0x3f6d248d,0xbec4bf35,0xbf553f35,0x3f7bbec4,0xbf0ebf35,0x3e483f6d
.long 0xa5543f80,0x248dbf80,0xa5543f80,0x248dbf80,0x3f553f35,0xbf7bbec4,0x3f0ebf35,0xbe483f6d
.long 0x3f6d248d,0xbec43f35,0xbf6da554,0x3ec4bf35,0x3e48bf35,0x3f553f6d,0x3f7b3f35,0xbf0e3ec4
.long 0xbf35bf80,0x3f35248d,0xbf35bf80,0x3f35248d,0xbf7bbf35,0xbf0ebf6d,0x3e483f35,0xbf55bec4
.long 0xbec4a554,0xbf6dbf35,0x3ec4248d,0x3f6d3f35,0x3f0e3f35,0x3e483ec4,0xbf55bf35,0xbf7bbf6d
.long 0x3f803f80,0x3f803f80,0x3f803f80,0x3f803f80,0xbf7bbf80,0xbf55bf6d,0x3e48a554,0x3f0e3ec4
.long 0x3f6d3f80,0x3ec43f35,0xbf6dbf80,0xbec4bf35,0xbf55bf80,0x3e48bec4,0xbf0e248d,0xbf7bbf6d
.long 0x3f353f80,0xbf35248d,0x3f353f80,0xbf35248d,0xbf0ebf80,0x3f7b3ec4,0x3f55a554,0x3e483f6d
.long 0x3ec43f80,0xbf6dbf35,0xbec4bf80,0x3f6d3f35,0xbe48bf80,0x3f0e3f6d,0xbf7b248d,0x3f55bec4
.long 0x248d3f80,0xa554bf80,0x248d3f80,0xa554bf80,0x3e48bf80,0xbf0e3f6d,0x3f7ba554,0xbf55bec4
.long 0xbec43f80,0x3f6dbf35,0x3ec4bf80,0xbf6d3f35,0x3f0ebf80,0xbf7b3ec4,0xbf55248d,0xbe483f6d
.long 0xbf353f80,0x3f35a554,0xbf353f80,0x3f35a554,0x3f55bf80,0xbe48bec4,0x3f0ea554,0x3f7bbf6d
.long 0xbf6d3f80,0xbec43f35,0x3f6dbf80,0x3ec4bf35,0x3f7bbf80,0x3f55bf6d,0xbe48248d,0xbf0e3ec4
.long 0xbf803f80,0xbf803f80,0xbf803f80,0xbf803f80,0x3f7bbf80,0x3f55bf6d,0xbe48a554,0xbf0e3ec4
.long 0xbf6d3f80,0xbec43f35,0x3f6dbf80,0x3ec4bf35,0x3f55bf80,0xbe48bec4,0x3f0e248d,0x3f7bbf6d
.long 0xbf353f80,0x3f35248d,0xbf353f80,0x3f35248d,0x3f0ebf80,0xbf7b3ec4,0xbf55a554,0xbe483f6d
.long 0xbec43f80,0x3f6dbf35,0x3ec4bf80,0xbf6d3f35,0x3e48bf80,0xbf0e3f6d,0x3f7b248d,0xbf55bec4
.long 0xa5543f80,0x248dbf80,0xa5543f80,0x248dbf80,0xbe48bf80,0x3f0e3f6d,0xbf7ba554,0x3f55bec4
.long 0x3ec43f80,0xbf6dbf35,0xbec4bf80,0x3f6d3f35,0xbf0ebf80,0x3f7b3ec4,0x3f55248d,0x3e483f6d
.long 0x3f353f80,0xbf35a554,0x3f353f80,0xbf35a554,0xbf55bf80,0x3e48bec4,0xbf0ea554,0xbf7bbf6d
.long 0x3f6d3f80,0x3ec43f35,0xbf6dbf80,0xbec4bf35,0xbf7bbf80,0xbf55bf6d,0x3e48248d,0x3f0e3ec4
.long 0x3f803f80,0x3f803f80,0x3f803f80,0x3f803f80,0xbf0ebf35,0xbe48bec4,0x3f553f35,0x3f7b3f6d
.long 0xbec4248d,0xbf6dbf35,0x3ec4a554,0x3f6d3f35,0x3f7b3f35,0x3f0e3f6d,0xbe48bf35,0x3f553ec4
.long 0xbf35bf80,0x3f35a554,0xbf35bf80,0x3f35a554,0xbe483f35,0xbf55bf6d,0xbf7bbf35,0x3f0ebec4
.long 0x3f6da554,0xbec43f35,0xbf6d248d,0x3ec4bf35,0xbf55bf35,0x3f7b3ec4,0xbf0e3f35,0x3e48bf6d
.long 0x248d3f80,0xa554bf80,0x248d3f80,0xa554bf80,0x3f55bf35,0xbf7b3ec4,0x3f0e3f35,0xbe48bf6d
.long 0xbf6d248d,0x3ec43f35,0x3f6da554,0xbec4bf35,0x3e483f35,0x3f55bf6d,0x3f7bbf35,0xbf0ebec4
.long 0x3f35bf80,0xbf35248d,0x3f35bf80,0xbf35248d,0xbf7b3f35,0xbf0e3f6d,0x3e48bf35,0xbf553ec4
.long 0x3ec4a554,0x3f6dbf35,0xbec4248d,0xbf6d3f35,0x3f0ebf35,0x3e48bec4,0xbf553f35,0xbf7b3f6d
.long 0xbf803f80,0xbf803f80,0xbf803f80,0xbf803f80,0x3f0ebf35,0x3e48bec4,0xbf553f35,0xbf7b3f6d
.long 0x3ec4248d,0x3f6dbf35,0xbec4a554,0xbf6d3f35,0xbf7b3f35,0xbf0e3f6d,0x3e48bf35,0xbf553ec4
.long 0x3f35bf80,0xbf35a554,0x3f35bf80,0xbf35a554,0x3e483f35,0x3f55bf6d,0x3f7bbf35,0xbf0ebec4
.long 0xbf6da554,0x3ec43f35,0x3f6d248d,0xbec4bf35,0x3f55bf35,0xbf7b3ec4,0x3f0e3f35,0xbe48bf6d
.long 0xa5543f80,0x248dbf80,0xa5543f80,0x248dbf80,0xbf55bf35,0x3f7b3ec4,0xbf0e3f35,0x3e48bf6d
.long 0x3f6d248d,0xbec43f35,0xbf6da554,0x3ec4bf35,0xbe483f35,0xbf55bf6d,0xbf7bbf35,0x3f0ebec4
.long 0xbf35bf80,0x3f35248d,0xbf35bf80,0x3f35248d,0x3f7b3f35,0x3f0e3f6d,0xbe48bf35,0x3f553ec4
.long 0xbec4a554,0xbf6dbf35,0x3ec4248d,0x3f6d3f35,0xbf0ebf35,0xbe48bec4,0x3f553f35,0x3f7b3f6d
.long 0x0,0x0,0x0,0x0,0x3e480000,0x3f0e3ec4,0x3f7b3f80,0x3f553f6d
.long 0x3ec40000,0x3f6d3f35,0xbec4250d,0xbf6dbf35,0x3f0e0000,0x3f7b3f6d,0xbf55bf80,0x3e48bec4
.long 0x3f350000,0x3f353f80,0x3f350000,0x3f353f80,0x3f550000,0x3e483f6d,0x3f0e3f80,0xbf7bbec4
.long 0x3f6d0000,0xbec43f35,0xbf6d250d,0x3ec4bf35,0x3f7b0000,0xbf553ec4,0xbe48bf80,0x3f0e3f6d
.long 0x3f800000,0xbf80250d,0x3f800000,0xbf80250d,0x3f7b0000,0xbf55bec4,0xbe483f80,0x3f0ebf6d
.long 0x3f6d0000,0xbec4bf35,0xbf6d250d,0x3ec43f35,0x3f550000,0x3e48bf6d,0x3f0ebf80,0xbf7b3ec4
.long 0x3f350000,0x3f35bf80,0x3f350000,0x3f35bf80,0x3f0e0000,0x3f7bbf6d,0xbf553f80,0x3e483ec4
.long 0x3ec40000,0x3f6dbf35,0xbec4250d,0xbf6d3f35,0x3e480000,0x3f0ebec4,0x3f7bbf80,0x3f55bf6d
.long 0x250d0000,0x250d0000,0x250d0000,0x250d0000,0xbe480000,0xbf0e3ec4,0xbf7b3f80,0xbf553f6d
.long 0xbec40000,0xbf6d3f35,0x3ec4250d,0x3f6dbf35,0xbf0e0000,0xbf7b3f6d,0x3f55bf80,0xbe48bec4
.long 0xbf350000,0xbf353f80,0xbf350000,0xbf353f80,0xbf550000,0xbe483f6d,0xbf0e3f80,0x3f7bbec4
.long 0xbf6d0000,0x3ec43f35,0x3f6d250d,0xbec4bf35,0xbf7b0000,0x3f553ec4,0x3e48bf80,0xbf0e3f6d
.long 0xbf800000,0x3f80250d,0xbf800000,0x3f80250d,0xbf7b0000,0x3f55bec4,0x3e483f80,0xbf0ebf6d
.long 0xbf6d0000,0x3ec4bf35,0x3f6d250d,0xbec43f35,0xbf550000,0xbe48bf6d,0xbf0ebf80,0x3f7b3ec4
.long 0xbf350000,0xbf35bf80,0xbf350000,0xbf35bf80,0xbf0e0000,0xbf7bbf6d,0x3f553f80,0xbe483ec4
.long 0xbec40000,0xbf6dbf35,0x3ec4250d,0x3f6d3f35,0xbe480000,0xbf0ebec4,0xbf7bbf80,0xbf55bf6d
.long 0x0,0x0,0x0,0x0,0x3f553f35,0x3f7b3f6d,0x3f0e3f35,0x3e483ec4
.long 0x3f6d3f80,0x3ec43f35,0xbf6dbf80,0xbec4bf35,0x3e483f35,0xbf55bec4,0x3f7b3f35,0x3f0e3f6d
.long 0xbf35250d,0xbf35bf80,0xbf35250d,0xbf35bf80,0xbf7bbf35,0x3f0ebec4,0x3e48bf35,0x3f553f6d
.long 0xbec4bf80,0x3f6d3f35,0x3ec43f80,0xbf6dbf35,0x3f0ebf35,0xbe483f6d,0xbf55bf35,0x3f7b3ec4
.long 0x3f800000,0xbf80250d,0x3f800000,0xbf80250d,0x3f0e3f35,0xbe48bf6d,0xbf553f35,0x3f7bbec4
.long 0xbec43f80,0x3f6dbf35,0x3ec4bf80,0xbf6d3f35,0xbf7b3f35,0x3f0e3ec4,0x3e483f35,0x3f55bf6d
.long 0xbf35250d,0xbf353f80,0xbf35250d,0xbf353f80,0x3e48bf35,0xbf553ec4,0x3f7bbf35,0x3f0ebf6d
.long 0x3f6dbf80,0x3ec4bf35,0xbf6d3f80,0xbec43f35,0x3f55bf35,0x3f7bbf6d,0x3f0ebf35,0x3e48bec4
.long 0x250d0000,0x250d0000,0x250d0000,0x250d0000,0xbf553f35,0xbf7b3f6d,0xbf0e3f35,0xbe483ec4
.long 0xbf6d3f80,0xbec43f35,0x3f6dbf80,0x3ec4bf35,0xbe483f35,0x3f55bec4,0xbf7b3f35,0xbf0e3f6d
.long 0x3f35250d,0x3f35bf80,0x3f35250d,0x3f35bf80,0x3f7bbf35,0xbf0ebec4,0xbe48bf35,0xbf553f6d
.long 0x3ec4bf80,0xbf6d3f35,0xbec43f80,0x3f6dbf35,0xbf0ebf35,0x3e483f6d,0x3f55bf35,0xbf7b3ec4
.long 0xbf800000,0x3f80250d,0xbf800000,0x3f80250d,0xbf0e3f35,0x3e48bf6d,0x3f553f35,0xbf7bbec4
.long 0x3ec43f80,0xbf6dbf35,0xbec4bf80,0x3f6d3f35,0x3f7b3f35,0xbf0e3ec4,0xbe483f35,0xbf55bf6d
.long 0x3f35250d,0x3f353f80,0x3f35250d,0x3f353f80,0xbe48bf35,0x3f553ec4,0xbf7bbf35,0xbf0ebf6d
.long 0xbf6dbf80,0xbec4bf35,0x3f6d3f80,0x3ec43f35,0xbf55bf35,0xbf7bbf6d,0xbf0ebf35,0xbe48bec4
.long 0x0,0x0,0x0,0x0,0xbe48250d,0xbf0ebec4,0xbf7bbf80,0xbf55bf6d
.long 0x3ec40000,0x3f6d3f35,0xbec4250d,0xbf6dbf35,0xbf0e250d,0xbf7bbf6d,0x3f553f80,0xbe483ec4
.long 0x3f350000,0x3f353f80,0x3f350000,0x3f353f80,0xbf55250d,0xbe48bf6d,0xbf0ebf80,0x3f7b3ec4
.long 0x3f6d0000,0xbec43f35,0xbf6d250d,0x3ec4bf35,0xbf7b250d,0x3f55bec4,0x3e483f80,0xbf0ebf6d
.long 0x3f800000,0xbf80250d,0x3f800000,0xbf80250d,0xbf7b250d,0x3f553ec4,0x3e48bf80,0xbf0e3f6d
.long 0x3f6d0000,0xbec4bf35,0xbf6d250d,0x3ec43f35,0xbf55250d,0xbe483f6d,0xbf0e3f80,0x3f7bbec4
.long 0x3f350000,0x3f35bf80,0x3f350000,0x3f35bf80,0xbf0e250d,0xbf7b3f6d,0x3f55bf80,0xbe48bec4
.long 0x3ec40000,0x3f6dbf35,0xbec4250d,0xbf6d3f35,0xbe48250d,0xbf0e3ec4,0xbf7b3f80,0xbf553f6d
.long 0x250d0000,0x250d0000,0x250d0000,0x250d0000,0x3e48250d,0x3f0ebec4,0x3f7bbf80,0x3f55bf6d
.long 0xbec40000,0xbf6d3f35,0x3ec4250d,0x3f6dbf35,0x3f0e250d,0x3f7bbf6d,0xbf553f80,0x3e483ec4
.long 0xbf350000,0xbf353f80,0xbf350000,0xbf353f80,0x3f55250d,0x3e48bf6d,0x3f0ebf80,0xbf7b3ec4
.long 0xbf6d0000,0x3ec43f35,0x3f6d250d,0xbec4bf35,0x3f7b250d,0xbf55bec4,0xbe483f80,0x3f0ebf6d
.long 0xbf800000,0x3f80250d,0xbf800000,0x3f80250d,0x3f7b250d,0xbf553ec4,0xbe48bf80,0x3f0e3f6d
.long 0xbf6d0000,0x3ec4bf35,0x3f6d250d,0xbec43f35,0x3f55250d,0x3e483f6d,0x3f0e3f80,0xbf7bbec4
.long 0xbf350000,0xbf35bf80,0xbf350000,0xbf35bf80,0x3f0e250d,0x3f7b3f6d,0xbf55bf80,0x3e48bec4
.long 0xbec40000,0xbf6dbf35,0x3ec4250d,0x3f6d3f35,0x3e48250d,0x3f0e3ec4,0x3f7b3f80,0x3f553f6d
.long 0x0,0x0,0x0,0x0,0xbf55bf35,0xbf7bbf6d,0xbf0ebf35,0xbe48bec4
.long 0x3f6d3f80,0x3ec43f35,0xbf6dbf80,0xbec4bf35,0xbe48bf35,0x3f553ec4,0xbf7bbf35,0xbf0ebf6d
.long 0xbf35250d,0xbf35bf80,0xbf35250d,0xbf35bf80,0x3f7b3f35,0xbf0e3ec4,0xbe483f35,0xbf55bf6d
.long 0xbec4bf80,0x3f6d3f35,0x3ec43f80,0xbf6dbf35,0xbf0e3f35,0x3e48bf6d,0x3f553f35,0xbf7bbec4
.long 0x3f800000,0xbf80250d,0x3f800000,0xbf80250d,0xbf0ebf35,0x3e483f6d,0x3f55bf35,0xbf7b3ec4
.long 0xbec43f80,0x3f6dbf35,0x3ec4bf80,0xbf6d3f35,0x3f7bbf35,0xbf0ebec4,0xbe48bf35,0xbf553f6d
.long 0xbf35250d,0xbf353f80,0xbf35250d,0xbf353f80,0xbe483f35,0x3f55bec4,0xbf7b3f35,0xbf0e3f6d
.long 0x3f6dbf80,0x3ec4bf35,0xbf6d3f80,0xbec43f35,0xbf553f35,0xbf7b3f6d,0xbf0e3f35,0xbe483ec4
.long 0x250d0000,0x250d0000,0x250d0000,0x250d0000,0x3f55bf35,0x3f7bbf6d,0x3f0ebf35,0x3e48bec4
.long 0xbf6d3f80,0xbec43f35,0x3f6dbf80,0x3ec4bf35,0x3e48bf35,0xbf553ec4,0x3f7bbf35,0x3f0ebf6d
.long 0x3f35250d,0x3f35bf80,0x3f35250d,0x3f35bf80,0xbf7b3f35,0x3f0e3ec4,0x3e483f35,0x3f55bf6d
.long 0x3ec4bf80,0xbf6d3f35,0xbec43f80,0x3f6dbf35,0x3f0e3f35,0xbe48bf6d,0xbf553f35,0x3f7bbec4
.long 0xbf800000,0x3f80250d,0xbf800000,0x3f80250d,0x3f0ebf35,0xbe483f6d,0xbf55bf35,0x3f7b3ec4
.long 0x3ec43f80,0xbf6dbf35,0xbec4bf80,0x3f6d3f35,0xbf7bbf35,0x3f0ebec4,0x3e48bf35,0x3f553f6d
.long 0x3f35250d,0x3f353f80,0x3f35250d,0x3f353f80,0x3e483f35,0xbf55bec4,0x3f7b3f35,0x3f0e3f6d
.long 0xbf6dbf80,0xbec4bf35,0x3f6d3f80,0x3ec43f35,0x3f553f35,0x3f7b3f6d,0x3f0e3f35,0x3e483ec4
.long 0x3f800000,0x3f800000,0x00000000,0x00000000,0x3f800000,0x3f7fffb1,0x00000000,0x3b490fc6,0x3f800000,0x3f7ffec4,0x00000000,0x3bc90f88,0x3f800000,0x3f7ffd39,0x00000000,0x3c16cb58
.long 0x3f800000,0x3f7ffb11,0x00000000,0x3c490e90,0x3f800000,0x3f7ff84a,0x00000000,0x3c7b514b,0x3f800000,0x3f7ff4e6,0x00000000,0x3c96c9b6,0x3f800000,0x3f7ff0e3,0x00000000,0x3cafea69
.long 0x3f800000,0x3f7fec43,0x00000000,0x3cc90ab0,0x3f800000,0x3f7fe705,0x00000000,0x3ce22a7a,0x3f800000,0x3f7fe129,0x00000000,0x3cfb49ba,0x3f800000,0x3f7fdaaf,0x00000000,0x3d0a342f
.long 0x3f800000,0x3f7fd397,0x00000000,0x3d16c32c,0x3f800000,0x3f7fcbe2,0x00000000,0x3d2351cb,0x3f800000,0x3f7fc38f,0x00000000,0x3d2fe007,0x3f800000,0x3f7fba9e,0x00000000,0x3d3c6dd5
.long 0x3f800000,0x3f7fb10f,0x00000000,0x3d48fb30,0x3f800000,0x3f7fa6e3,0x00000000,0x3d55880e,0x3f800000,0x3f7f9c18,0x00000000,0x3d621469,0x3f800000,0x3f7f90b1,0x00000000,0x3d6ea038
.long 0x3f800000,0x3f7f84ab,0x00000000,0x3d7b2b74,0x3f800000,0x3f7f7808,0x00000000,0x3d83db0a,0x3f800000,0x3f7f6ac7,0x00000000,0x3d8a200a,0x3f800000,0x3f7f5ce9,0x00000000,0x3d9064b4
.long 0x3f800000,0x3f7f4e6d,0x00000000,0x3d96a905,0x3f800000,0x3f7f3f54,0x00000000,0x3d9cecf9,0x3f800000,0x3f7f2f9d,0x00000000,0x3da3308c,0x3f800000,0x3f7f1f49,0x00000000,0x3da973ba
.long 0x3f800000,0x3f7f0e58,0x00000000,0x3dafb680,0x3f800000,0x3f7efcc9,0x00000000,0x3db5f8da,0x3f800000,0x3f7eea9d,0x00000000,0x3dbc3ac3,0x3f800000,0x3f7ed7d4,0x00000000,0x3dc27c39
.long 0x3f800000,0x3f800000,0x00000000,0x00000000,0x3f7ffb11,0x3f7ff84a,0x3c490e90,0x3c7b514b,0x3f7fec43,0x3f7fe129,0x3cc90ab0,0x3cfb49ba,0x3f7fd397,0x3f7fba9e,0x3d16c32c,0x3d3c6dd5
.long 0x3f7fb10f,0x3f7f84ab,0x3d48fb30,0x3d7b2b74,0x3f7f84ab,0x3f7f3f54,0x3d7b2b74,0x3d9cecf9,0x3f7f4e6d,0x3f7eea9d,0x3d96a905,0x3dbc3ac3,0x3f7f0e58,0x3f7e868b,0x3dafb680,0x3ddb7d37
.long 0x3f7ec46d,0x3f7e1324,0x3dc8bd36,0x3dfab273,0x3f7e70b0,0x3f7d906e,0x3de1bc2e,0x3e0cec4a,0x3f7e1324,0x3f7cfe73,0x3dfab273,0x3e1c76de,0x3f7dabcc,0x3f7c5d3a,0x3e09cf86,0x3e2bf804
.long 0x3f7d3aac,0x3f7baccd,0x3e164083,0x3e3b6ecf,0x3f7cbfc9,0x3f7aed37,0x3e22abb6,0x3e4ada4f,0x3f7c3b28,0x3f7a1e84,0x3e2f10a2,0x3e5a3997,0x3f7baccd,0x3f7940c0,0x3e3b6ecf,0x3e698bba
.long 0x3f7b14be,0x3f7853f8,0x3e47c5c2,0x3e78cfcc,0x3f7a7302,0x3f77583a,0x3e541501,0x3e840270,0x3f79c79d,0x3f764d97,0x3e605c13,0x3e8b9507,0x3f791298,0x3f75341d,0x3e6c9a7f,0x3e931f35
.long 0x3f7853f8,0x3f740bdd,0x3e78cfcc,0x3e9aa086,0x3f778bc5,0x3f72d4eb,0x3e827dc0,0x3ea21887,0x3f76ba07,0x3f718f57,0x3e888e93,0x3ea986c4,0x3f75dec6,0x3f703b37,0x3e8e9a22,0x3eb0eacb
.long 0x3f74fa0b,0x3f6ed89e,0x3e94a031,0x3eb8442a,0x3f740bdd,0x3f6d67a1,0x3e9aa086,0x3ebf926f,0x3f731447,0x3f6be858,0x3ea09ae5,0x3ec6d529,0x3f721352,0x3f6a5ad9,0x3ea68f12,0x3ece0bea
.long 0x3f710908,0x3f68bf3c,0x3eac7cd4,0x3ed53641,0x3f6ff573,0x3f671599,0x3eb263ef,0x3edc53c1,0x3f6ed89e,0x3f655e0b,0x3eb8442a,0x3ee363fa,0x3f6db293,0x3f6398ac,0x3ebe1d4a,0x3eea6681
.long 0x3f800000,0x3f800000,0x00000000,0x00000000,0x3f7ffec4,0x3f7ffd39,0x3bc90f88,0x3c16cb58,0x3f7ffb11,0x3f7ff4e6,0x3c490e90,0x3c96c9b6,0x3f7ff4e6,0x3f7fe705,0x3c96c9b6,0x3ce22a7a
.long 0x3f7fec43,0x3f7fd397,0x3cc90ab0,0x3d16c32c,0x3f7fe129,0x3f7fba9e,0x3cfb49ba,0x3d3c6dd5,0x3f7fd397,0x3f7f9c18,0x3d16c32c,0x3d621469,0x3f7fc38f,0x3f7f7808,0x3d2fe007,0x3d83db0a
.long 0x3f7fb10f,0x3f7f4e6d,0x3d48fb30,0x3d96a905,0x3f7f9c18,0x3f7f1f49,0x3d621469,0x3da973ba,0x3f7f84ab,0x3f7eea9d,0x3d7b2b74,0x3dbc3ac3,0x3f7f6ac7,0x3f7eb069,0x3d8a200a,0x3dcefdb7
.long 0x3f7f4e6d,0x3f7e70b0,0x3d96a905,0x3de1bc2e,0x3f7f2f9d,0x3f7e2b72,0x3da3308c,0x3df475c0,0x3f7f0e58,0x3f7de0b1,0x3dafb680,0x3e039502,0x3f7eea9d,0x3f7d906e,0x3dbc3ac3,0x3e0cec4a
.long 0x3f7ec46d,0x3f7d3aac,0x3dc8bd36,0x3e164083,0x3f7e9bc9,0x3f7cdf6c,0x3dd53db9,0x3e1f917b,0x3f7e70b0,0x3f7c7eb0,0x3de1bc2e,0x3e28defc,0x3f7e4323,0x3f7c187a,0x3dee3876,0x3e3228d4
.long 0x3f7e1324,0x3f7baccd,0x3dfab273,0x3e3b6ecf,0x3f7de0b1,0x3f7b3bab,0x3e039502,0x3e44b0b9,0x3f7dabcc,0x3f7ac516,0x3e09cf86,0x3e4dee60,0x3f7d7474,0x3f7a4910,0x3e1008b7,0x3e57278f
.long 0x3f7d3aac,0x3f79c79d,0x3e164083,0x3e605c13,0x3f7cfe73,0x3f7940c0,0x3e1c76de,0x3e698bba,0x3f7cbfc9,0x3f78b47b,0x3e22abb6,0x3e72b651,0x3f7c7eb0,0x3f7822d1,0x3e28defc,0x3e7bdba4
.long 0x3f7c3b28,0x3f778bc5,0x3e2f10a2,0x3e827dc0,0x3f7bf531,0x3f76ef5b,0x3e354098,0x3e870ada,0x3f7baccd,0x3f764d97,0x3e3b6ecf,0x3e8b9507,0x3f7b61fc,0x3f75a67b,0x3e419b37,0x3e901c2c
.long 0x3f800000,0x3f800000,0x00000000,0x00000000,0x3f7ff4e6,0x3f7ff0e3,0x3c96c9b6,0x3cafea69,0x3f7fd397,0x3f7fc38f,0x3d16c32c,0x3d2fe007,0x3f7f9c18,0x3f7f7808,0x3d621469,0x3d83db0a
.long 0x3f7f4e6d,0x3f7f0e58,0x3d96a905,0x3dafb680,0x3f7eea9d,0x3f7e868b,0x3dbc3ac3,0x3ddb7d37,0x3f7e70b0,0x3f7de0b1,0x3de1bc2e,0x3e039502,0x3f7de0b1,0x3f7d1cdd,0x3e039502,0x3e195be0
.long 0x3f7d3aac,0x3f7c3b28,0x3e164083,0x3e2f10a2,0x3f7c7eb0,0x3f7b3bab,0x3e28defc,0x3e44b0b9,0x3f7baccd,0x3f7a1e84,0x3e3b6ecf,0x3e5a3997,0x3f7ac516,0x3f78e3d6,0x3e4dee60,0x3e6fa8b2
.long 0x3f79c79d,0x3f778bc5,0x3e605c13,0x3e827dc0,0x3f78b47b,0x3f76167a,0x3e72b651,0x3e8d17c0,0x3f778bc5,0x3f748422,0x3e827dc0,0x3e97a117,0x3f764d97,0x3f72d4eb,0x3e8b9507,0x3ea21887
.long 0x3f74fa0b,0x3f710908,0x3e94a031,0x3eac7cd4,0x3f73913f,0x3f6f20b0,0x3e9d9e78,0x3eb6ccc3,0x3f721352,0x3f6d1c1d,0x3ea68f12,0x3ec1071e,0x3f708066,0x3f6afb8c,0x3eaf713a,0x3ecb2aae
.long 0x3f6ed89e,0x3f68bf3c,0x3eb8442a,0x3ed53641,0x3f6d1c1d,0x3f666771,0x3ec1071e,0x3edf28a9,0x3f6b4b0c,0x3f63f473,0x3ec9b953,0x3ee900b7,0x3f696591,0x3f61668a,0x3ed25a09,0x3ef2bd43
.long 0x3f676bd8,0x3f5ebe05,0x3edae880,0x3efc5d27,0x3f655e0b,0x3f5bfb34,0x3ee363fa,0x3f02ef9f,0x3f633c5a,0x3f591e6a,0x3eebcbbb,0x3f07a136,0x3f6106f2,0x3f5627fe,0x3ef41f07,0x3f0c42c9
.long 0x3f5ebe05,0x3f531849,0x3efc5d27,0x3f10d3cd,0x3f5c61c7,0x3f4fefa8,0x3f0242b1,0x3f1553b7,0x3f59f26a,0x3f4cae79,0x3f064b82,0x3f19c200,0x3f577026,0x3f495521,0x3f0a48ad,0x3f1e1e22
.long 0x3f800000,0x3f800000,0x00000000,0x00000000,0x3f7fec43,0x3f7fe705,0x3cc90ab0,0x3ce22a7a,0x3f7fb10f,0x3f7f9c18,0x3d48fb30,0x3d621469,0x3f7f4e6d,0x3f7f1f49,0x3d96a905,0x3da973ba
.long 0x3f7ec46d,0x3f7e70b0,0x3dc8bd36,0x3de1bc2e,0x3f7e1324,0x3f7d906e,0x3dfab273,0x3e0cec4a,0x3f7d3aac,0x3f7c7eb0,0x3e164083,0x3e28defc,0x3f7c3b28,0x3f7b3bab,0x3e2f10a2,0x3e44b0b9
.long 0x3f7b14be,0x3f79c79d,0x3e47c5c2,0x3e605c13,0x3f79c79d,0x3f7822d1,0x3e605c13,0x3e7bdba4,0x3f7853f8,0x3f764d97,0x3e78cfcc,0x3e8b9507,0x3f76ba07,0x3f74484b,0x3e888e93,0x3e9920fe
.long 0x3f74fa0b,0x3f721352,0x3e94a031,0x3ea68f12,0x3f731447,0x3f6faf1b,0x3ea09ae5,0x3eb3dca5,0x3f710908,0x3f6d1c1d,0x3eac7cd4,0x3ec1071e,0x3f6ed89e,0x3f6a5ad9,0x3eb8442a,0x3ece0bea
.long 0x3f6c835e,0x3f676bd8,0x3ec3ef15,0x3edae880,0x3f6a09a7,0x3f644fac,0x3ecf7bca,0x3ee79a5d,0x3f676bd8,0x3f6106f2,0x3edae880,0x3ef41f07,0x3f64aa59,0x3f5d924d,0x3ee63375,0x3f003a06
.long 0x3f61c598,0x3f59f26a,0x3ef15aea,0x3f064b82,0x3f5ebe05,0x3f5627fe,0x3efc5d27,0x3f0c42c9,0x3f5b941a,0x3f5233c6,0x3f039c3d,0x3f121eb0,0x3f584853,0x3f4e1689,0x3f08f59b,0x3f17de12
.long 0x3f54db31,0x3f49d112,0x3f0e39da,0x3f1d7fd1,0x3f514d3d,0x3f456439,0x3f13682a,0x3f2302d3,0x3f4d9f02,0x3f40d0da,0x3f187fc0,0x3f286605,0x3f49d112,0x3f3c17d9,0x3f1d7fd1,0x3f2da859
.long 0x3f45e403,0x3f373a23,0x3f226799,0x3f32c8c9,0x3f41d870,0x3f3238aa,0x3f273656,0x3f37c655,0x3f3daef9,0x3f2d1469,0x3f2beb4a,0x3f3ca003,0x3f396842,0x3f27ce61,0x3f3085bb,0x3f4154e1
.long 0x3f800000,0x3f800000,0x00000000,0x00000000,0x3f7fd397,0x3f7fcbe2,0x3d16c32c,0x3d2351cb,0x3f7f4e6d,0x3f7f2f9d,0x3d96a905,0x3da3308c,0x3f7e70b0,0x3f7e2b72,0x3de1bc2e,0x3df475c0
.long 0x3f7d3aac,0x3f7cbfc9,0x3e164083,0x3e22abb6,0x3f7baccd,0x3f7aed37,0x3e3b6ecf,0x3e4ada4f,0x3f79c79d,0x3f78b47b,0x3e605c13,0x3e72b651,0x3f778bc5,0x3f76167a,0x3e827dc0,0x3e8d17c0
.long 0x3f74fa0b,0x3f731447,0x3e94a031,0x3ea09ae5,0x3f721352,0x3f6faf1b,0x3ea68f12,0x3eb3dca5,0x3f6ed89e,0x3f6be858,0x3eb8442a,0x3ec6d529,0x3f6b4b0c,0x3f67c187,0x3ec9b953,0x3ed97cb9
.long 0x3f676bd8,0x3f633c5a,0x3edae880,0x3eebcbbb,0x3f633c5a,0x3f5e5aa6,0x3eebcbbb,0x3efdbabb,0x3f5ebe05,0x3f591e6a,0x3efc5d27,0x3f07a136,0x3f59f26a,0x3f5389c7,0x3f064b82,0x3f102dd5
.long 0x3f54db31,0x3f4d9f02,0x3f0e39da,0x3f187fc0,0x3f4f7a1f,0x3f476085,0x3f15f6d9,0x3f209393,0x3f49d112,0x3f40d0da,0x3f1d7fd1,0x3f286605,0x3f43e200,0x3f39f2ac,0x3f24d225,0x3f2ff3e6
.long 0x3f3daef9,0x3f32c8c9,0x3f2beb4a,0x3f373a23,0x3f373a23,0x3f2b561b,0x3f32c8c9,0x3f3e35c5,0x3f3085bb,0x3f239da9,0x3f396842,0x3f44e3f5,0x3f299415,0x3f1ba299,0x3f3fc767,0x3f4b41fa
.long 0x3f226799,0x3f13682a,0x3f45e403,0x3f514d3d,0x3f1b02c6,0x3f0af1b7,0x3f4bbbf8,0x3f570348,0x3f13682a,0x3f0242b1,0x3f514d3d,0x3f5c61c7,0x3f0b9a6b,0x3ef2bd43,0x3f5695e5,0x3f61668a
.long 0x3f039c3d,0x3ee0924f,0x3f5b941a,0x3f660f88,0x3ef6e0cb,0x3ece0bea,0x3f604621,0x3f6a5ad9,0x3ee63375,0x3ebb31a0,0x3f64aa59,0x3f6e46be,0x3ed53641,0x3ea80b1f,0x3f68bf3c,0x3f71d19f
.long 0x3f800000,0x3f800000,0x00000000,0x00000000,0x3f7fe129,0x3f7fdaaf,0x3cfb49ba,0x3d0a342f,0x3f7f84ab,0x3f7f6ac7,0x3d7b2b74,0x3d8a200a,0x3f7eea9d,0x3f7eb069,0x3dbc3ac3,0x3dcefdb7
.long 0x3f7e1324,0x3f7dabcc,0x3dfab273,0x3e09cf86,0x3f7cfe73,0x3f7c5d3a,0x3e1c76de,0x3e2bf804,0x3f7baccd,0x3f7ac516,0x3e3b6ecf,0x3e4dee60,0x3f7a1e84,0x3f78e3d6,0x3e5a3997,0x3e6fa8b2
.long 0x3f7853f8,0x3f76ba07,0x3e78cfcc,0x3e888e93,0x3f764d97,0x3f74484b,0x3e8b9507,0x3e9920fe,0x3f740bdd,0x3f718f57,0x3e9aa086,0x3ea986c4,0x3f718f57,0x3f6e8ff8,0x3ea986c4,0x3eb9bb1e
.long 0x3f6ed89e,0x3f6b4b0c,0x3eb8442a,0x3ec9b953,0x3f6be858,0x3f67c187,0x3ec6d529,0x3ed97cb9,0x3f68bf3c,0x3f63f473,0x3ed53641,0x3ee900b7,0x3f655e0b,0x3f5fe4e9,0x3ee363fa,0x3ef840c8
.long 0x3f61c598,0x3f5b941a,0x3ef15aea,0x3f039c3d,0x3f5df6be,0x3f570348,0x3eff17b2,0x3f0af1b7,0x3f59f26a,0x3f5233c6,0x3f064b82,0x3f121eb0,0x3f55b993,0x3f4d26fd,0x3f0cead0,0x3f19210f
.long 0x3f514d3d,0x3f47de65,0x3f13682a,0x3f1ff6cb,0x3f4cae79,0x3f425b89,0x3f19c200,0x3f269de3,0x3f47de65,0x3f3ca003,0x3f1ff6cb,0x3f2d1469,0x3f42de29,0x3f36ad7f,0x3f26050a,0x3f33587a
.long 0x3f3daef9,0x3f3085bb,0x3f2beb4a,0x3f396842,0x3f385216,0x3f2a2a80,0x3f31a81d,0x3f3f41fc,0x3f32c8c9,0x3f239da9,0x3f373a23,0x3f44e3f5,0x3f2d1469,0x3f1ce11f,0x3f3ca003,0x3f4a4c87
.long 0x3f273656,0x3f15f6d9,0x3f41d870,0x3f4f7a1f,0x3f212ff9,0x3f0ee0db,0x3f46e22a,0x3f546b3b,0x3f1b02c6,0x3f07a136,0x3f4bbbf8,0x3f591e6a,0x3f14b039,0x3f003a06,0x3f5064af,0x3f5d924d
.long 0x3f800000,0x3f800000,0x00000000,0x00000000,0x3f7fc38f,0x3f7fba9e,0x3d2fe007,0x3d3c6dd5,0x3f7f0e58,0x3f7eea9d,0x3dafb680,0x3dbc3ac3,0x3f7de0b1,0x3f7d906e,0x3e039502,0x3e0cec4a
.long 0x3f7c3b28,0x3f7baccd,0x3e2f10a2,0x3e3b6ecf,0x3f7a1e84,0x3f7940c0,0x3e5a3997,0x3e698bba,0x3f778bc5,0x3f764d97,0x3e827dc0,0x3e8b9507,0x3f748422,0x3f72d4eb,0x3e97a117,0x3ea21887
.long 0x3f710908,0x3f6ed89e,0x3eac7cd4,0x3eb8442a,0x3f6d1c1d,0x3f6a5ad9,0x3ec1071e,0x3ece0bea,0x3f68bf3c,0x3f655e0b,0x3ed53641,0x3ee363fa,0x3f63f473,0x3f5fe4e9,0x3ee900b7,0x3ef840c8
.long 0x3f5ebe05,0x3f59f26a,0x3efc5d27,0x3f064b82,0x3f591e6a,0x3f5389c7,0x3f07a136,0x3f102dd5,0x3f531849,0x3f4cae79,0x3f10d3cd,0x3f19c200,0x3f4cae79,0x3f456439,0x3f19c200,0x3f2302d3
.long 0x3f45e403,0x3f3daef9,0x3f226799,0x3f2beb4a,0x3f3ebc1b,0x3f3592e7,0x3f2ac082,0x3f34768f,0x3f373a23,0x3f2d1469,0x3f32c8c9,0x3f3ca003,0x3f2f61a5,0x3f24381a,0x3f3a7ca4,0x3f446337
.long 0x3f273656,0x3f1b02c6,0x3f41d870,0x3f4bbbf8,0x3f1ebc12,0x3f11796b,0x3f48d8b3,0x3f52a649,0x3f15f6d9,0x3f07a136,0x3f4f7a1f,0x3f591e6a,0x3f0cead0,0x3efafef7,0x3f55b993,0x3f5f20db
.long 0x3f039c3d,0x3ee63375,0x3f5b941a,0x3f64aa59,0x3ef41f07,0x3ed0eb2a,0x3f6106f2,0x3f69b7e4,0x3ee0924f,0x3ebb31a0,0x3f660f88,0x3f6e46be,0x3ecc9b8b,0x3ea5129f,0x3f6aab7b,0x3f725470
.long 0x3eb8442a,0x3e8e9a22,0x3f6ed89e,0x3f75dec6,0x3ea395c5,0x3e6fa8b2,0x3f7294f8,0x3f78e3d6,0x3e8e9a22,0x3e419b37,0x3f75dec6,0x3f7b61fc,0x3e72b651,0x3e1324ca,0x3f78b47b,0x3f7d57de
.long 0x3f800000,0x3f800000,0x00000000,0x00000000,0x3f7fb10f,0x3f7fa6e3,0x3d48fb30,0x3d55880e,0x3f7ec46d,0x3f7e9bc9,0x3dc8bd36,0x3dd53db9,0x3f7d3aac,0x3f7cdf6c,0x3e164083,0x3e1f917b
.long 0x3f7b14be,0x3f7a7302,0x3e47c5c2,0x3e541501,0x3f7853f8,0x3f77583a,0x3e78cfcc,0x3e840270,0x3f74fa0b,0x3f73913f,0x3e94a031,0x3e9d9e78,0x3f710908,0x3f6f20b0,0x3eac7cd4,0x3eb6ccc3
.long 0x3f6c835e,0x3f6a09a7,0x3ec3ef15,0x3ecf7bca,0x3f676bd8,0x3f644fac,0x3edae880,0x3ee79a5d,0x3f61c598,0x3f5df6be,0x3ef15aea,0x3eff17b2,0x3f5b941a,0x3f570348,0x3f039c3d,0x3f0af1b7
.long 0x3f54db31,0x3f4f7a1f,0x3f0e39da,0x3f15f6d9,0x3f4d9f02,0x3f476085,0x3f187fc0,0x3f209393,0x3f45e403,0x3f3ebc1b,0x3f226799,0x3f2ac082,0x3f3daef9,0x3f3592e7,0x3f2beb4a,0x3f34768f
.long 0x3f3504f3,0x3f2beb4a,0x3f3504f3,0x3f3daef9,0x3f2beb4a,0x3f21cbfb,0x3f3daef9,0x3f466354,0x3f226799,0x3f173c07,0x3f45e403,0x3f4e8d90,0x3f187fc0,0x3f0c42c9,0x3f4d9f02,0x3f5627fe
.long 0x3f0e39da,0x3f00e7e4,0x3f54db31,0x3f5d2d53,0x3f039c3d,0x3eea6681,0x3f5b941a,0x3f6398ac,0x3ef15aea,0x3ed25a09,0x3f61c598,0x3f696591,0x3edae880,0x3eb9bb1e,0x3f676bd8,0x3f6e8ff8
.long 0x3ec3ef15,0x3ea09ae5,0x3f6c835e,0x3f731447,0x3eac7cd4,0x3e870ada,0x3f710908,0x3f76ef5b,0x3e94a031,0x3e5a3997,0x3f74fa0b,0x3f7a1e84,0x3e78cfcc,0x3e25c58c,0x3f7853f8,0x3f7c9f8a
.long 0x3e47c5c2,0x3de1bc2e,0x3f7b14be,0x3f7e70b0,0x3e164083,0x3d6ea038,0x3f7d3aac,0x3f7f90b1,0x3dc8bd36,0x3bc90f88,0x3f7ec46d,0x3f7ffec4,0x3d48fb30,0xbd3c6dd5,0x3f7fb10f,0x3f7fba9e
.long 0x3f800000,0x3f800000,0x00000000,0x00000000,0x3f7f84ab,0x3f7f7808,0x3d7b2b74,0x3d83db0a,0x3f7e1324,0x3f7de0b1,0x3dfab273,0x3e039502,0x3f7baccd,0x3f7b3bab,0x3e3b6ecf,0x3e44b0b9
.long 0x3f7853f8,0x3f778bc5,0x3e78cfcc,0x3e827dc0,0x3f740bdd,0x3f72d4eb,0x3e9aa086,0x3ea21887,0x3f6ed89e,0x3f6d1c1d,0x3eb8442a,0x3ec1071e,0x3f68bf3c,0x3f666771,0x3ed53641,0x3edf28a9
.long 0x3f61c598,0x3f5ebe05,0x3ef15aea,0x3efc5d27,0x3f59f26a,0x3f5627fe,0x3f064b82,0x3f0c42c9,0x3f514d3d,0x3f4cae79,0x3f13682a,0x3f19c200,0x3f47de65,0x3f425b89,0x3f1ff6cb,0x3f269de3
.long 0x3f3daef9,0x3f373a23,0x3f2beb4a,0x3f32c8c9,0x3f32c8c9,0x3f2b561b,0x3f373a23,0x3f3e35c5,0x3f273656,0x3f1ebc12,0x3f41d870,0x3f48d8b3,0x3f1b02c6,0x3f11796b,0x3f4bbbf8,0x3f52a649
.long 0x3f0e39da,0x3f039c3d,0x3f54db31,0x3f5b941a,0x3f00e7e4,0x3eea6681,0x3f5d2d53,0x3f6398ac,0x3ee63375,0x3ecc9b8b,0x3f64aa59,0x3f6aab7b,0x3ec9b953,0x3eadf73c,0x3f6b4b0c,0x3f70c501
.long 0x3eac7cd4,0x3e8e9a22,0x3f710908,0x3f75dec6,0x3e8e9a22,0x3e5d4b1a,0x3f75dec6,0x3f79f35e,0x3e605c13,0x3e1c76de,0x3f79c79d,0x3f7cfe73,0x3e22abb6,0x3db5f8da,0x3f7cbfc9,0x3f7efcc9
.long 0x3dc8bd36,0x3cc90ab0,0x3f7ec46d,0x3f7fec43,0x3d16c32c,0xbd2351cb,0x3f7fd397,0x3f7fcbe2,0xbcc90ab0,0xbdd53db9,0x3f7fec43,0x3f7e9bc9,0xbdafb680,0xbe2bf804,0x3f7f0e58,0x3f7c5d3a
.long 0xbe164083,0xbe6c9a7f,0x3f7d3aac,0x3f791298,0xbe541501,0xbe9620d2,0x3f7a7302,0x3f74bf62,0xbe888e93,0xbeb554ec,0x3f76ba07,0x3f6f6830,0xbea68f12,0xbed3c867,0x3f721352,0x3f6912ae
.long 0x3f800000,0x3f800000,0x00000000,0x00000000,0x3f7f9c18,0x3f7f90b1,0x3d621469,0x3d6ea038,0x3f7e70b0,0x3f7e4323,0x3de1bc2e,0x3dee3876,0x3f7c7eb0,0x3f7c187a,0x3e28defc,0x3e3228d4
.long 0x3f79c79d,0x3f791298,0x3e605c13,0x3e6c9a7f,0x3f764d97,0x3f75341d,0x3e8b9507,0x3e931f35,0x3f721352,0x3f708066,0x3ea68f12,0x3eaf713a,0x3f6d1c1d,0x3f6afb8c,0x3ec1071e,0x3ecb2aae
.long 0x3f676bd8,0x3f64aa59,0x3edae880,0x3ee63375,0x3f6106f2,0x3f5d924d,0x3ef41f07,0x3f003a06,0x3f59f26a,0x3f55b993,0x3f064b82,0x3f0cead0,0x3f5233c6,0x3f4d26fd,0x3f121eb0,0x3f19210f
.long 0x3f49d112,0x3f43e200,0x3f1d7fd1,0x3f24d225,0x3f40d0da,0x3f39f2ac,0x3f286605,0x3f2ff3e6,0x3f373a23,0x3f2f61a5,0x3f32c8c9,0x3f3a7ca4,0x3f2d1469,0x3f24381a,0x3f3ca003,0x3f446337
.long 0x3f226799,0x3f187fc0,0x3f45e403,0x3f4d9f02,0x3f173c07,0x3f0c42c9,0x3f4e8d90,0x3f5627fe,0x3f0b9a6b,0x3eff17b2,0x3f5695e5,0x3f5df6be,0x3eff17b2,0x3ee4cbfe,0x3f5df6be,0x3f650479
.long 0x3ee63375,0x3ec9b953,0x3f64aa59,0x3f6b4b0c,0x3ecc9b8b,0x3eadf73c,0x3f6aab7b,0x3f70c501,0x3eb263ef,0x3e919ddd,0x3f6ff573,0x3f756d97,0x3e97a117,0x3e698bba,0x3f748422,0x3f7940c0
.long 0x3e78cfcc,0x3e2f10a2,0x3f7853f8,0x3f7c3b28,0x3e419b37,0x3de7fa9a,0x3f7b61fc,0x3f7e5a38,0x3e09cf86,0x3d621469,0x3f7dabcc,0x3f7f9c18,0x3da3308c,0xbb490fc6,0x3f7f2f9d,0x3f7fffb1
.long 0x3cc90ab0,0xbd7b2b74,0x3f7fec43,0x3f7f84ab,0xbcfb49ba,0xbdf475c0,0x3f7fe129,0x3f7e2b72,0xbdafb680,0xbe354098,0x3f7f0e58,0x3f7bf531,0xbe1008b7,0xbe6fa8b2,0x3f7d7474,0x3f78e3d6
.long 0x3f800000,0x3f800000,0x00000000,0x00000000,0x3f7f6ac7,0x3f7f5ce9,0x3d8a200a,0x3d9064b4,0x3f7dabcc,0x3f7d7474,0x3e09cf86,0x3e1008b7,0x3f7ac516,0x3f7a4910,0x3e4dee60,0x3e57278f
.long 0x3f76ba07,0x3f75dec6,0x3e888e93,0x3e8e9a22,0x3f718f57,0x3f703b37,0x3ea986c4,0x3eb0eacb,0x3f6b4b0c,0x3f696591,0x3ec9b953,0x3ed25a09,0x3f63f473,0x3f61668a,0x3ee900b7,0x3ef2bd43
.long 0x3f5b941a,0x3f584853,0x3f039c3d,0x3f08f59b,0x3f5233c6,0x3f4e1689,0x3f121eb0,0x3f17de12,0x3f47de65,0x3f42de29,0x3f1ff6cb,0x3f26050a,0x3f3ca003,0x3f36ad7f,0x3f2d1469,0x3f33587a
.long 0x3f3085bb,0x3f299415,0x3f396842,0x3f3fc767,0x3f239da9,0x3f1ba299,0x3f44e3f5,0x3f4b41fa,0x3f15f6d9,0x3f0cead0,0x3f4f7a1f,0x3f55b993,0x3f07a136,0x3efafef7,0x3f591e6a,0x3f5f20db
.long 0x3ef15aea,0x3edae880,0x3f61c598,0x3f676bd8,0x3ed25a09,0x3eb9bb1e,0x3f696591,0x3f6e8ff8,0x3eb263ef,0x3e97a117,0x3f6ff573,0x3f748422,0x3e919ddd,0x3e698bba,0x3f756d97,0x3f7940c0
.long 0x3e605c13,0x3e22abb6,0x3f79c79d,0x3f7cbfc9,0x3e1c76de,0x3db5f8da,0x3f7cfe73,0x3f7efcc9,0x3dafb680,0x3c96c9b6,0x3f7f0e58,0x3f7ff4e6,0x3c96c9b6,0xbd55880e,0x3f7ff4e6,0x3f7fa6e3
.long 0xbd48fb30,0xbdfab273,0x3f7fb10f,0x3f7e1324,0xbdee3876,0xbe44b0b9,0x3f7e4323,0x3f7b3bab,0xbe3b6ecf,0xbe8586ce,0x3f7baccd,0x3f772417,0xbe7ee6e1,0xbea80b1f,0x3f77f110,0x3f71d19f
.long 0xbea09ae5,0xbec9b953,0x3f731447,0x3f6b4b0c,0xbec1071e,0xbeea6681,0x3f6d1c1d,0x3f6398ac,0xbee0924f,0xbf04f484,0x3f660f88,0x3f5ac450,0xbeff17b2,0xbf140c5f,0x3f5df6be,0x3f50d937
.long 0x3f800000,0x3f800000,0x00000000,0x00000000,0x3f7f4e6d,0x3f7f3f54,0x3d96a905,0x3d9cecf9,0x3f7d3aac,0x3f7cfe73,0x3e164083,0x3e1c76de,0x3f79c79d,0x3f7940c0,0x3e605c13,0x3e698bba
.long 0x3f74fa0b,0x3f740bdd,0x3e94a031,0x3e9aa086,0x3f6ed89e,0x3f6d67a1,0x3eb8442a,0x3ebf926f,0x3f676bd8,0x3f655e0b,0x3edae880,0x3ee363fa,0x3f5ebe05,0x3f5bfb34,0x3efc5d27,0x3f02ef9f
.long 0x3f54db31,0x3f514d3d,0x3f0e39da,0x3f13682a,0x3f49d112,0x3f456439,0x3f1d7fd1,0x3f2302d3,0x3f3daef9,0x3f385216,0x3f2beb4a,0x3f31a81d,0x3f3085bb,0x3f2a2a80,0x3f396842,0x3f3f41fc
.long 0x3f226799,0x3f1b02c6,0x3f45e403,0x3f4bbbf8,0x3f13682a,0x3f0af1b7,0x3f514d3d,0x3f570348,0x3f039c3d,0x3ef41f07,0x3f5b941a,0x3f6106f2,0x3ee63375,0x3ed0eb2a,0x3f64aa59,0x3f69b7e4
.long 0x3ec3ef15,0x3eac7cd4,0x3f6c835e,0x3f710908,0x3ea09ae5,0x3e870ada,0x3f731447,0x3f76ef5b,0x3e78cfcc,0x3e419b37,0x3f7853f8,0x3f7b61fc,0x3e2f10a2,0x3de7fa9a,0x3f7c3b28,0x3f7e5a38
.long 0x3dc8bd36,0x3d16c32c,0x3f7ec46d,0x3f7fd397,0x3cc90ab0,0xbd2351cb,0x3f7fec43,0x3f7fcbe2,0xbd48fb30,0xbdee3876,0x3f7fb10f,0x3f7e4323,0xbdfab273,0xbe44b0b9,0x3f7e1324,0x3f7b3bab
.long 0xbe47c5c2,0xbe888e93,0x3f7b14be,0x3f76ba07,0xbe888e93,0xbeadf73c,0x3f76ba07,0x3f70c501,0xbeac7cd4,0xbed25a09,0x3f710908,0x3f696591,0xbecf7bca,0xbef58035,0x3f6a09a7,0x3f60a6cf
.long 0xbef15aea,0xbf0b9a6b,0x3f61c598,0x3f5695e5,0xbf08f59b,0xbf1ba299,0x3f584853,0x3f4b41fa,0xbf187fc0,0xbf2ac082,0x3f4d9f02,0x3f3ebc1b,0xbf273656,0xbf38dd65,0x3f41d870,0x3f311722
.long 0x3f800000,0x3f800000,0x00000000,0x00000000,0x3f7f0e58,0x3f7efcc9,0x3dafb680,0x3db5f8da,0x3f7c3b28,0x3f7bf531,0x3e2f10a2,0x3e354098,0x3f778bc5,0x3f76ef5b,0x3e827dc0,0x3e870ada
.long 0x3f710908,0x3f6ff573,0x3eac7cd4,0x3eb263ef,0x3f68bf3c,0x3f671599,0x3ed53641,0x3edc53c1,0x3f5ebe05,0x3f5c61c7,0x3efc5d27,0x3f0242b1,0x3f531849,0x3f4fefa8,0x3f10d3cd,0x3f1553b7
.long 0x3f45e403,0x3f41d870,0x3f226799,0x3f273656,0x3f373a23,0x3f3238aa,0x3f32c8c9,0x3f37c655,0x3f273656,0x3f212ff9,0x3f41d870,0x3f46e22a,0x3f15f6d9,0x3f0ee0db,0x3f4f7a1f,0x3f546b3b
.long 0x3f039c3d,0x3ef6e0cb,0x3f5b941a,0x3f604621,0x3ee0924f,0x3ece0bea,0x3f660f88,0x3f6a5ad9,0x3eb8442a,0x3ea395c5,0x3f6ed89e,0x3f7294f8,0x3e8e9a22,0x3e6fa8b2,0x3f75dec6,0x3f78e3d6
.long 0x3e47c5c2,0x3e164083,0x3f7b14be,0x3f7d3aac,0x3de1bc2e,0x3d6ea038,0x3f7e70b0,0x3f7f90b1,0x3cc90ab0,0xbcfb49ba,0x3f7fec43,0x3f7fe129,0xbd7b2b74,0xbdf475c0,0x3f7f84ab,0x3f7e2b72
.long 0xbe164083,0xbe541501,0x3f7d3aac,0x3f7a7302,0xbe6c9a7f,0xbe9620d2,0x3f791298,0x3f74bf62,0xbea09ae5,0xbec1071e,0x3f731447,0x3f6d1c1d,0xbec9b953,0xbeea6681,0x3f6b4b0c,0x3f6398ac
.long 0xbef15aea,0xbf08f59b,0x3f61c598,0x3f584853,0xbf0b9a6b,0xbf1ba299,0x3f5695e5,0x3f4b41fa,0xbf1d7fd1,0xbf2d1469,0x3f49d112,0x3f3ca003,0xbf2e3bde,0xbf3d27b8,0x3f3b8f3b,0x3f2c800f
.long 0xbf3daef9,0xbf4bbbf8,0x3f2beb4a,0x3f1b02c6,0xbf4bbbf8,0xbf58b3a1,0x3f1b02c6,0x3f084b92,0xbf584853,0xbf63f473,0x3f08f59b,0x3ee900b7,0xbf633c5a,0xbf6d67a1,0x3eebcbbb,0x3ebf926f
.long 0x3f800000,0x3f800000,0x00000000,0x00000000,0x3f7f2f9d,0x3f7f1f49,0x3da3308c,0x3da973ba,0x3f7cbfc9,0x3f7c7eb0,0x3e22abb6,0x3e28defc,0x3f78b47b,0x3f7822d1,0x3e72b651,0x3e7bdba4
.long 0x3f731447,0x3f721352,0x3ea09ae5,0x3ea68f12,0x3f6be858,0x3f6a5ad9,0x3ec6d529,0x3ece0bea,0x3f633c5a,0x3f6106f2,0x3eebcbbb,0x3ef41f07,0x3f591e6a,0x3f5627fe,0x3f07a136,0x3f0c42c9
.long 0x3f4d9f02,0x3f49d112,0x3f187fc0,0x3f1d7fd1,0x3f40d0da,0x3f3c17d9,0x3f286605,0x3f2da859,0x3f32c8c9,0x3f2d1469,0x3f373a23,0x3f3ca003,0x3f239da9,0x3f1ce11f,0x3f44e3f5,0x3f4a4c87
.long 0x3f13682a,0x3f0b9a6b,0x3f514d3d,0x3f5695e5,0x3f0242b1,0x3ef2bd43,0x3f5c61c7,0x3f61668a,0x3ee0924f,0x3ecc9b8b,0x3f660f88,0x3f6aab7b,0x3ebb31a0,0x3ea5129f,0x3f6e46be,0x3f725470
.long 0x3e94a031,0x3e78cfcc,0x3f74fa0b,0x3f7853f8,0x3e5a3997,0x3e25c58c,0x3f7a1e84,0x3f7c9f8a,0x3e09cf86,0x3da3308c,0x3f7dabcc,0x3f7f2f9d,0x3d621469,0xbb490fc6,0x3f7f9c18,0x3f7fffb1
.long 0xbcc90ab0,0xbdafb680,0x3f7fec43,0x3f7f0e58,0xbdd53db9,0xbe2bf804,0x3f7e9bc9,0x3f7c5d3a,0xbe3b6ecf,0xbe7ee6e1,0x3f7baccd,0x3f77f110,0xbe8586ce,0xbea80b1f,0x3f772417,0x3f71d19f
.long 0xbeac7cd4,0xbecf7bca,0x3f710908,0x3f6a09a7,0xbed25a09,0xbef58035,0x3f696591,0x3f60a6cf,0xbef6e0cb,0xbf0cead0,0x3f604621,0x3f55b993,0xbf0cead0,0xbf1e1e22,0x3f55b993,0x3f495521
.long 0xbf1d7fd1,0xbf2e3bde,0x3f49d112,0x3f3b8f3b,0xbf2d1469,0xbf3d27b8,0x3f3ca003,0x3f2c800f,0xbf3b8f3b,0xbf4ac77f,0x3f2e3bde,0x3f1c420c,0xbf48d8b3,0xbf570348,0x3f1ebc12,0x3f0af1b7
.long 0x3f800000,0x3f800000,0x00000000,0x00000000,0x3f7eea9d,0x3f7ed7d4,0x3dbc3ac3,0x3dc27c39,0x3f7baccd,0x3f7b61fc,0x3e3b6ecf,0x3e419b37,0x3f764d97,0x3f75a67b,0x3e8b9507,0x3e901c2c
.long 0x3f6ed89e,0x3f6db293,0x3eb8442a,0x3ebe1d4a,0x3f655e0b,0x3f6398ac,0x3ee363fa,0x3eea6681,0x3f59f26a,0x3f577026,0x3f064b82,0x3f0a48ad,0x3f4cae79,0x3f495521,0x3f19c200,0x3f1e1e22
.long 0x3f3daef9,0x3f396842,0x3f2beb4a,0x3f3085bb,0x3f2d1469,0x3f27ce61,0x3f3ca003,0x3f4154e1,0x3f1b02c6,0x3f14b039,0x3f4bbbf8,0x3f5064af,0x3f07a136,0x3f003a06,0x3f591e6a,0x3f5d924d
.long 0x3ee63375,0x3ed53641,0x3f64aa59,0x3f68bf3c,0x3ebb31a0,0x3ea80b1f,0x3f6e46be,0x3f71d19f,0x3e8e9a22,0x3e72b651,0x3f75dec6,0x3f78b47b,0x3e419b37,0x3e1324ca,0x3f7b61fc,0x3f7d57de
.long 0x3dc8bd36,0x3d48fb30,0x3f7ec46d,0x3f7fb10f,0x3bc90f88,0xbd3c6dd5,0x3f7ffec4,0x3f7fba9e,0xbdafb680,0xbe1008b7,0x3f7f0e58,0x3f7d7474,0xbe354098,0xbe6fa8b2,0x3f7bf531,0x3f78e3d6
.long 0xbe888e93,0xbea68f12,0x3f76ba07,0x3f721352,0xbeb554ec,0xbed3c867,0x3f6f6830,0x3f6912ae,0xbee0924f,0xbeff17b2,0x3f660f88,0x3f5df6be,0xbf04f484,0xbf140c5f,0x3f5ac450,0x3f50d937
.long 0xbf187fc0,0xbf273656,0x3f4d9f02,0x3f41d870,0xbf2ac082,0xbf38dd65,0x3f3ebc1b,0x3f311722,0xbf3b8f3b,0xbf48d8b3,0x3f2e3bde,0x3f1ebc12,0xbf4ac77f,0xbf570348,0x3f1c420c,0x3f0af1b7
.long 0xbf584853,0xbf633c5a,0x3f08f59b,0x3eebcbbb,0xbf63f473,0xbf6d67a1,0x3ee900b7,0x3ebf926f,0xbf6db293,0xbf756d97,0x3ebe1d4a,0x3e919ddd,0xbf756d97,0xbf7b3bab,0x3e919ddd,0x3e44b0b9
.long 0x3f803f80,0x3f803f80,0x3f803f80,0x3f803f80,0x3f7f3f80,0x3f753f7b,0x3f223f35,0x3ef13f0e
.long 0x3f7b3f80,0x3f553f6d,0xbe48248d,0xbf0ebec4,0x3f753f80,0x3f223f55,0xbf62bf35,0xbf7fbf7b
.long 0x3f6d3f80,0x3ec43f35,0xbf6dbf80,0xbec4bf35,0x3f623f80,0x3dc93f0e,0xbe95bf35,0x3f223e48
.long 0x3f553f80,0xbe483ec4,0x3f0ea554,0x3f7b3f6d,0x3f463f80,0xbef13e48,0x3f7f3f35,0x3e953f55
.long 0x3f353f80,0xbf35248d,0x3f353f80,0xbf35248d,0x3f223f80,0xbf62be48,0xbdc93f35,0xbf75bf55
.long 0x3f0e3f80,0xbf7bbec4,0xbf55248d,0xbe48bf6d,0x3ef13f80,0xbf7fbf0e,0xbf75bf35,0x3f46be48
.long 0x3ec43f80,0xbf6dbf35,0xbec4bf80,0x3f6d3f35,0x3e953f80,0xbf46bf55,0x3ef1bf35,0x3dc93f7b
.long 0x3e483f80,0xbf0ebf6d,0x3f7ba554,0xbf553ec4,0x3dc93f80,0xbe95bf7b,0x3f463f35,0xbf62bf0e
.long 0x248d3f80,0xa554bf80,0x248d3f80,0xa554bf80,0xbdc93f80,0x3e95bf7b,0xbf463f35,0x3f62bf0e
.long 0xbe483f80,0x3f0ebf6d,0xbf7b248d,0x3f553ec4,0xbe953f80,0x3f46bf55,0xbef1bf35,0xbdc93f7b
.long 0xbec43f80,0x3f6dbf35,0x3ec4bf80,0xbf6d3f35,0xbef13f80,0x3f7fbf0e,0x3f75bf35,0xbf46be48
.long 0xbf0e3f80,0x3f7bbec4,0x3f55a554,0x3e48bf6d,0xbf223f80,0x3f62be48,0x3dc93f35,0x3f75bf55
.long 0xbf353f80,0x3f35a554,0xbf353f80,0x3f35a554,0xbf463f80,0x3ef13e48,0xbf7f3f35,0xbe953f55
.long 0xbf553f80,0x3e483ec4,0xbf0e248d,0xbf7b3f6d,0xbf623f80,0xbdc93f0e,0x3e95bf35,0xbf223e48
.long 0xbf6d3f80,0xbec43f35,0x3f6dbf80,0x3ec4bf35,0xbf753f80,0xbf223f55,0x3f62bf35,0x3f7fbf7b
.long 0xbf7b3f80,0xbf553f6d,0x3e48a554,0x3f0ebec4,0xbf7f3f80,0xbf753f7b,0xbf223f35,0xbef13f0e
.long 0x3f803f80,0x3f803f80,0x3f803f80,0x3f803f80,0x3f623f6d,0x3f463f55,0x3e953ec4,0x3dc93e48
.long 0x3f0e3f35,0x3e483ec4,0xbf55bf35,0xbf7bbf6d,0x3dc93ec4,0xbef1be48,0xbf46bf6d,0xbe95bf0e
.long 0xbec4248d,0xbf6dbf35,0x3ec4a554,0x3f6d3f35,0xbf46bec4,0xbf75bf7b,0x3f7f3f6d,0x3ef13f55
.long 0xbf7bbf35,0xbf0ebf6d,0x3e483f35,0xbf55bec4,0xbf75bf6d,0x3dc9bf0e,0xbf62bec4,0xbf22bf7b
.long 0xbf35bf80,0x3f35a554,0xbf35bf80,0x3f35a554,0xbe95bf6d,0x3f7f3f0e,0x3ef1bec4,0x3f463f7b
.long 0x3e48bf35,0x3f553f6d,0x3f7b3f35,0xbf0e3ec4,0x3f22bec4,0x3e953f7b,0x3dc93f6d,0xbf62bf55
.long 0x3f6da554,0xbec43f35,0xbf6d248d,0x3ec4bf35,0x3f7f3ec4,0xbf623e48,0xbf22bf6d,0x3f753f0e
.long 0x3f553f35,0xbf7bbec4,0x3f0ebf35,0xbe483f6d,0x3ef13f6d,0xbf22bf55,0x3f753ec4,0xbf7fbe48
.long 0x248d3f80,0xa554bf80,0x248d3f80,0xa554bf80,0xbef13f6d,0x3f22bf55,0xbf753ec4,0x3f7fbe48
.long 0xbf553f35,0x3f7bbec4,0xbf0ebf35,0x3e483f6d,0xbf7f3ec4,0x3f623e48,0x3f22bf6d,0xbf753f0e
.long 0xbf6d248d,0x3ec43f35,0x3f6da554,0xbec4bf35,0xbf22bec4,0xbe953f7b,0xbdc93f6d,0x3f62bf55
.long 0xbe48bf35,0xbf553f6d,0xbf7b3f35,0x3f0e3ec4,0x3e95bf6d,0xbf7f3f0e,0xbef1bec4,0xbf463f7b
.long 0x3f35bf80,0xbf35248d,0x3f35bf80,0xbf35248d,0x3f75bf6d,0xbdc9bf0e,0x3f62bec4,0x3f22bf7b
.long 0x3f7bbf35,0x3f0ebf6d,0xbe483f35,0x3f55bec4,0x3f46bec4,0x3f75bf7b,0xbf7f3f6d,0xbef13f55
.long 0x3ec4a554,0x3f6dbf35,0xbec4248d,0xbf6d3f35,0xbdc93ec4,0x3ef1be48,0x3f46bf6d,0x3e95bf0e
.long 0xbf0e3f35,0xbe483ec4,0x3f55bf35,0x3f7bbf6d,0xbf623f6d,0xbf463f55,0xbe953ec4,0xbdc93e48
.long 0x3f803f80,0x3f803f80,0x3f803f80,0x3f803f80,0xbdc9248d,0xbe95be48,0xbf46bf35,0xbf62bf55
.long 0xbf7bbf80,0xbf55bf6d,0x3e48a554,0x3f0e3ec4,0x3e95a554,0x3f463f0e,0x3ef13f35,0xbdc93e48
.long 0x3f6d3f80,0x3ec43f35,0xbf6dbf80,0xbec4bf35,0xbef1248d,0xbf7fbf55,0x3f753f35,0x3f463f7b
.long 0xbf55bf80,0x3e48bec4,0xbf0e248d,0xbf7bbf6d,0x3f22a554,0x3f623f7b,0xbdc9bf35,0x3f753f0e
.long 0x3f353f80,0xbf35248d,0x3f353f80,0xbf35248d,0xbf46248d,0xbef1bf7b,0xbf7fbf35,0x3e95bf0e
.long 0xbf0ebf80,0x3f7b3ec4,0x3f55a554,0x3e483f6d,0x3f62a554,0xbdc93f55,0xbe953f35,0xbf22bf7b
.long 0x3ec43f80,0xbf6dbf35,0xbec4bf80,0x3f6d3f35,0xbf75248d,0x3f22bf0e,0x3f623f35,0xbf7fbe48
.long 0xbe48bf80,0x3f0e3f6d,0xbf7b248d,0x3f55bec4,0x3f7fa554,0xbf753e48,0x3f22bf35,0xbef13f55
.long 0x248d3f80,0xa554bf80,0x248d3f80,0xa554bf80,0xbf7f248d,0x3f753e48,0xbf22bf35,0x3ef13f55
.long 0x3e48bf80,0xbf0e3f6d,0x3f7ba554,0xbf55bec4,0x3f75a554,0xbf22bf0e,0xbf623f35,0x3f7fbe48
.long 0xbec43f80,0x3f6dbf35,0x3ec4bf80,0xbf6d3f35,0xbf62248d,0x3dc93f55,0x3e953f35,0x3f22bf7b
.long 0x3f0ebf80,0xbf7b3ec4,0xbf55248d,0xbe483f6d,0x3f46a554,0x3ef1bf7b,0x3f7fbf35,0xbe95bf0e
.long 0xbf353f80,0x3f35a554,0xbf353f80,0x3f35a554,0xbf22248d,0xbf623f7b,0x3dc9bf35,0xbf753f0e
.long 0x3f55bf80,0xbe48bec4,0x3f0ea554,0x3f7bbf6d,0x3ef1a554,0x3f7fbf55,0xbf753f35,0xbf463f7b
.long 0xbf6d3f80,0xbec43f35,0x3f6dbf80,0x3ec4bf35,0xbe95248d,0xbf463f0e,0xbef13f35,0x3dc93e48
.long 0x3f7bbf80,0x3f55bf6d,0xbe48248d,0xbf0e3ec4,0x3dc9a554,0x3e95be48,0x3f46bf35,0x3f62bf55
.long 0x3f803f80,0x3f803f80,0x3f803f80,0x3f803f80,0xbef1bec4,0xbf22bf0e,0xbf75bf6d,0xbf7fbf7b
.long 0xbf0ebf35,0xbe48bec4,0x3f553f35,0x3f7b3f6d,0x3f7f3f6d,0x3f623f7b,0xbf22bec4,0xbf75bf55
.long 0xbec4248d,0xbf6dbf35,0x3ec4a554,0x3f6d3f35,0xbf22bf6d,0x3e95be48,0xbdc93ec4,0xbf62bf0e
.long 0x3f7b3f35,0x3f0e3f6d,0xbe48bf35,0x3f553ec4,0xbe953ec4,0xbf7fbf55,0x3ef13f6d,0xbf46be48
.long 0xbf35bf80,0x3f35a554,0xbf35bf80,0x3f35a554,0x3f753ec4,0x3dc93f55,0x3f623f6d,0xbf223e48
.long 0xbe483f35,0xbf55bf6d,0xbf7bbf35,0x3f0ebec4,0xbf46bf6d,0x3f753e48,0x3f7f3ec4,0xbef13f0e
.long 0x3f6da554,0xbec43f35,0xbf6d248d,0x3ec4bf35,0xbdc93f6d,0xbef1bf7b,0x3f46bec4,0xbe953f55
.long 0xbf55bf35,0x3f7b3ec4,0xbf0e3f35,0x3e48bf6d,0x3f62bec4,0xbf463f0e,0x3e95bf6d,0xbdc93f7b
.long 0x248d3f80,0xa554bf80,0x248d3f80,0xa554bf80,0xbf62bec4,0x3f463f0e,0xbe95bf6d,0x3dc93f7b
.long 0x3f55bf35,0xbf7b3ec4,0x3f0e3f35,0xbe48bf6d,0x3dc93f6d,0x3ef1bf7b,0xbf46bec4,0x3e953f55
.long 0xbf6d248d,0x3ec43f35,0x3f6da554,0xbec4bf35,0x3f46bf6d,0xbf753e48,0xbf7f3ec4,0x3ef13f0e
.long 0x3e483f35,0x3f55bf6d,0x3f7bbf35,0xbf0ebec4,0xbf753ec4,0xbdc93f55,0xbf623f6d,0x3f223e48
.long 0x3f35bf80,0xbf35248d,0x3f35bf80,0xbf35248d,0x3e953ec4,0x3f7fbf55,0xbef13f6d,0x3f46be48
.long 0xbf7b3f35,0xbf0e3f6d,0x3e48bf35,0xbf553ec4,0x3f22bf6d,0xbe95be48,0x3dc93ec4,0x3f62bf0e
.long 0x3ec4a554,0x3f6dbf35,0xbec4248d,0xbf6d3f35,0xbf7f3f6d,0xbf623f7b,0x3f22bec4,0x3f75bf55
.long 0x3f0ebf35,0x3e48bec4,0xbf553f35,0xbf7b3f6d,0x3ef1bec4,0x3f22bf0e,0x3f75bf6d,0x3f7fbf7b
.long 0x3f803f80,0x3f803f80,0x3f803f80,0x3f803f80,0xbf7fbf80,0xbf75bf7b,0xbf22bf35,0xbef1bf0e
.long 0x3f7b3f80,0x3f553f6d,0xbe48248d,0xbf0ebec4,0xbf75bf80,0xbf22bf55,0x3f623f35,0x3f7f3f7b
.long 0x3f6d3f80,0x3ec43f35,0xbf6dbf80,0xbec4bf35,0xbf62bf80,0xbdc9bf0e,0x3e953f35,0xbf22be48
.long 0x3f553f80,0xbe483ec4,0x3f0ea554,0x3f7b3f6d,0xbf46bf80,0x3ef1be48,0xbf7fbf35,0xbe95bf55
.long 0x3f353f80,0xbf35248d,0x3f353f80,0xbf35248d,0xbf22bf80,0x3f623e48,0x3dc9bf35,0x3f753f55
.long 0x3f0e3f80,0xbf7bbec4,0xbf55248d,0xbe48bf6d,0xbef1bf80,0x3f7f3f0e,0x3f753f35,0xbf463e48
.long 0x3ec43f80,0xbf6dbf35,0xbec4bf80,0x3f6d3f35,0xbe95bf80,0x3f463f55,0xbef13f35,0xbdc9bf7b
.long 0x3e483f80,0xbf0ebf6d,0x3f7ba554,0xbf553ec4,0xbdc9bf80,0x3e953f7b,0xbf46bf35,0x3f623f0e
.long 0x248d3f80,0xa554bf80,0x248d3f80,0xa554bf80,0x3dc9bf80,0xbe953f7b,0x3f46bf35,0xbf623f0e
.long 0xbe483f80,0x3f0ebf6d,0xbf7b248d,0x3f553ec4,0x3e95bf80,0xbf463f55,0x3ef13f35,0x3dc9bf7b
.long 0xbec43f80,0x3f6dbf35,0x3ec4bf80,0xbf6d3f35,0x3ef1bf80,0xbf7f3f0e,0xbf753f35,0x3f463e48
.long 0xbf0e3f80,0x3f7bbec4,0x3f55a554,0x3e48bf6d,0x3f22bf80,0xbf623e48,0xbdc9bf35,0xbf753f55
.long 0xbf353f80,0x3f35a554,0xbf353f80,0x3f35a554,0x3f46bf80,0xbef1be48,0x3f7fbf35,0x3e95bf55
.long 0xbf553f80,0x3e483ec4,0xbf0e248d,0xbf7b3f6d,0x3f62bf80,0x3dc9bf0e,0xbe953f35,0x3f22be48
.long 0xbf6d3f80,0xbec43f35,0x3f6dbf80,0x3ec4bf35,0x3f75bf80,0x3f22bf55,0xbf623f35,0xbf7f3f7b
.long 0xbf7b3f80,0xbf553f6d,0x3e48a554,0x3f0ebec4,0x3f7fbf80,0x3f75bf7b,0x3f22bf35,0x3ef1bf0e
.long 0x3f803f80,0x3f803f80,0x3f803f80,0x3f803f80,0xbf62bf6d,0xbf46bf55,0xbe95bec4,0xbdc9be48
.long 0x3f0e3f35,0x3e483ec4,0xbf55bf35,0xbf7bbf6d,0xbdc9bec4,0x3ef13e48,0x3f463f6d,0x3e953f0e
.long 0xbec4248d,0xbf6dbf35,0x3ec4a554,0x3f6d3f35,0x3f463ec4,0x3f753f7b,0xbf7fbf6d,0xbef1bf55
.long 0xbf7bbf35,0xbf0ebf6d,0x3e483f35,0xbf55bec4,0x3f753f6d,0xbdc93f0e,0x3f623ec4,0x3f223f7b
.long 0xbf35bf80,0x3f35a554,0xbf35bf80,0x3f35a554,0x3e953f6d,0xbf7fbf0e,0xbef13ec4,0xbf46bf7b
.long 0x3e48bf35,0x3f553f6d,0x3f7b3f35,0xbf0e3ec4,0xbf223ec4,0xbe95bf7b,0xbdc9bf6d,0x3f623f55
.long 0x3f6da554,0xbec43f35,0xbf6d248d,0x3ec4bf35,0xbf7fbec4,0x3f62be48,0x3f223f6d,0xbf75bf0e
.long 0x3f553f35,0xbf7bbec4,0x3f0ebf35,0xbe483f6d,0xbef1bf6d,0x3f223f55,0xbf75bec4,0x3f7f3e48
.long 0x248d3f80,0xa554bf80,0x248d3f80,0xa554bf80,0x3ef1bf6d,0xbf223f55,0x3f75bec4,0xbf7f3e48
.long 0xbf553f35,0x3f7bbec4,0xbf0ebf35,0x3e483f6d,0x3f7fbec4,0xbf62be48,0xbf223f6d,0x3f75bf0e
.long 0xbf6d248d,0x3ec43f35,0x3f6da554,0xbec4bf35,0x3f223ec4,0x3e95bf7b,0x3dc9bf6d,0xbf623f55
.long 0xbe48bf35,0xbf553f6d,0xbf7b3f35,0x3f0e3ec4,0xbe953f6d,0x3f7fbf0e,0x3ef13ec4,0x3f46bf7b
.long 0x3f35bf80,0xbf35248d,0x3f35bf80,0xbf35248d,0xbf753f6d,0x3dc93f0e,0xbf623ec4,0xbf223f7b
.long 0x3f7bbf35,0x3f0ebf6d,0xbe483f35,0x3f55bec4,0xbf463ec4,0xbf753f7b,0x3f7fbf6d,0x3ef1bf55
.long 0x3ec4a554,0x3f6dbf35,0xbec4248d,0xbf6d3f35,0x3dc9bec4,0xbef13e48,0xbf463f6d,0xbe953f0e
.long 0xbf0e3f35,0xbe483ec4,0x3f55bf35,0x3f7bbf6d,0x3f62bf6d,0x3f46bf55,0x3e95bec4,0x3dc9be48
.long 0x3f803f80,0x3f803f80,0x3f803f80,0x3f803f80,0x3dc9a554,0x3e953e48,0x3f463f35,0x3f623f55
.long 0xbf7bbf80,0xbf55bf6d,0x3e48a554,0x3f0e3ec4,0xbe95248d,0xbf46bf0e,0xbef1bf35,0x3dc9be48
.long 0x3f6d3f80,0x3ec43f35,0xbf6dbf80,0xbec4bf35,0x3ef1a554,0x3f7f3f55,0xbf75bf35,0xbf46bf7b
.long 0xbf55bf80,0x3e48bec4,0xbf0e248d,0xbf7bbf6d,0xbf22248d,0xbf62bf7b,0x3dc93f35,0xbf75bf0e
.long 0x3f353f80,0xbf35248d,0x3f353f80,0xbf35248d,0x3f46a554,0x3ef13f7b,0x3f7f3f35,0xbe953f0e
.long 0xbf0ebf80,0x3f7b3ec4,0x3f55a554,0x3e483f6d,0xbf62248d,0x3dc9bf55,0x3e95bf35,0x3f223f7b
.long 0x3ec43f80,0xbf6dbf35,0xbec4bf80,0x3f6d3f35,0x3f75a554,0xbf223f0e,0xbf62bf35,0x3f7f3e48
.long 0xbe48bf80,0x3f0e3f6d,0xbf7b248d,0x3f55bec4,0xbf7f248d,0x3f75be48,0xbf223f35,0x3ef1bf55
.long 0x248d3f80,0xa554bf80,0x248d3f80,0xa554bf80,0x3f7fa554,0xbf75be48,0x3f223f35,0xbef1bf55
.long 0x3e48bf80,0xbf0e3f6d,0x3f7ba554,0xbf55bec4,0xbf75248d,0x3f223f0e,0x3f62bf35,0xbf7f3e48
.long 0xbec43f80,0x3f6dbf35,0x3ec4bf80,0xbf6d3f35,0x3f62a554,0xbdc9bf55,0xbe95bf35,0xbf223f7b
.long 0x3f0ebf80,0xbf7b3ec4,0xbf55248d,0xbe483f6d,0xbf46248d,0xbef13f7b,0xbf7f3f35,0x3e953f0e
.long 0xbf353f80,0x3f35a554,0xbf353f80,0x3f35a554,0x3f22a554,0x3f62bf7b,0xbdc93f35,0x3f75bf0e
.long 0x3f55bf80,0xbe48bec4,0x3f0ea554,0x3f7bbf6d,0xbef1248d,0xbf7f3f55,0x3f75bf35,0x3f46bf7b
.long 0xbf6d3f80,0xbec43f35,0x3f6dbf80,0x3ec4bf35,0x3e95a554,0x3f46bf0e,0x3ef1bf35,0xbdc9be48
.long 0x3f7bbf80,0x3f55bf6d,0xbe48248d,0xbf0e3ec4,0xbdc9248d,0xbe953e48,0xbf463f35,0xbf623f55
.long 0x3f803f80,0x3f803f80,0x3f803f80,0x3f803f80,0x3ef13ec4,0x3f223f0e,0x3f753f6d,0x3f7f3f7b
.long 0xbf0ebf35,0xbe48bec4,0x3f553f35,0x3f7b3f6d,0xbf7fbf6d,0xbf62bf7b,0x3f223ec4,0x3f753f55
.long 0xbec4248d,0xbf6dbf35,0x3ec4a554,0x3f6d3f35,0x3f223f6d,0xbe953e48,0x3dc9bec4,0x3f623f0e
.long 0x3f7b3f35,0x3f0e3f6d,0xbe48bf35,0x3f553ec4,0x3e95bec4,0x3f7f3f55,0xbef1bf6d,0x3f463e48
.long 0xbf35bf80,0x3f35a554,0xbf35bf80,0x3f35a554,0xbf75bec4,0xbdc9bf55,0xbf62bf6d,0x3f22be48
.long 0xbe483f35,0xbf55bf6d,0xbf7bbf35,0x3f0ebec4,0x3f463f6d,0xbf75be48,0xbf7fbec4,0x3ef1bf0e
.long 0x3f6da554,0xbec43f35,0xbf6d248d,0x3ec4bf35,0x3dc9bf6d,0x3ef13f7b,0xbf463ec4,0x3e95bf55
.long 0xbf55bf35,0x3f7b3ec4,0xbf0e3f35,0x3e48bf6d,0xbf623ec4,0x3f46bf0e,0xbe953f6d,0x3dc9bf7b
.long 0x248d3f80,0xa554bf80,0x248d3f80,0xa554bf80,0x3f623ec4,0xbf46bf0e,0x3e953f6d,0xbdc9bf7b
.long 0x3f55bf35,0xbf7b3ec4,0x3f0e3f35,0xbe48bf6d,0xbdc9bf6d,0xbef13f7b,0x3f463ec4,0xbe95bf55
.long 0xbf6d248d,0x3ec43f35,0x3f6da554,0xbec4bf35,0xbf463f6d,0x3f75be48,0x3f7fbec4,0xbef1bf0e
.long 0x3e483f35,0x3f55bf6d,0x3f7bbf35,0xbf0ebec4,0x3f75bec4,0x3dc9bf55,0x3f62bf6d,0xbf22be48
.long 0x3f35bf80,0xbf35248d,0x3f35bf80,0xbf35248d,0xbe95bec4,0xbf7f3f55,0x3ef1bf6d,0xbf463e48
.long 0xbf7b3f35,0xbf0e3f6d,0x3e48bf35,0xbf553ec4,0xbf223f6d,0x3e953e48,0xbdc9bec4,0xbf623f0e
.long 0x3ec4a554,0x3f6dbf35,0xbec4248d,0xbf6d3f35,0x3f7fbf6d,0x3f62bf7b,0xbf223ec4,0xbf753f55
.long 0x3f0ebf35,0x3e48bec4,0xbf553f35,0xbf7b3f6d,0xbef13ec4,0xbf223f0e,0xbf753f6d,0xbf7f3f7b
.long 0xbf803f80,0xbf803f80,0xbf803f80,0xbf803f80,0xbf7f3f80,0xbf753f7b,0xbf223f35,0xbef13f0e
.long 0xbf7b3f80,0xbf553f6d,0x3e48248d,0x3f0ebec4,0xbf753f80,0xbf223f55,0x3f62bf35,0x3f7fbf7b
.long 0xbf6d3f80,0xbec43f35,0x3f6dbf80,0x3ec4bf35,0xbf623f80,0xbdc93f0e,0x3e95bf35,0xbf223e48
.long 0xbf553f80,0x3e483ec4,0xbf0ea554,0xbf7b3f6d,0xbf463f80,0x3ef13e48,0xbf7f3f35,0xbe953f55
.long 0xbf353f80,0x3f35248d,0xbf353f80,0x3f35248d,0xbf223f80,0x3f62be48,0x3dc93f35,0x3f75bf55
.long 0xbf0e3f80,0x3f7bbec4,0x3f55248d,0x3e48bf6d,0xbef13f80,0x3f7fbf0e,0x3f75bf35,0xbf46be48
.long 0xbec43f80,0x3f6dbf35,0x3ec4bf80,0xbf6d3f35,0xbe953f80,0x3f46bf55,0xbef1bf35,0xbdc93f7b
.long 0xbe483f80,0x3f0ebf6d,0xbf7ba554,0x3f553ec4,0xbdc93f80,0x3e95bf7b,0xbf463f35,0x3f62bf0e
.long 0xa5543f80,0x248dbf80,0xa5543f80,0x248dbf80,0x3dc93f80,0xbe95bf7b,0x3f463f35,0xbf62bf0e
.long 0x3e483f80,0xbf0ebf6d,0x3f7b248d,0xbf553ec4,0x3e953f80,0xbf46bf55,0x3ef1bf35,0x3dc93f7b
.long 0x3ec43f80,0xbf6dbf35,0xbec4bf80,0x3f6d3f35,0x3ef13f80,0xbf7fbf0e,0xbf75bf35,0x3f46be48
.long 0x3f0e3f80,0xbf7bbec4,0xbf55a554,0xbe48bf6d,0x3f223f80,0xbf62be48,0xbdc93f35,0xbf75bf55
.long 0x3f353f80,0xbf35a554,0x3f353f80,0xbf35a554,0x3f463f80,0xbef13e48,0x3f7f3f35,0x3e953f55
.long 0x3f553f80,0xbe483ec4,0x3f0e248d,0x3f7b3f6d,0x3f623f80,0x3dc93f0e,0xbe95bf35,0x3f223e48
.long 0x3f6d3f80,0x3ec43f35,0xbf6dbf80,0xbec4bf35,0x3f753f80,0x3f223f55,0xbf62bf35,0xbf7fbf7b
.long 0x3f7b3f80,0x3f553f6d,0xbe48a554,0xbf0ebec4,0x3f7f3f80,0x3f753f7b,0x3f223f35,0x3ef13f0e
.long 0xbf803f80,0xbf803f80,0xbf803f80,0xbf803f80,0xbf623f6d,0xbf463f55,0xbe953ec4,0xbdc93e48
.long 0xbf0e3f35,0xbe483ec4,0x3f55bf35,0x3f7bbf6d,0xbdc93ec4,0x3ef1be48,0x3f46bf6d,0x3e95bf0e
.long 0x3ec4248d,0x3f6dbf35,0xbec4a554,0xbf6d3f35,0x3f46bec4,0x3f75bf7b,0xbf7f3f6d,0xbef13f55
.long 0x3f7bbf35,0x3f0ebf6d,0xbe483f35,0x3f55bec4,0x3f75bf6d,0xbdc9bf0e,0x3f62bec4,0x3f22bf7b
.long 0x3f35bf80,0xbf35a554,0x3f35bf80,0xbf35a554,0x3e95bf6d,0xbf7f3f0e,0xbef1bec4,0xbf463f7b
.long 0xbe48bf35,0xbf553f6d,0xbf7b3f35,0x3f0e3ec4,0xbf22bec4,0xbe953f7b,0xbdc93f6d,0x3f62bf55
.long 0xbf6da554,0x3ec43f35,0x3f6d248d,0xbec4bf35,0xbf7f3ec4,0x3f623e48,0x3f22bf6d,0xbf753f0e
.long 0xbf553f35,0x3f7bbec4,0xbf0ebf35,0x3e483f6d,0xbef13f6d,0x3f22bf55,0xbf753ec4,0x3f7fbe48
.long 0xa5543f80,0x248dbf80,0xa5543f80,0x248dbf80,0x3ef13f6d,0xbf22bf55,0x3f753ec4,0xbf7fbe48
.long 0x3f553f35,0xbf7bbec4,0x3f0ebf35,0xbe483f6d,0x3f7f3ec4,0xbf623e48,0xbf22bf6d,0x3f753f0e
.long 0x3f6d248d,0xbec43f35,0xbf6da554,0x3ec4bf35,0x3f22bec4,0x3e953f7b,0x3dc93f6d,0xbf62bf55
.long 0x3e48bf35,0x3f553f6d,0x3f7b3f35,0xbf0e3ec4,0xbe95bf6d,0x3f7f3f0e,0x3ef1bec4,0x3f463f7b
.long 0xbf35bf80,0x3f35248d,0xbf35bf80,0x3f35248d,0xbf75bf6d,0x3dc9bf0e,0xbf62bec4,0xbf22bf7b
.long 0xbf7bbf35,0xbf0ebf6d,0x3e483f35,0xbf55bec4,0xbf46bec4,0xbf75bf7b,0x3f7f3f6d,0x3ef13f55
.long 0xbec4a554,0xbf6dbf35,0x3ec4248d,0x3f6d3f35,0x3dc93ec4,0xbef1be48,0xbf46bf6d,0xbe95bf0e
.long 0x3f0e3f35,0x3e483ec4,0xbf55bf35,0xbf7bbf6d,0x3f623f6d,0x3f463f55,0x3e953ec4,0x3dc93e48
.long 0xbf803f80,0xbf803f80,0xbf803f80,0xbf803f80,0x3dc9248d,0x3e95be48,0x3f46bf35,0x3f62bf55
.long 0x3f7bbf80,0x3f55bf6d,0xbe48a554,0xbf0e3ec4,0xbe95a554,0xbf463f0e,0xbef13f35,0x3dc93e48
.long 0xbf6d3f80,0xbec43f35,0x3f6dbf80,0x3ec4bf35,0x3ef1248d,0x3f7fbf55,0xbf753f35,0xbf463f7b
.long 0x3f55bf80,0xbe48bec4,0x3f0e248d,0x3f7bbf6d,0xbf22a554,0xbf623f7b,0x3dc9bf35,0xbf753f0e
.long 0xbf353f80,0x3f35248d,0xbf353f80,0x3f35248d,0x3f46248d,0x3ef1bf7b,0x3f7fbf35,0xbe95bf0e
.long 0x3f0ebf80,0xbf7b3ec4,0xbf55a554,0xbe483f6d,0xbf62a554,0x3dc93f55,0x3e953f35,0x3f22bf7b
.long 0xbec43f80,0x3f6dbf35,0x3ec4bf80,0xbf6d3f35,0x3f75248d,0xbf22bf0e,0xbf623f35,0x3f7fbe48
.long 0x3e48bf80,0xbf0e3f6d,0x3f7b248d,0xbf55bec4,0xbf7fa554,0x3f753e48,0xbf22bf35,0x3ef13f55
.long 0xa5543f80,0x248dbf80,0xa5543f80,0x248dbf80,0x3f7f248d,0xbf753e48,0x3f22bf35,0xbef13f55
.long 0xbe48bf80,0x3f0e3f6d,0xbf7ba554,0x3f55bec4,0xbf75a554,0x3f22bf0e,0x3f623f35,0xbf7fbe48
.long 0x3ec43f80,0xbf6dbf35,0xbec4bf80,0x3f6d3f35,0x3f62248d,0xbdc93f55,0xbe953f35,0xbf22bf7b
.long 0xbf0ebf80,0x3f7b3ec4,0x3f55248d,0x3e483f6d,0xbf46a554,0xbef1bf7b,0xbf7fbf35,0x3e95bf0e
.long 0x3f353f80,0xbf35a554,0x3f353f80,0xbf35a554,0x3f22248d,0x3f623f7b,0xbdc9bf35,0x3f753f0e
.long 0xbf55bf80,0x3e48bec4,0xbf0ea554,0xbf7bbf6d,0xbef1a554,0xbf7fbf55,0x3f753f35,0x3f463f7b
.long 0x3f6d3f80,0x3ec43f35,0xbf6dbf80,0xbec4bf35,0x3e95248d,0x3f463f0e,0x3ef13f35,0xbdc93e48
.long 0xbf7bbf80,0xbf55bf6d,0x3e48248d,0x3f0e3ec4,0xbdc9a554,0xbe95be48,0xbf46bf35,0xbf62bf55
.long 0xbf803f80,0xbf803f80,0xbf803f80,0xbf803f80,0x3ef1bec4,0x3f22bf0e,0x3f75bf6d,0x3f7fbf7b
.long 0x3f0ebf35,0x3e48bec4,0xbf553f35,0xbf7b3f6d,0xbf7f3f6d,0xbf623f7b,0x3f22bec4,0x3f75bf55
.long 0x3ec4248d,0x3f6dbf35,0xbec4a554,0xbf6d3f35,0x3f22bf6d,0xbe95be48,0x3dc93ec4,0x3f62bf0e
.long 0xbf7b3f35,0xbf0e3f6d,0x3e48bf35,0xbf553ec4,0x3e953ec4,0x3f7fbf55,0xbef13f6d,0x3f46be48
.long 0x3f35bf80,0xbf35a554,0x3f35bf80,0xbf35a554,0xbf753ec4,0xbdc93f55,0xbf623f6d,0x3f223e48
.long 0x3e483f35,0x3f55bf6d,0x3f7bbf35,0xbf0ebec4,0x3f46bf6d,0xbf753e48,0xbf7f3ec4,0x3ef13f0e
.long 0xbf6da554,0x3ec43f35,0x3f6d248d,0xbec4bf35,0x3dc93f6d,0x3ef1bf7b,0xbf46bec4,0x3e953f55
.long 0x3f55bf35,0xbf7b3ec4,0x3f0e3f35,0xbe48bf6d,0xbf62bec4,0x3f463f0e,0xbe95bf6d,0x3dc93f7b
.long 0xa5543f80,0x248dbf80,0xa5543f80,0x248dbf80,0x3f62bec4,0xbf463f0e,0x3e95bf6d,0xbdc93f7b
.long 0xbf55bf35,0x3f7b3ec4,0xbf0e3f35,0x3e48bf6d,0xbdc93f6d,0xbef1bf7b,0x3f46bec4,0xbe953f55
.long 0x3f6d248d,0xbec43f35,0xbf6da554,0x3ec4bf35,0xbf46bf6d,0x3f753e48,0x3f7f3ec4,0xbef13f0e
.long 0xbe483f35,0xbf55bf6d,0xbf7bbf35,0x3f0ebec4,0x3f753ec4,0x3dc93f55,0x3f623f6d,0xbf223e48
.long 0xbf35bf80,0x3f35248d,0xbf35bf80,0x3f35248d,0xbe953ec4,0xbf7fbf55,0x3ef13f6d,0xbf46be48
.long 0x3f7b3f35,0x3f0e3f6d,0xbe48bf35,0x3f553ec4,0xbf22bf6d,0x3e95be48,0xbdc93ec4,0xbf62bf0e
.long 0xbec4a554,0xbf6dbf35,0x3ec4248d,0x3f6d3f35,0x3f7f3f6d,0x3f623f7b,0xbf22bec4,0xbf75bf55
.long 0xbf0ebf35,0xbe48bec4,0x3f553f35,0x3f7b3f6d,0xbef1bec4,0xbf22bf0e,0xbf75bf6d,0xbf7fbf7b
.long 0xbf803f80,0xbf803f80,0xbf803f80,0xbf803f80,0x3f7fbf80,0x3f75bf7b,0x3f22bf35,0x3ef1bf0e
.long 0xbf7b3f80,0xbf553f6d,0x3e48248d,0x3f0ebec4,0x3f75bf80,0x3f22bf55,0xbf623f35,0xbf7f3f7b
.long 0xbf6d3f80,0xbec43f35,0x3f6dbf80,0x3ec4bf35,0x3f62bf80,0x3dc9bf0e,0xbe953f35,0x3f22be48
.long 0xbf553f80,0x3e483ec4,0xbf0ea554,0xbf7b3f6d,0x3f46bf80,0xbef1be48,0x3f7fbf35,0x3e95bf55
.long 0xbf353f80,0x3f35248d,0xbf353f80,0x3f35248d,0x3f22bf80,0xbf623e48,0xbdc9bf35,0xbf753f55
.long 0xbf0e3f80,0x3f7bbec4,0x3f55248d,0x3e48bf6d,0x3ef1bf80,0xbf7f3f0e,0xbf753f35,0x3f463e48
.long 0xbec43f80,0x3f6dbf35,0x3ec4bf80,0xbf6d3f35,0x3e95bf80,0xbf463f55,0x3ef13f35,0x3dc9bf7b
.long 0xbe483f80,0x3f0ebf6d,0xbf7ba554,0x3f553ec4,0x3dc9bf80,0xbe953f7b,0x3f46bf35,0xbf623f0e
.long 0xa5543f80,0x248dbf80,0xa5543f80,0x248dbf80,0xbdc9bf80,0x3e953f7b,0xbf46bf35,0x3f623f0e
.long 0x3e483f80,0xbf0ebf6d,0x3f7b248d,0xbf553ec4,0xbe95bf80,0x3f463f55,0xbef13f35,0xbdc9bf7b
.long 0x3ec43f80,0xbf6dbf35,0xbec4bf80,0x3f6d3f35,0xbef1bf80,0x3f7f3f0e,0x3f753f35,0xbf463e48
.long 0x3f0e3f80,0xbf7bbec4,0xbf55a554,0xbe48bf6d,0xbf22bf80,0x3f623e48,0x3dc9bf35,0x3f753f55
.long 0x3f353f80,0xbf35a554,0x3f353f80,0xbf35a554,0xbf46bf80,0x3ef1be48,0xbf7fbf35,0xbe95bf55
.long 0x3f553f80,0xbe483ec4,0x3f0e248d,0x3f7b3f6d,0xbf62bf80,0xbdc9bf0e,0x3e953f35,0xbf22be48
.long 0x3f6d3f80,0x3ec43f35,0xbf6dbf80,0xbec4bf35,0xbf75bf80,0xbf22bf55,0x3f623f35,0x3f7f3f7b
.long 0x3f7b3f80,0x3f553f6d,0xbe48a554,0xbf0ebec4,0xbf7fbf80,0xbf75bf7b,0xbf22bf35,0xbef1bf0e
.long 0xbf803f80,0xbf803f80,0xbf803f80,0xbf803f80,0x3f62bf6d,0x3f46bf55,0x3e95bec4,0x3dc9be48
.long 0xbf0e3f35,0xbe483ec4,0x3f55bf35,0x3f7bbf6d,0x3dc9bec4,0xbef13e48,0xbf463f6d,0xbe953f0e
.long 0x3ec4248d,0x3f6dbf35,0xbec4a554,0xbf6d3f35,0xbf463ec4,0xbf753f7b,0x3f7fbf6d,0x3ef1bf55
.long 0x3f7bbf35,0x3f0ebf6d,0xbe483f35,0x3f55bec4,0xbf753f6d,0x3dc93f0e,0xbf623ec4,0xbf223f7b
.long 0x3f35bf80,0xbf35a554,0x3f35bf80,0xbf35a554,0xbe953f6d,0x3f7fbf0e,0x3ef13ec4,0x3f46bf7b
.long 0xbe48bf35,0xbf553f6d,0xbf7b3f35,0x3f0e3ec4,0x3f223ec4,0x3e95bf7b,0x3dc9bf6d,0xbf623f55
.long 0xbf6da554,0x3ec43f35,0x3f6d248d,0xbec4bf35,0x3f7fbec4,0xbf62be48,0xbf223f6d,0x3f75bf0e
.long 0xbf553f35,0x3f7bbec4,0xbf0ebf35,0x3e483f6d,0x3ef1bf6d,0xbf223f55,0x3f75bec4,0xbf7f3e48
.long 0xa5543f80,0x248dbf80,0xa5543f80,0x248dbf80,0xbef1bf6d,0x3f223f55,0xbf75bec4,0x3f7f3e48
.long 0x3f553f35,0xbf7bbec4,0x3f0ebf35,0xbe483f6d,0xbf7fbec4,0x3f62be48,0x3f223f6d,0xbf75bf0e
.long 0x3f6d248d,0xbec43f35,0xbf6da554,0x3ec4bf35,0xbf223ec4,0xbe95bf7b,0xbdc9bf6d,0x3f623f55
.long 0x3e48bf35,0x3f553f6d,0x3f7b3f35,0xbf0e3ec4,0x3e953f6d,0xbf7fbf0e,0xbef13ec4,0xbf46bf7b
.long 0xbf35bf80,0x3f35248d,0xbf35bf80,0x3f35248d,0x3f753f6d,0xbdc93f0e,0x3f623ec4,0x3f223f7b
.long 0xbf7bbf35,0xbf0ebf6d,0x3e483f35,0xbf55bec4,0x3f463ec4,0x3f753f7b,0xbf7fbf6d,0xbef1bf55
.long 0xbec4a554,0xbf6dbf35,0x3ec4248d,0x3f6d3f35,0xbdc9bec4,0x3ef13e48,0x3f463f6d,0x3e953f0e
.long 0x3f0e3f35,0x3e483ec4,0xbf55bf35,0xbf7bbf6d,0xbf62bf6d,0xbf46bf55,0xbe95bec4,0xbdc9be48
.long 0xbf803f80,0xbf803f80,0xbf803f80,0xbf803f80,0xbdc9a554,0xbe953e48,0xbf463f35,0xbf623f55
.long 0x3f7bbf80,0x3f55bf6d,0xbe48a554,0xbf0e3ec4,0x3e95248d,0x3f46bf0e,0x3ef1bf35,0xbdc9be48
.long 0xbf6d3f80,0xbec43f35,0x3f6dbf80,0x3ec4bf35,0xbef1a554,0xbf7f3f55,0x3f75bf35,0x3f46bf7b
.long 0x3f55bf80,0xbe48bec4,0x3f0e248d,0x3f7bbf6d,0x3f22248d,0x3f62bf7b,0xbdc93f35,0x3f75bf0e
.long 0xbf353f80,0x3f35248d,0xbf353f80,0x3f35248d,0xbf46a554,0xbef13f7b,0xbf7f3f35,0x3e953f0e
.long 0x3f0ebf80,0xbf7b3ec4,0xbf55a554,0xbe483f6d,0x3f62248d,0xbdc9bf55,0xbe95bf35,0xbf223f7b
.long 0xbec43f80,0x3f6dbf35,0x3ec4bf80,0xbf6d3f35,0xbf75a554,0x3f223f0e,0x3f62bf35,0xbf7f3e48
.long 0x3e48bf80,0xbf0e3f6d,0x3f7b248d,0xbf55bec4,0x3f7f248d,0xbf75be48,0x3f223f35,0xbef1bf55
.long 0xa5543f80,0x248dbf80,0xa5543f80,0x248dbf80,0xbf7fa554,0x3f75be48,0xbf223f35,0x3ef1bf55
.long 0xbe48bf80,0x3f0e3f6d,0xbf7ba554,0x3f55bec4,0x3f75248d,0xbf223f0e,0xbf62bf35,0x3f7f3e48
.long 0x3ec43f80,0xbf6dbf35,0xbec4bf80,0x3f6d3f35,0xbf62a554,0x3dc9bf55,0x3e95bf35,0x3f223f7b
.long 0xbf0ebf80,0x3f7b3ec4,0x3f55248d,0x3e483f6d,0x3f46248d,0x3ef13f7b,0x3f7f3f35,0xbe953f0e
.long 0x3f353f80,0xbf35a554,0x3f353f80,0xbf35a554,0xbf22a554,0xbf62bf7b,0x3dc93f35,0xbf75bf0e
.long 0xbf55bf80,0x3e48bec4,0xbf0ea554,0xbf7bbf6d,0x3ef1248d,0x3f7f3f55,0xbf75bf35,0xbf46bf7b
.long 0x3f6d3f80,0x3ec43f35,0xbf6dbf80,0xbec4bf35,0xbe95a554,0xbf46bf0e,0xbef1bf35,0x3dc9be48
.long 0xbf7bbf80,0xbf55bf6d,0x3e48248d,0x3f0e3ec4,0x3dc9248d,0x3e953e48,0x3f463f35,0x3f623f55
.long 0xbf803f80,0xbf803f80,0xbf803f80,0xbf803f80,0xbef13ec4,0xbf223f0e,0xbf753f6d,0xbf7f3f7b
.long 0x3f0ebf35,0x3e48bec4,0xbf553f35,0xbf7b3f6d,0x3f7fbf6d,0x3f62bf7b,0xbf223ec4,0xbf753f55
.long 0x3ec4248d,0x3f6dbf35,0xbec4a554,0xbf6d3f35,0xbf223f6d,0x3e953e48,0xbdc9bec4,0xbf623f0e
.long 0xbf7b3f35,0xbf0e3f6d,0x3e48bf35,0xbf553ec4,0xbe95bec4,0xbf7f3f55,0x3ef1bf6d,0xbf463e48
.long 0x3f35bf80,0xbf35a554,0x3f35bf80,0xbf35a554,0x3f75bec4,0x3dc9bf55,0x3f62bf6d,0xbf22be48
.long 0x3e483f35,0x3f55bf6d,0x3f7bbf35,0xbf0ebec4,0xbf463f6d,0x3f75be48,0x3f7fbec4,0xbef1bf0e
.long 0xbf6da554,0x3ec43f35,0x3f6d248d,0xbec4bf35,0xbdc9bf6d,0xbef13f7b,0x3f463ec4,0xbe95bf55
.long 0x3f55bf35,0xbf7b3ec4,0x3f0e3f35,0xbe48bf6d,0x3f623ec4,0xbf46bf0e,0x3e953f6d,0xbdc9bf7b
.long 0xa5543f80,0x248dbf80,0xa5543f80,0x248dbf80,0xbf623ec4,0x3f46bf0e,0xbe953f6d,0x3dc9bf7b
.long 0xbf55bf35,0x3f7b3ec4,0xbf0e3f35,0x3e48bf6d,0x3dc9bf6d,0x3ef13f7b,0xbf463ec4,0x3e95bf55
.long 0x3f6d248d,0xbec43f35,0xbf6da554,0x3ec4bf35,0x3f463f6d,0xbf75be48,0xbf7fbec4,0x3ef1bf0e
.long 0xbe483f35,0xbf55bf6d,0xbf7bbf35,0x3f0ebec4,0xbf75bec4,0xbdc9bf55,0xbf62bf6d,0x3f22be48
.long 0xbf35bf80,0x3f35248d,0xbf35bf80,0x3f35248d,0x3e95bec4,0x3f7f3f55,0xbef1bf6d,0x3f463e48
.long 0x3f7b3f35,0x3f0e3f6d,0xbe48bf35,0x3f553ec4,0x3f223f6d,0xbe953e48,0x3dc9bec4,0x3f623f0e
.long 0xbec4a554,0xbf6dbf35,0x3ec4248d,0x3f6d3f35,0xbf7fbf6d,0xbf62bf7b,0x3f223ec4,0x3f753f55
.long 0xbf0ebf35,0xbe48bec4,0x3f553f35,0x3f7b3f6d,0x3ef13ec4,0x3f223f0e,0x3f753f6d,0x3f7f3f7b
.long 0x0,0x0,0x0,0x0,0x3dc90000,0x3e953e48,0x3f463f35,0x3f623f55
.long 0x3e480000,0x3f0e3ec4,0x3f7b3f80,0x3f553f6d,0x3e950000,0x3f463f0e,0x3ef13f35,0xbdc93e48
.long 0x3ec40000,0x3f6d3f35,0xbec4250d,0xbf6dbf35,0x3ef10000,0x3f7f3f55,0xbf75bf35,0xbf46bf7b
.long 0x3f0e0000,0x3f7b3f6d,0xbf55bf80,0x3e48bec4,0x3f220000,0x3f623f7b,0xbdc9bf35,0x3f753f0e
.long 0x3f350000,0x3f353f80,0x3f350000,0x3f353f80,0x3f460000,0x3ef13f7b,0x3f7f3f35,0xbe953f0e
.long 0x3f550000,0x3e483f6d,0x3f0e3f80,0xbf7bbec4,0x3f620000,0xbdc93f55,0xbe953f35,0xbf22bf7b
.long 0x3f6d0000,0xbec43f35,0xbf6d250d,0x3ec4bf35,0x3f750000,0xbf223f0e,0xbf62bf35,0x3f7f3e48
.long 0x3f7b0000,0xbf553ec4,0xbe48bf80,0x3f0e3f6d,0x3f7f0000,0xbf753e48,0x3f22bf35,0xbef13f55
.long 0x3f800000,0xbf80250d,0x3f800000,0xbf80250d,0x3f7f0000,0xbf75be48,0x3f223f35,0xbef1bf55
.long 0x3f7b0000,0xbf55bec4,0xbe483f80,0x3f0ebf6d,0x3f750000,0xbf22bf0e,0xbf623f35,0x3f7fbe48
.long 0x3f6d0000,0xbec4bf35,0xbf6d250d,0x3ec43f35,0x3f620000,0xbdc9bf55,0xbe95bf35,0xbf223f7b
.long 0x3f550000,0x3e48bf6d,0x3f0ebf80,0xbf7b3ec4,0x3f460000,0x3ef1bf7b,0x3f7fbf35,0xbe95bf0e
.long 0x3f350000,0x3f35bf80,0x3f350000,0x3f35bf80,0x3f220000,0x3f62bf7b,0xbdc93f35,0x3f75bf0e
.long 0x3f0e0000,0x3f7bbf6d,0xbf553f80,0x3e483ec4,0x3ef10000,0x3f7fbf55,0xbf753f35,0xbf463f7b
.long 0x3ec40000,0x3f6dbf35,0xbec4250d,0xbf6d3f35,0x3e950000,0x3f46bf0e,0x3ef1bf35,0xbdc9be48
.long 0x3e480000,0x3f0ebec4,0x3f7bbf80,0x3f55bf6d,0x3dc90000,0x3e95be48,0x3f46bf35,0x3f62bf55
.long 0x0,0x0,0x0,0x0,0x3ef13ec4,0x3f223f0e,0x3f753f6d,0x3f7f3f7b
.long 0x3f553f35,0x3f7b3f6d,0x3f0e3f35,0x3e483ec4,0x3f7f3f6d,0x3f623f7b,0xbf22bec4,0xbf75bf55
.long 0x3f6d3f80,0x3ec43f35,0xbf6dbf80,0xbec4bf35,0x3f223f6d,0xbe953e48,0x3dc9bec4,0x3f623f0e
.long 0x3e483f35,0xbf55bec4,0x3f7b3f35,0x3f0e3f6d,0xbe953ec4,0xbf7fbf55,0x3ef13f6d,0xbf46be48
.long 0xbf35250d,0xbf35bf80,0xbf35250d,0xbf35bf80,0xbf75bec4,0xbdc9bf55,0xbf62bf6d,0x3f22be48
.long 0xbf7bbf35,0x3f0ebec4,0x3e48bf35,0x3f553f6d,0xbf46bf6d,0x3f753e48,0x3f7f3ec4,0xbef13f0e
.long 0xbec4bf80,0x3f6d3f35,0x3ec43f80,0xbf6dbf35,0x3dc9bf6d,0x3ef13f7b,0xbf463ec4,0x3e95bf55
.long 0x3f0ebf35,0xbe483f6d,0xbf55bf35,0x3f7b3ec4,0x3f62bec4,0xbf463f0e,0x3e95bf6d,0xbdc93f7b
.long 0x3f800000,0xbf80250d,0x3f800000,0xbf80250d,0x3f623ec4,0xbf46bf0e,0x3e953f6d,0xbdc9bf7b
.long 0x3f0e3f35,0xbe48bf6d,0xbf553f35,0x3f7bbec4,0x3dc93f6d,0x3ef1bf7b,0xbf46bec4,0x3e953f55
.long 0xbec43f80,0x3f6dbf35,0x3ec4bf80,0xbf6d3f35,0xbf463f6d,0x3f75be48,0x3f7fbec4,0xbef1bf0e
.long 0xbf7b3f35,0x3f0e3ec4,0x3e483f35,0x3f55bf6d,0xbf753ec4,0xbdc93f55,0xbf623f6d,0x3f223e48
.long 0xbf35250d,0xbf353f80,0xbf35250d,0xbf353f80,0xbe95bec4,0xbf7f3f55,0x3ef1bf6d,0xbf463e48
.long 0x3e48bf35,0xbf553ec4,0x3f7bbf35,0x3f0ebf6d,0x3f22bf6d,0xbe95be48,0x3dc93ec4,0x3f62bf0e
.long 0x3f6dbf80,0x3ec4bf35,0xbf6d3f80,0xbec43f35,0x3f7fbf6d,0x3f62bf7b,0xbf223ec4,0xbf753f55
.long 0x3f55bf35,0x3f7bbf6d,0x3f0ebf35,0x3e48bec4,0x3ef1bec4,0x3f22bf0e,0x3f75bf6d,0x3f7fbf7b
.long 0x0,0x0,0x0,0x0,0x3f7f3f80,0x3f753f7b,0x3f223f35,0x3ef13f0e
.long 0xbe48250d,0xbf0ebec4,0xbf7bbf80,0xbf55bf6d,0xbf75bf80,0xbf22bf55,0x3f623f35,0x3f7f3f7b
.long 0x3ec40000,0x3f6d3f35,0xbec4250d,0xbf6dbf35,0x3f623f80,0x3dc93f0e,0xbe95bf35,0x3f223e48
.long 0xbf0e250d,0xbf7bbf6d,0x3f553f80,0xbe483ec4,0xbf46bf80,0x3ef1be48,0xbf7fbf35,0xbe95bf55
.long 0x3f350000,0x3f353f80,0x3f350000,0x3f353f80,0x3f223f80,0xbf62be48,0xbdc93f35,0xbf75bf55
.long 0xbf55250d,0xbe48bf6d,0xbf0ebf80,0x3f7b3ec4,0xbef1bf80,0x3f7f3f0e,0x3f753f35,0xbf463e48
.long 0x3f6d0000,0xbec43f35,0xbf6d250d,0x3ec4bf35,0x3e953f80,0xbf46bf55,0x3ef1bf35,0x3dc93f7b
.long 0xbf7b250d,0x3f55bec4,0x3e483f80,0xbf0ebf6d,0xbdc9bf80,0x3e953f7b,0xbf46bf35,0x3f623f0e
.long 0x3f800000,0xbf80250d,0x3f800000,0xbf80250d,0xbdc93f80,0x3e95bf7b,0xbf463f35,0x3f62bf0e
.long 0xbf7b250d,0x3f553ec4,0x3e48bf80,0xbf0e3f6d,0x3e95bf80,0xbf463f55,0x3ef13f35,0x3dc9bf7b
.long 0x3f6d0000,0xbec4bf35,0xbf6d250d,0x3ec43f35,0xbef13f80,0x3f7fbf0e,0x3f75bf35,0xbf46be48
.long 0xbf55250d,0xbe483f6d,0xbf0e3f80,0x3f7bbec4,0x3f22bf80,0xbf623e48,0xbdc9bf35,0xbf753f55
.long 0x3f350000,0x3f35bf80,0x3f350000,0x3f35bf80,0xbf463f80,0x3ef13e48,0xbf7f3f35,0xbe953f55
.long 0xbf0e250d,0xbf7b3f6d,0x3f55bf80,0xbe48bec4,0x3f62bf80,0x3dc9bf0e,0xbe953f35,0x3f22be48
.long 0x3ec40000,0x3f6dbf35,0xbec4250d,0xbf6d3f35,0xbf753f80,0xbf223f55,0x3f62bf35,0x3f7fbf7b
.long 0xbe48250d,0xbf0e3ec4,0xbf7b3f80,0xbf553f6d,0x3f7fbf80,0x3f75bf7b,0x3f22bf35,0x3ef1bf0e
.long 0x0,0x0,0x0,0x0,0x3f623f6d,0x3f463f55,0x3e953ec4,0x3dc93e48
.long 0xbf55bf35,0xbf7bbf6d,0xbf0ebf35,0xbe48bec4,0xbdc9bec4,0x3ef13e48,0x3f463f6d,0x3e953f0e
.long 0x3f6d3f80,0x3ec43f35,0xbf6dbf80,0xbec4bf35,0xbf46bec4,0xbf75bf7b,0x3f7f3f6d,0x3ef13f55
.long 0xbe48bf35,0x3f553ec4,0xbf7bbf35,0xbf0ebf6d,0x3f753f6d,0xbdc93f0e,0x3f623ec4,0x3f223f7b
.long 0xbf35250d,0xbf35bf80,0xbf35250d,0xbf35bf80,0xbe95bf6d,0x3f7f3f0e,0x3ef1bec4,0x3f463f7b
.long 0x3f7b3f35,0xbf0e3ec4,0xbe483f35,0xbf55bf6d,0xbf223ec4,0xbe95bf7b,0xbdc9bf6d,0x3f623f55
.long 0xbec4bf80,0x3f6d3f35,0x3ec43f80,0xbf6dbf35,0x3f7f3ec4,0xbf623e48,0xbf22bf6d,0x3f753f0e
.long 0xbf0e3f35,0x3e48bf6d,0x3f553f35,0xbf7bbec4,0xbef1bf6d,0x3f223f55,0xbf75bec4,0x3f7f3e48
.long 0x3f800000,0xbf80250d,0x3f800000,0xbf80250d,0xbef13f6d,0x3f22bf55,0xbf753ec4,0x3f7fbe48
.long 0xbf0ebf35,0x3e483f6d,0x3f55bf35,0xbf7b3ec4,0x3f7fbec4,0xbf62be48,0xbf223f6d,0x3f75bf0e
.long 0xbec43f80,0x3f6dbf35,0x3ec4bf80,0xbf6d3f35,0xbf22bec4,0xbe953f7b,0xbdc93f6d,0x3f62bf55
.long 0x3f7bbf35,0xbf0ebec4,0xbe48bf35,0xbf553f6d,0xbe953f6d,0x3f7fbf0e,0x3ef13ec4,0x3f46bf7b
.long 0xbf35250d,0xbf353f80,0xbf35250d,0xbf353f80,0x3f75bf6d,0xbdc9bf0e,0x3f62bec4,0x3f22bf7b
.long 0xbe483f35,0x3f55bec4,0xbf7b3f35,0xbf0e3f6d,0xbf463ec4,0xbf753f7b,0x3f7fbf6d,0x3ef1bf55
.long 0x3f6dbf80,0x3ec4bf35,0xbf6d3f80,0xbec43f35,0xbdc93ec4,0x3ef1be48,0x3f46bf6d,0x3e95bf0e
.long 0xbf553f35,0xbf7b3f6d,0xbf0e3f35,0xbe483ec4,0x3f62bf6d,0x3f46bf55,0x3e95bec4,0x3dc9be48
.long 0x0,0x0,0x0,0x0,0xbdc9250d,0xbe95be48,0xbf46bf35,0xbf62bf55
.long 0x3e480000,0x3f0e3ec4,0x3f7b3f80,0x3f553f6d,0xbe95250d,0xbf46bf0e,0xbef1bf35,0x3dc9be48
.long 0x3ec40000,0x3f6d3f35,0xbec4250d,0xbf6dbf35,0xbef1250d,0xbf7fbf55,0x3f753f35,0x3f463f7b
.long 0x3f0e0000,0x3f7b3f6d,0xbf55bf80,0x3e48bec4,0xbf22250d,0xbf62bf7b,0x3dc93f35,0xbf75bf0e
.long 0x3f350000,0x3f353f80,0x3f350000,0x3f353f80,0xbf46250d,0xbef1bf7b,0xbf7fbf35,0x3e95bf0e
.long 0x3f550000,0x3e483f6d,0x3f0e3f80,0xbf7bbec4,0xbf62250d,0x3dc9bf55,0x3e95bf35,0x3f223f7b
.long 0x3f6d0000,0xbec43f35,0xbf6d250d,0x3ec4bf35,0xbf75250d,0x3f22bf0e,0x3f623f35,0xbf7fbe48
.long 0x3f7b0000,0xbf553ec4,0xbe48bf80,0x3f0e3f6d,0xbf7f250d,0x3f75be48,0xbf223f35,0x3ef1bf55
.long 0x3f800000,0xbf80250d,0x3f800000,0xbf80250d,0xbf7f250d,0x3f753e48,0xbf22bf35,0x3ef13f55
.long 0x3f7b0000,0xbf55bec4,0xbe483f80,0x3f0ebf6d,0xbf75250d,0x3f223f0e,0x3f62bf35,0xbf7f3e48
.long 0x3f6d0000,0xbec4bf35,0xbf6d250d,0x3ec43f35,0xbf62250d,0x3dc93f55,0x3e953f35,0x3f22bf7b
.long 0x3f550000,0x3e48bf6d,0x3f0ebf80,0xbf7b3ec4,0xbf46250d,0xbef13f7b,0xbf7f3f35,0x3e953f0e
.long 0x3f350000,0x3f35bf80,0x3f350000,0x3f35bf80,0xbf22250d,0xbf623f7b,0x3dc9bf35,0xbf753f0e
.long 0x3f0e0000,0x3f7bbf6d,0xbf553f80,0x3e483ec4,0xbef1250d,0xbf7f3f55,0x3f75bf35,0x3f46bf7b
.long 0x3ec40000,0x3f6dbf35,0xbec4250d,0xbf6d3f35,0xbe95250d,0xbf463f0e,0xbef13f35,0x3dc93e48
.long 0x3e480000,0x3f0ebec4,0x3f7bbf80,0x3f55bf6d,0xbdc9250d,0xbe953e48,0xbf463f35,0xbf623f55
.long 0x0,0x0,0x0,0x0,0xbef1bec4,0xbf22bf0e,0xbf75bf6d,0xbf7fbf7b
.long 0x3f553f35,0x3f7b3f6d,0x3f0e3f35,0x3e483ec4,0xbf7fbf6d,0xbf62bf7b,0x3f223ec4,0x3f753f55
.long 0x3f6d3f80,0x3ec43f35,0xbf6dbf80,0xbec4bf35,0xbf22bf6d,0x3e95be48,0xbdc93ec4,0xbf62bf0e
.long 0x3e483f35,0xbf55bec4,0x3f7b3f35,0x3f0e3f6d,0x3e95bec4,0x3f7f3f55,0xbef1bf6d,0x3f463e48
.long 0xbf35250d,0xbf35bf80,0xbf35250d,0xbf35bf80,0x3f753ec4,0x3dc93f55,0x3f623f6d,0xbf223e48
.long 0xbf7bbf35,0x3f0ebec4,0x3e48bf35,0x3f553f6d,0x3f463f6d,0xbf75be48,0xbf7fbec4,0x3ef1bf0e
.long 0xbec4bf80,0x3f6d3f35,0x3ec43f80,0xbf6dbf35,0xbdc93f6d,0xbef1bf7b,0x3f46bec4,0xbe953f55
.long 0x3f0ebf35,0xbe483f6d,0xbf55bf35,0x3f7b3ec4,0xbf623ec4,0x3f46bf0e,0xbe953f6d,0x3dc9bf7b
.long 0x3f800000,0xbf80250d,0x3f800000,0xbf80250d,0xbf62bec4,0x3f463f0e,0xbe95bf6d,0x3dc93f7b
.long 0x3f0e3f35,0xbe48bf6d,0xbf553f35,0x3f7bbec4,0xbdc9bf6d,0xbef13f7b,0x3f463ec4,0xbe95bf55
.long 0xbec43f80,0x3f6dbf35,0x3ec4bf80,0xbf6d3f35,0x3f46bf6d,0xbf753e48,0xbf7f3ec4,0x3ef13f0e
.long 0xbf7b3f35,0x3f0e3ec4,0x3e483f35,0x3f55bf6d,0x3f75bec4,0x3dc9bf55,0x3f62bf6d,0xbf22be48
.long 0xbf35250d,0xbf353f80,0xbf35250d,0xbf353f80,0x3e953ec4,0x3f7fbf55,0xbef13f6d,0x3f46be48
.long 0x3e48bf35,0xbf553ec4,0x3f7bbf35,0x3f0ebf6d,0xbf223f6d,0x3e953e48,0xbdc9bec4,0xbf623f0e
.long 0x3f6dbf80,0x3ec4bf35,0xbf6d3f80,0xbec43f35,0xbf7f3f6d,0xbf623f7b,0x3f22bec4,0x3f75bf55
.long 0x3f55bf35,0x3f7bbf6d,0x3f0ebf35,0x3e48bec4,0xbef13ec4,0xbf223f0e,0xbf753f6d,0xbf7f3f7b
.long 0x0,0x0,0x0,0x0,0xbf7fbf80,0xbf75bf7b,0xbf22bf35,0xbef1bf0e
.long 0xbe48250d,0xbf0ebec4,0xbf7bbf80,0xbf55bf6d,0x3f753f80,0x3f223f55,0xbf62bf35,0xbf7fbf7b
.long 0x3ec40000,0x3f6d3f35,0xbec4250d,0xbf6dbf35,0xbf62bf80,0xbdc9bf0e,0x3e953f35,0xbf22be48
.long 0xbf0e250d,0xbf7bbf6d,0x3f553f80,0xbe483ec4,0x3f463f80,0xbef13e48,0x3f7f3f35,0x3e953f55
.long 0x3f350000,0x3f353f80,0x3f350000,0x3f353f80,0xbf22bf80,0x3f623e48,0x3dc9bf35,0x3f753f55
.long 0xbf55250d,0xbe48bf6d,0xbf0ebf80,0x3f7b3ec4,0x3ef13f80,0xbf7fbf0e,0xbf75bf35,0x3f46be48
.long 0x3f6d0000,0xbec43f35,0xbf6d250d,0x3ec4bf35,0xbe95bf80,0x3f463f55,0xbef13f35,0xbdc9bf7b
.long 0xbf7b250d,0x3f55bec4,0x3e483f80,0xbf0ebf6d,0x3dc93f80,0xbe95bf7b,0x3f463f35,0xbf62bf0e
.long 0x3f800000,0xbf80250d,0x3f800000,0xbf80250d,0x3dc9bf80,0xbe953f7b,0x3f46bf35,0xbf623f0e
.long 0xbf7b250d,0x3f553ec4,0x3e48bf80,0xbf0e3f6d,0xbe953f80,0x3f46bf55,0xbef1bf35,0xbdc93f7b
.long 0x3f6d0000,0xbec4bf35,0xbf6d250d,0x3ec43f35,0x3ef1bf80,0xbf7f3f0e,0xbf753f35,0x3f463e48
.long 0xbf55250d,0xbe483f6d,0xbf0e3f80,0x3f7bbec4,0xbf223f80,0x3f62be48,0x3dc93f35,0x3f75bf55
.long 0x3f350000,0x3f35bf80,0x3f350000,0x3f35bf80,0x3f46bf80,0xbef1be48,0x3f7fbf35,0x3e95bf55
.long 0xbf0e250d,0xbf7b3f6d,0x3f55bf80,0xbe48bec4,0xbf623f80,0xbdc93f0e,0x3e95bf35,0xbf223e48
.long 0x3ec40000,0x3f6dbf35,0xbec4250d,0xbf6d3f35,0x3f75bf80,0x3f22bf55,0xbf623f35,0xbf7f3f7b
.long 0xbe48250d,0xbf0e3ec4,0xbf7b3f80,0xbf553f6d,0xbf7f3f80,0xbf753f7b,0xbf223f35,0xbef13f0e
.long 0x0,0x0,0x0,0x0,0xbf62bf6d,0xbf46bf55,0xbe95bec4,0xbdc9be48
.long 0xbf55bf35,0xbf7bbf6d,0xbf0ebf35,0xbe48bec4,0x3dc93ec4,0xbef1be48,0xbf46bf6d,0xbe95bf0e
.long 0x3f6d3f80,0x3ec43f35,0xbf6dbf80,0xbec4bf35,0x3f463ec4,0x3f753f7b,0xbf7fbf6d,0xbef1bf55
.long 0xbe48bf35,0x3f553ec4,0xbf7bbf35,0xbf0ebf6d,0xbf75bf6d,0x3dc9bf0e,0xbf62bec4,0xbf22bf7b
.long 0xbf35250d,0xbf35bf80,0xbf35250d,0xbf35bf80,0x3e953f6d,0xbf7fbf0e,0xbef13ec4,0xbf46bf7b
.long 0x3f7b3f35,0xbf0e3ec4,0xbe483f35,0xbf55bf6d,0x3f22bec4,0x3e953f7b,0x3dc93f6d,0xbf62bf55
.long 0xbec4bf80,0x3f6d3f35,0x3ec43f80,0xbf6dbf35,0xbf7fbec4,0x3f62be48,0x3f223f6d,0xbf75bf0e
.long 0xbf0e3f35,0x3e48bf6d,0x3f553f35,0xbf7bbec4,0x3ef13f6d,0xbf22bf55,0x3f753ec4,0xbf7fbe48
.long 0x3f800000,0xbf80250d,0x3f800000,0xbf80250d,0x3ef1bf6d,0xbf223f55,0x3f75bec4,0xbf7f3e48
.long 0xbf0ebf35,0x3e483f6d,0x3f55bf35,0xbf7b3ec4,0xbf7f3ec4,0x3f623e48,0x3f22bf6d,0xbf753f0e
.long 0xbec43f80,0x3f6dbf35,0x3ec4bf80,0xbf6d3f35,0x3f223ec4,0x3e95bf7b,0x3dc9bf6d,0xbf623f55
.long 0x3f7bbf35,0xbf0ebec4,0xbe48bf35,0xbf553f6d,0x3e95bf6d,0xbf7f3f0e,0xbef1bec4,0xbf463f7b
.long 0xbf35250d,0xbf353f80,0xbf35250d,0xbf353f80,0xbf753f6d,0x3dc93f0e,0xbf623ec4,0xbf223f7b
.long 0xbe483f35,0x3f55bec4,0xbf7b3f35,0xbf0e3f6d,0x3f46bec4,0x3f75bf7b,0xbf7f3f6d,0xbef13f55
.long 0x3f6dbf80,0x3ec4bf35,0xbf6d3f80,0xbec43f35,0x3dc9bec4,0xbef13e48,0xbf463f6d,0xbe953f0e
.long 0xbf553f35,0xbf7b3f6d,0xbf0e3f35,0xbe483ec4,0xbf623f6d,0xbf463f55,0xbe953ec4,0xbdc93e48
.long 0x250d0000,0x250d0000,0x250d0000,0x250d0000,0xbdc90000,0xbe953e48,0xbf463f35,0xbf623f55
.long 0xbe480000,0xbf0e3ec4,0xbf7b3f80,0xbf553f6d,0xbe950000,0xbf463f0e,0xbef13f35,0x3dc93e48
.long 0xbec40000,0xbf6d3f35,0x3ec4250d,0x3f6dbf35,0xbef10000,0xbf7f3f55,0x3f75bf35,0x3f46bf7b
.long 0xbf0e0000,0xbf7b3f6d,0x3f55bf80,0xbe48bec4,0xbf220000,0xbf623f7b,0x3dc9bf35,0xbf753f0e
.long 0xbf350000,0xbf353f80,0xbf350000,0xbf353f80,0xbf460000,0xbef13f7b,0xbf7f3f35,0x3e953f0e
.long 0xbf550000,0xbe483f6d,0xbf0e3f80,0x3f7bbec4,0xbf620000,0x3dc93f55,0x3e953f35,0x3f22bf7b
.long 0xbf6d0000,0x3ec43f35,0x3f6d250d,0xbec4bf35,0xbf750000,0x3f223f0e,0x3f62bf35,0xbf7f3e48
.long 0xbf7b0000,0x3f553ec4,0x3e48bf80,0xbf0e3f6d,0xbf7f0000,0x3f753e48,0xbf22bf35,0x3ef13f55
.long 0xbf800000,0x3f80250d,0xbf800000,0x3f80250d,0xbf7f0000,0x3f75be48,0xbf223f35,0x3ef1bf55
.long 0xbf7b0000,0x3f55bec4,0x3e483f80,0xbf0ebf6d,0xbf750000,0x3f22bf0e,0x3f623f35,0xbf7fbe48
.long 0xbf6d0000,0x3ec4bf35,0x3f6d250d,0xbec43f35,0xbf620000,0x3dc9bf55,0x3e95bf35,0x3f223f7b
.long 0xbf550000,0xbe48bf6d,0xbf0ebf80,0x3f7b3ec4,0xbf460000,0xbef1bf7b,0xbf7fbf35,0x3e95bf0e
.long 0xbf350000,0xbf35bf80,0xbf350000,0xbf35bf80,0xbf220000,0xbf62bf7b,0x3dc93f35,0xbf75bf0e
.long 0xbf0e0000,0xbf7bbf6d,0x3f553f80,0xbe483ec4,0xbef10000,0xbf7fbf55,0x3f753f35,0x3f463f7b
.long 0xbec40000,0xbf6dbf35,0x3ec4250d,0x3f6d3f35,0xbe950000,0xbf46bf0e,0xbef1bf35,0x3dc9be48
.long 0xbe480000,0xbf0ebec4,0xbf7bbf80,0xbf55bf6d,0xbdc90000,0xbe95be48,0xbf46bf35,0xbf62bf55
.long 0x250d0000,0x250d0000,0x250d0000,0x250d0000,0xbef13ec4,0xbf223f0e,0xbf753f6d,0xbf7f3f7b
.long 0xbf553f35,0xbf7b3f6d,0xbf0e3f35,0xbe483ec4,0xbf7f3f6d,0xbf623f7b,0x3f22bec4,0x3f75bf55
.long 0xbf6d3f80,0xbec43f35,0x3f6dbf80,0x3ec4bf35,0xbf223f6d,0x3e953e48,0xbdc9bec4,0xbf623f0e
.long 0xbe483f35,0x3f55bec4,0xbf7b3f35,0xbf0e3f6d,0x3e953ec4,0x3f7fbf55,0xbef13f6d,0x3f46be48
.long 0x3f35250d,0x3f35bf80,0x3f35250d,0x3f35bf80,0x3f75bec4,0x3dc9bf55,0x3f62bf6d,0xbf22be48
.long 0x3f7bbf35,0xbf0ebec4,0xbe48bf35,0xbf553f6d,0x3f46bf6d,0xbf753e48,0xbf7f3ec4,0x3ef13f0e
.long 0x3ec4bf80,0xbf6d3f35,0xbec43f80,0x3f6dbf35,0xbdc9bf6d,0xbef13f7b,0x3f463ec4,0xbe95bf55
.long 0xbf0ebf35,0x3e483f6d,0x3f55bf35,0xbf7b3ec4,0xbf62bec4,0x3f463f0e,0xbe95bf6d,0x3dc93f7b
.long 0xbf800000,0x3f80250d,0xbf800000,0x3f80250d,0xbf623ec4,0x3f46bf0e,0xbe953f6d,0x3dc9bf7b
.long 0xbf0e3f35,0x3e48bf6d,0x3f553f35,0xbf7bbec4,0xbdc93f6d,0xbef1bf7b,0x3f46bec4,0xbe953f55
.long 0x3ec43f80,0xbf6dbf35,0xbec4bf80,0x3f6d3f35,0x3f463f6d,0xbf75be48,0xbf7fbec4,0x3ef1bf0e
.long 0x3f7b3f35,0xbf0e3ec4,0xbe483f35,0xbf55bf6d,0x3f753ec4,0x3dc93f55,0x3f623f6d,0xbf223e48
.long 0x3f35250d,0x3f353f80,0x3f35250d,0x3f353f80,0x3e95bec4,0x3f7f3f55,0xbef1bf6d,0x3f463e48
.long 0xbe48bf35,0x3f553ec4,0xbf7bbf35,0xbf0ebf6d,0xbf22bf6d,0x3e95be48,0xbdc93ec4,0xbf62bf0e
.long 0xbf6dbf80,0xbec4bf35,0x3f6d3f80,0x3ec43f35,0xbf7fbf6d,0xbf62bf7b,0x3f223ec4,0x3f753f55
.long 0xbf55bf35,0xbf7bbf6d,0xbf0ebf35,0xbe48bec4,0xbef1bec4,0xbf22bf0e,0xbf75bf6d,0xbf7fbf7b
.long 0x250d0000,0x250d0000,0x250d0000,0x250d0000,0xbf7f3f80,0xbf753f7b,0xbf223f35,0xbef13f0e
.long 0x3e48250d,0x3f0ebec4,0x3f7bbf80,0x3f55bf6d,0x3f75bf80,0x3f22bf55,0xbf623f35,0xbf7f3f7b
.long 0xbec40000,0xbf6d3f35,0x3ec4250d,0x3f6dbf35,0xbf623f80,0xbdc93f0e,0x3e95bf35,0xbf223e48
.long 0x3f0e250d,0x3f7bbf6d,0xbf553f80,0x3e483ec4,0x3f46bf80,0xbef1be48,0x3f7fbf35,0x3e95bf55
.long 0xbf350000,0xbf353f80,0xbf350000,0xbf353f80,0xbf223f80,0x3f62be48,0x3dc93f35,0x3f75bf55
.long 0x3f55250d,0x3e48bf6d,0x3f0ebf80,0xbf7b3ec4,0x3ef1bf80,0xbf7f3f0e,0xbf753f35,0x3f463e48
.long 0xbf6d0000,0x3ec43f35,0x3f6d250d,0xbec4bf35,0xbe953f80,0x3f46bf55,0xbef1bf35,0xbdc93f7b
.long 0x3f7b250d,0xbf55bec4,0xbe483f80,0x3f0ebf6d,0x3dc9bf80,0xbe953f7b,0x3f46bf35,0xbf623f0e
.long 0xbf800000,0x3f80250d,0xbf800000,0x3f80250d,0x3dc93f80,0xbe95bf7b,0x3f463f35,0xbf62bf0e
.long 0x3f7b250d,0xbf553ec4,0xbe48bf80,0x3f0e3f6d,0xbe95bf80,0x3f463f55,0xbef13f35,0xbdc9bf7b
.long 0xbf6d0000,0x3ec4bf35,0x3f6d250d,0xbec43f35,0x3ef13f80,0xbf7fbf0e,0xbf75bf35,0x3f46be48
.long 0x3f55250d,0x3e483f6d,0x3f0e3f80,0xbf7bbec4,0xbf22bf80,0x3f623e48,0x3dc9bf35,0x3f753f55
.long 0xbf350000,0xbf35bf80,0xbf350000,0xbf35bf80,0x3f463f80,0xbef13e48,0x3f7f3f35,0x3e953f55
.long 0x3f0e250d,0x3f7b3f6d,0xbf55bf80,0x3e48bec4,0xbf62bf80,0xbdc9bf0e,0x3e953f35,0xbf22be48
.long 0xbec40000,0xbf6dbf35,0x3ec4250d,0x3f6d3f35,0x3f753f80,0x3f223f55,0xbf62bf35,0xbf7fbf7b
.long 0x3e48250d,0x3f0e3ec4,0x3f7b3f80,0x3f553f6d,0xbf7fbf80,0xbf75bf7b,0xbf22bf35,0xbef1bf0e
.long 0x250d0000,0x250d0000,0x250d0000,0x250d0000,0xbf623f6d,0xbf463f55,0xbe953ec4,0xbdc93e48
.long 0x3f55bf35,0x3f7bbf6d,0x3f0ebf35,0x3e48bec4,0x3dc9bec4,0xbef13e48,0xbf463f6d,0xbe953f0e
.long 0xbf6d3f80,0xbec43f35,0x3f6dbf80,0x3ec4bf35,0x3f46bec4,0x3f75bf7b,0xbf7f3f6d,0xbef13f55
.long 0x3e48bf35,0xbf553ec4,0x3f7bbf35,0x3f0ebf6d,0xbf753f6d,0x3dc93f0e,0xbf623ec4,0xbf223f7b
.long 0x3f35250d,0x3f35bf80,0x3f35250d,0x3f35bf80,0x3e95bf6d,0xbf7f3f0e,0xbef1bec4,0xbf463f7b
.long 0xbf7b3f35,0x3f0e3ec4,0x3e483f35,0x3f55bf6d,0x3f223ec4,0x3e95bf7b,0x3dc9bf6d,0xbf623f55
.long 0x3ec4bf80,0xbf6d3f35,0xbec43f80,0x3f6dbf35,0xbf7f3ec4,0x3f623e48,0x3f22bf6d,0xbf753f0e
.long 0x3f0e3f35,0xbe48bf6d,0xbf553f35,0x3f7bbec4,0x3ef1bf6d,0xbf223f55,0x3f75bec4,0xbf7f3e48
.long 0xbf800000,0x3f80250d,0xbf800000,0x3f80250d,0x3ef13f6d,0xbf22bf55,0x3f753ec4,0xbf7fbe48
.long 0x3f0ebf35,0xbe483f6d,0xbf55bf35,0x3f7b3ec4,0xbf7fbec4,0x3f62be48,0x3f223f6d,0xbf75bf0e
.long 0x3ec43f80,0xbf6dbf35,0xbec4bf80,0x3f6d3f35,0x3f22bec4,0x3e953f7b,0x3dc93f6d,0xbf62bf55
.long 0xbf7bbf35,0x3f0ebec4,0x3e48bf35,0x3f553f6d,0x3e953f6d,0xbf7fbf0e,0xbef13ec4,0xbf46bf7b
.long 0x3f35250d,0x3f353f80,0x3f35250d,0x3f353f80,0xbf75bf6d,0x3dc9bf0e,0xbf62bec4,0xbf22bf7b
.long 0x3e483f35,0xbf55bec4,0x3f7b3f35,0x3f0e3f6d,0x3f463ec4,0x3f753f7b,0xbf7fbf6d,0xbef1bf55
.long 0xbf6dbf80,0xbec4bf35,0x3f6d3f80,0x3ec43f35,0x3dc93ec4,0xbef1be48,0xbf46bf6d,0xbe95bf0e
.long 0x3f553f35,0x3f7b3f6d,0x3f0e3f35,0x3e483ec4,0xbf62bf6d,0xbf46bf55,0xbe95bec4,0xbdc9be48
.long 0x250d0000,0x250d0000,0x250d0000,0x250d0000,0x3dc9250d,0x3e95be48,0x3f46bf35,0x3f62bf55
.long 0xbe480000,0xbf0e3ec4,0xbf7b3f80,0xbf553f6d,0x3e95250d,0x3f46bf0e,0x3ef1bf35,0xbdc9be48
.long 0xbec40000,0xbf6d3f35,0x3ec4250d,0x3f6dbf35,0x3ef1250d,0x3f7fbf55,0xbf753f35,0xbf463f7b
.long 0xbf0e0000,0xbf7b3f6d,0x3f55bf80,0xbe48bec4,0x3f22250d,0x3f62bf7b,0xbdc93f35,0x3f75bf0e
.long 0xbf350000,0xbf353f80,0xbf350000,0xbf353f80,0x3f46250d,0x3ef1bf7b,0x3f7fbf35,0xbe95bf0e
.long 0xbf550000,0xbe483f6d,0xbf0e3f80,0x3f7bbec4,0x3f62250d,0xbdc9bf55,0xbe95bf35,0xbf223f7b
.long 0xbf6d0000,0x3ec43f35,0x3f6d250d,0xbec4bf35,0x3f75250d,0xbf22bf0e,0xbf623f35,0x3f7fbe48
.long 0xbf7b0000,0x3f553ec4,0x3e48bf80,0xbf0e3f6d,0x3f7f250d,0xbf75be48,0x3f223f35,0xbef1bf55
.long 0xbf800000,0x3f80250d,0xbf800000,0x3f80250d,0x3f7f250d,0xbf753e48,0x3f22bf35,0xbef13f55
.long 0xbf7b0000,0x3f55bec4,0x3e483f80,0xbf0ebf6d,0x3f75250d,0xbf223f0e,0xbf62bf35,0x3f7f3e48
.long 0xbf6d0000,0x3ec4bf35,0x3f6d250d,0xbec43f35,0x3f62250d,0xbdc93f55,0xbe953f35,0xbf22bf7b
.long 0xbf550000,0xbe48bf6d,0xbf0ebf80,0x3f7b3ec4,0x3f46250d,0x3ef13f7b,0x3f7f3f35,0xbe953f0e
.long 0xbf350000,0xbf35bf80,0xbf350000,0xbf35bf80,0x3f22250d,0x3f623f7b,0xbdc9bf35,0x3f753f0e
.long 0xbf0e0000,0xbf7bbf6d,0x3f553f80,0xbe483ec4,0x3ef1250d,0x3f7f3f55,0xbf75bf35,0xbf46bf7b
.long 0xbec40000,0xbf6dbf35,0x3ec4250d,0x3f6d3f35,0x3e95250d,0x3f463f0e,0x3ef13f35,0xbdc93e48
.long 0xbe480000,0xbf0ebec4,0xbf7bbf80,0xbf55bf6d,0x3dc9250d,0x3e953e48,0x3f463f35,0x3f623f55
.long 0x250d0000,0x250d0000,0x250d0000,0x250d0000,0x3ef1bec4,0x3f22bf0e,0x3f75bf6d,0x3f7fbf7b
.long 0xbf553f35,0xbf7b3f6d,0xbf0e3f35,0xbe483ec4,0x3f7fbf6d,0x3f62bf7b,0xbf223ec4,0xbf753f55
.long 0xbf6d3f80,0xbec43f35,0x3f6dbf80,0x3ec4bf35,0x3f22bf6d,0xbe95be48,0x3dc93ec4,0x3f62bf0e
.long 0xbe483f35,0x3f55bec4,0xbf7b3f35,0xbf0e3f6d,0xbe95bec4,0xbf7f3f55,0x3ef1bf6d,0xbf463e48
.long 0x3f35250d,0x3f35bf80,0x3f35250d,0x3f35bf80,0xbf753ec4,0xbdc93f55,0xbf623f6d,0x3f223e48
.long 0x3f7bbf35,0xbf0ebec4,0xbe48bf35,0xbf553f6d,0xbf463f6d,0x3f75be48,0x3f7fbec4,0xbef1bf0e
.long 0x3ec4bf80,0xbf6d3f35,0xbec43f80,0x3f6dbf35,0x3dc93f6d,0x3ef1bf7b,0xbf46bec4,0x3e953f55
.long 0xbf0ebf35,0x3e483f6d,0x3f55bf35,0xbf7b3ec4,0x3f623ec4,0xbf46bf0e,0x3e953f6d,0xbdc9bf7b
.long 0xbf800000,0x3f80250d,0xbf800000,0x3f80250d,0x3f62bec4,0xbf463f0e,0x3e95bf6d,0xbdc93f7b
.long 0xbf0e3f35,0x3e48bf6d,0x3f553f35,0xbf7bbec4,0x3dc9bf6d,0x3ef13f7b,0xbf463ec4,0x3e95bf55
.long 0x3ec43f80,0xbf6dbf35,0xbec4bf80,0x3f6d3f35,0xbf46bf6d,0x3f753e48,0x3f7f3ec4,0xbef13f0e
.long 0x3f7b3f35,0xbf0e3ec4,0xbe483f35,0xbf55bf6d,0xbf75bec4,0xbdc9bf55,0xbf62bf6d,0x3f22be48
.long 0x3f35250d,0x3f353f80,0x3f35250d,0x3f353f80,0xbe953ec4,0xbf7fbf55,0x3ef13f6d,0xbf46be48
.long 0xbe48bf35,0x3f553ec4,0xbf7bbf35,0xbf0ebf6d,0x3f223f6d,0xbe953e48,0x3dc9bec4,0x3f623f0e
.long 0xbf6dbf80,0xbec4bf35,0x3f6d3f80,0x3ec43f35,0x3f7f3f6d,0x3f623f7b,0xbf22bec4,0xbf75bf55
.long 0xbf55bf35,0xbf7bbf6d,0xbf0ebf35,0xbe48bec4,0x3ef13ec4,0x3f223f0e,0x3f753f6d,0x3f7f3f7b
.long 0x250d0000,0x250d0000,0x250d0000,0x250d0000,0x3f7fbf80,0x3f75bf7b,0x3f22bf35,0x3ef1bf0e
.long 0x3e48250d,0x3f0ebec4,0x3f7bbf80,0x3f55bf6d,0xbf753f80,0xbf223f55,0x3f62bf35,0x3f7fbf7b
.long 0xbec40000,0xbf6d3f35,0x3ec4250d,0x3f6dbf35,0x3f62bf80,0x3dc9bf0e,0xbe953f35,0x3f22be48
.long 0x3f0e250d,0x3f7bbf6d,0xbf553f80,0x3e483ec4,0xbf463f80,0x3ef13e48,0xbf7f3f35,0xbe953f55
.long 0xbf350000,0xbf353f80,0xbf350000,0xbf353f80,0x3f22bf80,0xbf623e48,0xbdc9bf35,0xbf753f55
.long 0x3f55250d,0x3e48bf6d,0x3f0ebf80,0xbf7b3ec4,0xbef13f80,0x3f7fbf0e,0x3f75bf35,0xbf46be48
.long 0xbf6d0000,0x3ec43f35,0x3f6d250d,0xbec4bf35,0x3e95bf80,0xbf463f55,0x3ef13f35,0x3dc9bf7b
.long 0x3f7b250d,0xbf55bec4,0xbe483f80,0x3f0ebf6d,0xbdc93f80,0x3e95bf7b,0xbf463f35,0x3f62bf0e
.long 0xbf800000,0x3f80250d,0xbf800000,0x3f80250d,0xbdc9bf80,0x3e953f7b,0xbf46bf35,0x3f623f0e
.long 0x3f7b250d,0xbf553ec4,0xbe48bf80,0x3f0e3f6d,0x3e953f80,0xbf46bf55,0x3ef1bf35,0x3dc93f7b
.long 0xbf6d0000,0x3ec4bf35,0x3f6d250d,0xbec43f35,0xbef1bf80,0x3f7f3f0e,0x3f753f35,0xbf463e48
.long 0x3f55250d,0x3e483f6d,0x3f0e3f80,0xbf7bbec4,0x3f223f80,0xbf62be48,0xbdc93f35,0xbf75bf55
.long 0xbf350000,0xbf35bf80,0xbf350000,0xbf35bf80,0xbf46bf80,0x3ef1be48,0xbf7fbf35,0xbe95bf55
.long 0x3f0e250d,0x3f7b3f6d,0xbf55bf80,0x3e48bec4,0x3f623f80,0x3dc93f0e,0xbe95bf35,0x3f223e48
.long 0xbec40000,0xbf6dbf35,0x3ec4250d,0x3f6d3f35,0xbf75bf80,0xbf22bf55,0x3f623f35,0x3f7f3f7b
.long 0x3e48250d,0x3f0e3ec4,0x3f7b3f80,0x3f553f6d,0x3f7f3f80,0x3f753f7b,0x3f223f35,0x3ef13f0e
.long 0x250d0000,0x250d0000,0x250d0000,0x250d0000,0x3f62bf6d,0x3f46bf55,0x3e95bec4,0x3dc9be48
.long 0x3f55bf35,0x3f7bbf6d,0x3f0ebf35,0x3e48bec4,0xbdc93ec4,0x3ef1be48,0x3f46bf6d,0x3e95bf0e
.long 0xbf6d3f80,0xbec43f35,0x3f6dbf80,0x3ec4bf35,0xbf463ec4,0xbf753f7b,0x3f7fbf6d,0x3ef1bf55
.long 0x3e48bf35,0xbf553ec4,0x3f7bbf35,0x3f0ebf6d,0x3f75bf6d,0xbdc9bf0e,0x3f62bec4,0x3f22bf7b
.long 0x3f35250d,0x3f35bf80,0x3f35250d,0x3f35bf80,0xbe953f6d,0x3f7fbf0e,0x3ef13ec4,0x3f46bf7b
.long 0xbf7b3f35,0x3f0e3ec4,0x3e483f35,0x3f55bf6d,0xbf22bec4,0xbe953f7b,0xbdc93f6d,0x3f62bf55
.long 0x3ec4bf80,0xbf6d3f35,0xbec43f80,0x3f6dbf35,0x3f7fbec4,0xbf62be48,0xbf223f6d,0x3f75bf0e
.long 0x3f0e3f35,0xbe48bf6d,0xbf553f35,0x3f7bbec4,0xbef13f6d,0x3f22bf55,0xbf753ec4,0x3f7fbe48
.long 0xbf800000,0x3f80250d,0xbf800000,0x3f80250d,0xbef1bf6d,0x3f223f55,0xbf75bec4,0x3f7f3e48
.long 0x3f0ebf35,0xbe483f6d,0xbf55bf35,0x3f7b3ec4,0x3f7f3ec4,0xbf623e48,0xbf22bf6d,0x3f753f0e
.long 0x3ec43f80,0xbf6dbf35,0xbec4bf80,0x3f6d3f35,0xbf223ec4,0xbe95bf7b,0xbdc9bf6d,0x3f623f55
.long 0xbf7bbf35,0x3f0ebec4,0x3e48bf35,0x3f553f6d,0xbe95bf6d,0x3f7f3f0e,0x3ef1bec4,0x3f463f7b
.long 0x3f35250d,0x3f353f80,0x3f35250d,0x3f353f80,0x3f753f6d,0xbdc93f0e,0x3f623ec4,0x3f223f7b
.long 0x3e483f35,0xbf55bec4,0x3f7b3f35,0x3f0e3f6d,0xbf46bec4,0xbf75bf7b,0x3f7f3f6d,0x3ef13f55
.long 0xbf6dbf80,0xbec4bf35,0x3f6d3f80,0x3ec43f35,0xbdc9bec4,0x3ef13e48,0x3f463f6d,0x3e953f0e
.long 0x3f553f35,0x3f7b3f6d,0x3f0e3f35,0x3e483ec4,0x3f623f6d,0x3f463f55,0x3e953ec4,0x3dc93e48
.long 0x3f800000,0x3f800000,0x00000000,0x00000000,0x3f7ec46d,0x3f7eb069,0x3dc8bd36,0x3dcefdb7,0x3f7b14be,0x3f7ac516,0x3e47c5c2,0x3e4dee60,0x3f74fa0b,0x3f74484b,0x3e94a031,0x3e9920fe
.long 0x3f6c835e,0x3f6b4b0c,0x3ec3ef15,0x3ec9b953,0x3f61c598,0x3f5fe4e9,0x3ef15aea,0x3ef840c8,0x3f54db31,0x3f5233c6,0x3f0e39da,0x3f121eb0,0x3f45e403,0x3f425b89,0x3f226799,0x3f269de3
.long 0x3f3504f3,0x3f3085bb,0x3f3504f3,0x3f396842,0x3f226799,0x3f1ce11f,0x3f45e403,0x3f4a4c87,0x3f0e39da,0x3f07a136,0x3f54db31,0x3f591e6a,0x3ef15aea,0x3ee1fb6a,0x3f61c598,0x3f65b710
.long 0x3ec3ef15,0x3eb263ef,0x3f6c835e,0x3f6ff573,0x3e94a031,0x3e80f8c0,0x3f74fa0b,0x3f77beb7,0x3e47c5c2,0x3e1c76de,0x3f7b14be,0x3f7cfe73,0x3dc8bd36,0x3d55880e,0x3f7ec46d,0x3f7fa6e3
.long 0x248d3132,0xbd48fb30,0x3f800000,0x3f7fb10f,0xbdc8bd36,0xbe195be0,0x3f7ec46d,0x3f7d1cdd,0xbe47c5c2,0xbe7ee6e1,0x3f7b14be,0x3f77f110,0xbe94a031,0xbeb0eacb,0x3f74fa0b,0x3f703b37
.long 0xbec3ef15,0xbee0924f,0x3f6c835e,0x3f660f88,0xbef15aea,0xbf06f686,0x3f61c598,0x3f5988ad,0xbf0e39da,0xbf1c420c,0x3f54db31,0x3f4ac77f,0xbf226799,0xbf2ff3e6,0x3f45e403,0x3f39f2ac
.long 0xbf3504f3,0xbf41d870,0x3f3504f3,0x3f273656,0xbf45e403,0xbf51c0c2,0x3f226799,0x3f12c39a,0xbf54db31,0xbf5f8327,0x3f0e39da,0x3ef9a02d,0xbf61c598,0xbf6afb8c,0x3ef15aea,0x3ecb2aae
.long 0xbf6c835e,0xbf740bdd,0x3ec3ef15,0x3e9aa086,0xbf74fa0b,0xbf7a9c59,0x3e94a031,0x3e5101f1,0xbf7b14be,0xbf7e9bc9,0x3e47c5c2,0x3dd53db9,0xbf7ec46d,0xbf7fffb1,0x3dc8bd36,0x3b490fc6
.long 0x3f800000,0x3f800000,0x00000000,0x00000000,0x3f7e70b0,0x3f7e5a38,0x3de1bc2e,0x3de7fa9a,0x3f79c79d,0x3f796e4e,0x3e605c13,0x3e667c66,0x3f721352,0x3f714c7a,0x3ea68f12,0x3eab0201
.long 0x3f676bd8,0x3f660f88,0x3edae880,0x3ee0924f,0x3f59f26a,0x3f57dc7f,0x3f064b82,0x3f099f4e,0x3f49d112,0x3f46e22a,0x3f1d7fd1,0x3f212ff9,0x3f373a23,0x3f33587a,0x3f32c8c9,0x3f36ad7f
.long 0x3f226799,0x3f1d7fd1,0x3f45e403,0x3f49d112,0x3f0b9a6b,0x3f05a02c,0x3f5695e5,0x3f5a5ba0,0x3ee63375,0x3ed8106b,0x3f64aa59,0x3f6816a8,0x3eb263ef,0x3ea21887,0x3f6ff573,0x3f72d4eb
.long 0x3e78cfcc,0x3e541501,0x3f7853f8,0x3f7a7302,0x3e09cf86,0x3dc27c39,0x3f7dabcc,0x3f7ed7d4,0x3cc90ab0,0xbc96c9b6,0x3f7fec43,0x3f7ff4e6,0xbdafb680,0xbe06b26e,0x3f7f0e58,0x3f7dc68c
.long 0xbe47c5c2,0xbe78cfcc,0x3f7b14be,0x3f7853f8,0xbe9aa086,0xbeb3dca5,0x3f740bdd,0x3f6faf1b,0xbecf7bca,0xbee900b7,0x3f6a09a7,0x3f63f473,0xbf00e7e4,0xbf0d9281,0x3f5d2d53,0x3f554aa4
.long 0xbf187fc0,0xbf24d225,0x3f4d9f02,0x3f43e200,0xbf2e3bde,0xbf39f2ac,0x3f3b8f3b,0x3f2ff3e6,0xbf41d870,0xbf4cae79,0x3f273656,0x3f19c200,0xbf531849,0xbf5cc7d1,0x3f10d3cd,0x3f019573
.long 0xbf61c598,0xbf6a09a7,0x3ef15aea,0x3ecf7bca,0xbf6db293,0xbf74484b,0x3ebe1d4a,0x3e9920fe,0xbf76ba07,0xbf7b61fc,0x3e888e93,0x3e419b37,0xbf7cbfc9,0xbf7f3f54,0x3e22abb6,0x3d9cecf9
.long 0xbf7fb10f,0xbf7fd397,0x3d48fb30,0xbd16c32c,0xbf7f84ab,0xbf7d1cdd,0xbd7b2b74,0xbe195be0,0xbf7c3b28,0xbf772417,0xbe2f10a2,0xbe8586ce,0xbf75dec6,0xbf6dfcf2,0xbe8e9a22,0xbebca7af
.long 0x3f800000,0x3f800000,0x00000000,0x00000000,0x3f7e9bc9,0x3f7e868b,0x3dd53db9,0x3ddb7d37,0x3f7a7302,0x3f7a1e84,0x3e541501,0x3e5a3997,0x3f73913f,0x3f72d4eb,0x3e9d9e78,0x3ea21887
.long 0x3f6a09a7,0x3f68bf3c,0x3ecf7bca,0x3ed53641,0x3f5df6be,0x3f5bfb34,0x3eff17b2,0x3f02ef9f,0x3f4f7a1f,0x3f4cae79,0x3f15f6d9,0x3f19c200,0x3f3ebc1b,0x3f3b0629,0x3f2ac082,0x3f2ecef7
.long 0x3f2beb4a,0x3f273656,0x3f3daef9,0x3f41d870,0x3f173c07,0x3f11796b,0x3f4e8d90,0x3f52a649,0x3f00e7e4,0x3ef41f07,0x3f5d2d53,0x3f6106f2,0x3ed25a09,0x3ec27b55,0x3f696591,0x3f6cd007
.long 0x3ea09ae5,0x3e8e9a22,0x3f731447,0x3f75dec6,0x3e5a3997,0x3e3228d4,0x3f7a1e84,0x3f7c187a,0x3de1bc2e,0x3d8a200a,0x3f7e70b0,0x3f7f6ac7,0x3bc90f88,0xbd2351cb,0x3f7ffec4,0x3f7fcbe2
.long 0xbdc8bd36,0xbe164083,0x3f7ec46d,0x3f7d3aac,0xbe4dee60,0xbe80f8c0,0x3f7ac516,0x3f77beb7,0xbe9aa086,0xbeb554ec,0x3f740bdd,0x3f6f6830,0xbecc9b8b,0xbee79a5d,0x3f6aab7b,0x3f644fac
.long 0xbefc5d27,0xbf0b9a6b,0x3f5ebe05,0x3f5695e5,0xbf14b039,0xbf21cbfb,0x3f5064af,0x3f466354,0xbf299415,0xbf36206c,0x3f3fc767,0x3f33e7bc,0xbf3ca003,0xbf485bca,0x3f2d1469,0x3f1f599f
.long 0xbf4d9f02,0xbf584853,0x3f187fc0,0x3f08f59b,0xbf5c61c7,0xbf65b710,0x3f0242b1,0x3ee1fb6a,0xbf68bf3c,0xbf708066,0x3ed53641,0x3eaf713a,0xbf7294f8,0xbf788486,0x3ea395c5,0x3e75c35a
.long 0xbf79c79d,0xbf7dabcc,0x3e605c13,0x3e09cf86,0xbf7e4323,0xbf7fe705,0x3dee3876,0x3ce22a7a,0xbf7ffb11,0xbf7f2f9d,0x3c490e90,0xbda3308c,0xbf7eea9d,0xbf7b87b2,0xbdbc3ac3,0xbe3e853e
.long 0x3f800000,0x3f800000,0x00000000,0x00000000,0x3f7e4323,0x3f7e2b72,0x3dee3876,0x3df475c0,0x3f791298,0x3f78b47b,0x3e6c9a7f,0x3e72b651,0x3f708066,0x3f6faf1b,0x3eaf713a,0x3eb3dca5
.long 0x3f64aa59,0x3f633c5a,0x3ee63375,0x3eebcbbb,0x3f55b993,0x3f5389c7,0x3f0cead0,0x3f102dd5,0x3f43e200,0x3f40d0da,0x3f24d225,0x3f286605,0x3f2f61a5,0x3f2b561b,0x3f3a7ca4,0x3f3e35c5
.long 0x3f187fc0,0x3f13682a,0x3f4d9f02,0x3f514d3d,0x3eff17b2,0x3ef2bd43,0x3f5df6be,0x3f61668a,0x3ec9b953,0x3ebb31a0,0x3f6b4b0c,0x3f6e46be,0x3e919ddd,0x3e80f8c0,0x3f756d97,0x3f77beb7
.long 0x3e2f10a2,0x3e09cf86,0x3f7c3b28,0x3f7dabcc,0x3d621469,0x3c7b514b,0x3f7f9c18,0x3f7ff84a,0xbd7b2b74,0xbdd53db9,0x3f7f84ab,0x3f7e9bc9,0xbe354098,0xbe636c83,0x3f7bf531,0x3f799b43
.long 0xbe94a031,0xbeac7cd4,0x3f74fa0b,0x3f710908,0xbecc9b8b,0xbee4cbfe,0x3f6aab7b,0x3f650479,0xbf00e7e4,0xbf0cead0,0x3f5d2d53,0x3f55b993,0xbf19c200,0xbf256bcb,0x3f4cae79,0x3f436051
.long 0xbf3085bb,0xbf3b8f3b,0x3f396842,0x3f2e3bde,0xbf44e3f5,0xbf4f0417,0x3f239da9,0x3f16999f,0xbf5695e5,0xbf5f8327,0x3f0b9a6b,0x3ef9a02d,0xbf655e0b,0xbf6cd007,0x3ee363fa,0x3ec27b55
.long 0xbf710908,0xbf76ba07,0x3eac7cd4,0x3e888e93,0xbf796e4e,0xbf7d1cdd,0x3e667c66,0x3e195be0,0xbf7e70b0,0xbf7fe129,0x3de1bc2e,0x3cfb49ba,0xbf7ffec4,0xbf7efcc9,0xbbc90f88,0xbdb5f8da
.long 0xbf7e1324,0xbf7a7302,0xbdfab273,0xbe541501,0xbf78b47b,0xbf725470,0xbe72b651,0xbea5129f,0xbf6ff573,0xbf66becc,0xbeb263ef,0xbeddbe79,0xbf63f473,0xbf57dc7f,0xbee900b7,0xbf099f4e
.long 0x3f800000,0x3f800000,0x00000000,0x00000000,0x3f7e1324,0x3f7dfa38,0x3dfab273,0x3e007745,0x3f7853f8,0x3f77f110,0x3e78cfcc,0x3e7ee6e1,0x3f6ed89e,0x3f6dfcf2,0x3eb8442a,0x3ebca7af
.long 0x3f61c598,0x3f604621,0x3ef15aea,0x3ef6e0cb,0x3f514d3d,0x3f4f0417,0x3f13682a,0x3f16999f,0x3f3daef9,0x3f3a7ca4,0x3f2beb4a,0x3f2f61a5,0x3f273656,0x3f2302d3,0x3f41d870,0x3f456439
.long 0x3f0e39da,0x3f08f59b,0x3f54db31,0x3f584853,0x3ee63375,0x3ed97cb9,0x3f64aa59,0x3f67c187,0x3eac7cd4,0x3e9d9e78,0x3f710908,0x3f73913f,0x3e605c13,0x3e3e853e,0x3f79c79d,0x3f7b87b2
.long 0x3dc8bd36,0x3d7b2b74,0x3f7ec46d,0x3f7f84ab,0xbcc90ab0,0xbd83db0a,0x3f7fec43,0x3f7f7808,0xbe164083,0xbe419b37,0x3f7d3aac,0x3f7b61fc,0xbe888e93,0xbe9f1cdf,0x3f76ba07,0x3f73530e
.long 0xbec3ef15,0xbedae880,0x3f6c835e,0x3f676bd8,0xbefc5d27,0xbf099f4e,0x3f5ebe05,0x3f57dc7f,0xbf187fc0,0xbf239da9,0x3f4d9f02,0x3f44e3f5,0xbf3085bb,0xbf3b0629,0x3f396842,0x3f2ecef7
.long 0xbf45e403,0xbf4f7a1f,0x3f226799,0x3f15f6d9,0xbf584853,0xbf60a6cf,0x3f08f59b,0x3ef58035,0xbf676bd8,0xbf6e46be,0x3edae880,0x3ebb31a0,0xbf731447,0xbf7822d1,0x3ea09ae5,0x3e7bdba4
.long 0xbf7b14be,0xbf7e1324,0x3e47c5c2,0x3dfab273,0xbf7f4e6d,0xbf7fffb1,0x3d96a905,0xbb490fc6,0xbf7fb10f,0xbf7de0b1,0xbd48fb30,0xbe039502,0xbf7c3b28,0xbf77beb7,0xbe2f10a2,0xbe80f8c0
.long 0xbf74fa0b,0xbf6db293,0xbe94a031,0xbebe1d4a,0xbf6a09a7,0xbf5fe4e9,0xbecf7bca,0xbef840c8,0xbf5b941a,0xbf4e8d90,0xbf039c3d,0xbf173c07,0xbf49d112,0xbf39f2ac,0xbf1d7fd1,0xbf2ff3e6
.long 0x3f800000,0x3f800000,0x00000000,0x00000000,0x3f7dabcc,0x3f7d906e,0x3e09cf86,0x3e0cec4a,0x3f76ba07,0x3f764d97,0x3e888e93,0x3e8b9507,0x3f6b4b0c,0x3f6a5ad9,0x3ec9b953,0x3ece0bea
.long 0x3f5b941a,0x3f59f26a,0x3f039c3d,0x3f064b82,0x3f47de65,0x3f456439,0x3f1ff6cb,0x3f2302d3,0x3f3085bb,0x3f2d1469,0x3f396842,0x3f3ca003,0x3f15f6d9,0x3f11796b,0x3f4f7a1f,0x3f52a649
.long 0x3ef15aea,0x3ee63375,0x3f61c598,0x3f64aa59,0x3eb263ef,0x3ea5129f,0x3f6ff573,0x3f725470,0x3e605c13,0x3e419b37,0x3f79c79d,0x3f7b61fc,0x3dafb680,0x3d55880e,0x3f7f0e58,0x3f7fa6e3
.long 0xbd48fb30,0xbdafb680,0x3f7fb10f,0x3f7f0e58,0xbe3b6ecf,0xbe636c83,0x3f7baccd,0x3f799b43,0xbea09ae5,0xbeb554ec,0x3f731447,0x3f6f6830,0xbee0924f,0xbef58035,0x3f660f88,0x3f60a6cf
.long 0xbf0e39da,0xbf187fc0,0x3f54db31,0x3f4d9f02,0xbf299415,0xbf33587a,0x3f3fc767,0x3f36ad7f,0xbf41d870,0xbf4ac77f,0x3f273656,0x3f1c420c,0xbf5695e5,0xbf5e5aa6,0x3f0b9a6b,0x3efdbabb
.long 0xbf676bd8,0xbf6db293,0x3edae880,0x3ebe1d4a,0xbf740bdd,0xbf788486,0x3e9aa086,0x3e75c35a,0xbf7c3b28,0xbf7e9bc9,0x3e2f10a2,0x3dd53db9,0xbf7fd397,0xbf7fdaaf,0x3d16c32c,0xbd0a342f
.long 0xbf7ec46d,0xbf7c3b28,0xbdc8bd36,0xbe2f10a2,0xbf791298,0xbf73ced9,0xbe6c9a7f,0xbe9c1faf,0xbf6ed89e,0xbf66becc,0xbeb8442a,0xbeddbe79,0xbf604621,0xbf554aa4,0xbef6e0cb,0xbf0d9281
.long 0xbf4d9f02,0xbf3fc767,0xbf187fc0,0xbf299415,0xbf373a23,0xbf269de3,0xbf32c8c9,0xbf425b89,0xbf1d7fd1,0xbf0a48ad,0xbf49d112,0xbf577026,0xbf00e7e4,0xbed6a399,0xbf5d2d53,0xbf686b39
.long 0x3f800000,0x3f800000,0x00000000,0x00000000,0x3f7de0b1,0x3f7dc68c,0x3e039502,0x3e06b26e,0x3f778bc5,0x3f772417,0x3e827dc0,0x3e8586ce,0x3f6d1c1d,0x3f6c3624,0x3ec1071e,0x3ec5625c
.long 0x3f5ebe05,0x3f5d2d53,0x3efc5d27,0x3f00e7e4,0x3f4cae79,0x3f4a4c87,0x3f19c200,0x3f1ce11f,0x3f373a23,0x3f33e7bc,0x3f32c8c9,0x3f36206c,0x3f1ebc12,0x3f1a6293,0x3f48d8b3,0x3f4c3578
.long 0x3f039c3d,0x3efc5d27,0x3f5b941a,0x3f5ebe05,0x3ecc9b8b,0x3ebf926f,0x3f6aab7b,0x3f6d67a1,0x3e8e9a22,0x3e7ee6e1,0x3f75dec6,0x3f77f110,0x3e1c76de,0x3df475c0,0x3f7cfe73,0x3f7e2b72
.long 0x3cc90ab0,0xbc490e90,0x3f7fec43,0x3f7ffb11,0xbdd53db9,0xbe1324ca,0x3f7e9bc9,0x3f7d57de,0xbe6c9a7f,0xbe8b9507,0x3f791298,0x3f764d97,0xbeb554ec,0xbecb2aae,0x3f6f6830,0x3f6afb8c
.long 0xbef15aea,0xbf039c3d,0x3f61c598,0x3f5b941a,0xbf14b039,0xbf1f599f,0x3f5064af,0x3f485bca,0xbf2e3bde,0xbf385216,0x3f3b8f3b,0x3f31a81d,0xbf44e3f5,0xbf4e1689,0x3f239da9,0x3f17de12
.long 0xbf584853,0xbf604621,0x3f08f59b,0x3ef6e0cb,0xbf6816a8,0xbf6e8ff8,0x3ed8106b,0x3eb9bb1e,0xbf740bdd,0xbf78b47b,0x3e9aa086,0x3e72b651,0xbf7bf531,0xbf7e868b,0x3e354098,0x3ddb7d37
.long 0xbf7fb10f,0xbf7fec43,0x3d48fb30,0xbcc90ab0,0xbf7f2f9d,0xbf7cdf6c,0xbda3308c,0xbe1f917b,0xbf7a7302,0xbf756d97,0xbe541501,0xbe919ddd,0xbf718f57,0xbf69b7e4,0xbea986c4,0xbed0eb2a
.long 0xbf64aa59,0xbf59f26a,0xbee63375,0xbf064b82,0xbf53fac3,0xbf466354,0xbf0f8784,0xbf21cbfb,0xbf3fc767,0xbf2f61a5,0xbf299415,0xbf3a7ca4,0xbf286605,0xbf1553b7,0xbf40d0da,0xbf4fefa8
.long 0x3f800000,0x3f800000,0x00000000,0x00000000,0x3f7d7474,0x3f7d57de,0x3e1008b7,0x3e1324ca,0x3f75dec6,0x3f756d97,0x3e8e9a22,0x3e919ddd,0x3f696591,0x3f686b39,0x3ed25a09,0x3ed6a399
.long 0x3f584853,0x3f5695e5,0x3f08f59b,0x3f0b9a6b,0x3f42de29,0x3f404c5c,0x3f26050a,0x3f28fd41,0x3f299415,0x3f26050a,0x3f3fc767,0x3f42de29,0x3f0cead0,0x3f084b92,0x3f55b993,0x3f58b3a1
.long 0x3edae880,0x3ecf7bca,0x3f676bd8,0x3f6a09a7,0x3e97a117,0x3e8a11f7,0x3f748422,0x3f76841b,0x3e22abb6,0x3e039502,0x3f7cbfc9,0x3f7de0b1,0x3c96c9b6,0xbc7b514b,0x3f7ff4e6,0x3f7ff84a
.long 0xbdfab273,0xbe22abb6,0x3f7e1324,0x3f7cbfc9,0xbe8586ce,0xbe9920fe,0x3f772417,0x3f74484b,0xbec9b953,0xbeddbe79,0x3f6b4b0c,0x3f66becc,0xbf04f484,0xbf0ee0db,0x3f5ac450,0x3f546b3b
.long 0xbf226799,0xbf2beb4a,0x3f45e403,0x3f3daef9,0xbf3ca003,0xbf456439,0x3f2d1469,0x3f2302d3,0xbf531849,0xbf5ac450,0x3f10d3cd,0x3f04f484,0xbf655e0b,0xbf6b99fb,0x3ee363fa,0x3ec8477c
.long 0xbf731447,0xbf778bc5,0x3ea09ae5,0x3e827dc0,0xbf7bf531,0xbf7e5a38,0x3e354098,0x3de7fa9a,0xbf7fd397,0xbf7fe129,0x3d16c32c,0xbcfb49ba,0xbf7e9bc9,0xbf7c187a,0xbdd53db9,0xbe3228d4
.long 0xbf7853f8,0xbf731447,0xbe78cfcc,0xbea09ae5,0xbf6d1c1d,0xbf650479,0xbec1071e,0xbee4cbfe,0xbf5d2d53,0xbf5233c6,0xbf00e7e4,0xbf121eb0,0xbf48d8b3,0xbf3b0629,0xbf1ebc12,0xbf2ecef7
.long 0xbf3085bb,0xbf1ff6cb,0xbf396842,0xbf47de65,0xbf14b039,0xbf019573,0xbf5064af,0xbf5cc7d1,0xbeebcbbb,0xbec1071e,0xbf633c5a,0xbf6d1c1d,0xbea986c4,0xbe75c35a,0xbf718f57,0xbf788486
.long 0x3f800000,0x3f800000,0x00000000,0x00000000,0x3f7d3aac,0x3f7d1cdd,0x3e164083,0x3e195be0,0x3f74fa0b,0x3f748422,0x3e94a031,0x3e97a117,0x3f676bd8,0x3f666771,0x3edae880,0x3edf28a9
.long 0x3f54db31,0x3f531849,0x3f0e39da,0x3f10d3cd,0x3f3daef9,0x3f3b0629,0x3f2beb4a,0x3f2ecef7,0x3f226799,0x3f1ebc12,0x3f45e403,0x3f48d8b3,0x3f039c3d,0x3efdbabb,0x3f5b941a,0x3f5e5aa6
.long 0x3ec3ef15,0x3eb8442a,0x3f6c835e,0x3f6ed89e,0x3e78cfcc,0x3e5d4b1a,0x3f7853f8,0x3f79f35e,0x3dc8bd36,0x3d8a200a,0x3f7ec46d,0x3f7f6ac7,0xbd48fb30,0xbda973ba,0x3f7fb10f,0x3f7f1f49
.long 0xbe47c5c2,0xbe6c9a7f,0x3f7b14be,0x3f791298,0xbeac7cd4,0xbebf926f,0x3f710908,0x3f6d67a1,0xbef15aea,0xbf0242b1,0x3f61c598,0x3f5c61c7,0xbf187fc0,0xbf21cbfb,0x3f4d9f02,0x3f466354
.long 0xbf3504f3,0xbf3daef9,0x3f3504f3,0x3f2beb4a,0xbf4d9f02,0xbf554aa4,0x3f187fc0,0x3f0d9281,0xbf61c598,0xbf6816a8,0x3ef15aea,0x3ed8106b,0xbf710908,0xbf75a67b,0x3eac7cd4,0x3e901c2c
.long 0xbf7b14be,0xbf7dabcc,0x3e47c5c2,0x3e09cf86,0xbf7fb10f,0xbf7ff84a,0x3d48fb30,0xbc7b514b,0xbf7ec46d,0xbf7c7eb0,0xbdc8bd36,0xbe28defc,0xbf7853f8,0xbf73530e,0xbe78cfcc,0xbe9f1cdf
.long 0xbf6c835e,0xbf64aa59,0xbec3ef15,0xbee63375,0xbf5b941a,0xbf50d937,0xbf039c3d,0xbf140c5f,0xbf45e403,0xbf385216,0xbf226799,0xbf31a81d,0xbf2beb4a,0xbf1ba299,0xbf3daef9,0xbf4b41fa
.long 0xbf0e39da,0xbef6e0cb,0xbf54db31,0xbf604621,0xbedae880,0xbeb0eacb,0xbf676bd8,0xbf703b37,0xbe94a031,0xbe4dee60,0xbf74fa0b,0xbf7ac516,0xbe164083,0xbd55880e,0xbf7d3aac,0xbf7fa6e3
.long 0x3f800000,0x3f800000,0x00000000,0x00000000,0x3f7cbfc9,0x3f7c9f8a,0x3e22abb6,0x3e25c58c,0x3f731447,0x3f7294f8,0x3ea09ae5,0x3ea395c5,0x3f633c5a,0x3f62241a,0x3eebcbbb,0x3eeff7fb
.long 0x3f4d9f02,0x3f4bbbf8,0x3f187fc0,0x3f1b02c6,0x3f32c8c9,0x3f2ff3e6,0x3f373a23,0x3f39f2ac,0x3f13682a,0x3f0f8784,0x3f514d3d,0x3f53fac3,0x3ee0924f,0x3ed6a399,0x3f660f88,0x3f686b39
.long 0x3e94a031,0x3e888e93,0x3f74fa0b,0x3f76ba07,0x3e09cf86,0x3ddb7d37,0x3f7dabcc,0x3f7e868b,0xbcc90ab0,0xbd621469,0x3f7fec43,0x3f7f9c18,0xbe3b6ecf,0xbe5d4b1a,0x3f7baccd,0x3f79f35e
.long 0xbeac7cd4,0xbebe1d4a,0x3f710908,0x3f6db293,0xbef6e0cb,0xbf044889,0x3f604621,0x3f5b2c79,0xbf1d7fd1,0xbf26050a,0x3f49d112,0x3f42de29,0xbf3b8f3b,0xbf436051,0x3f2e3bde,0x3f256bcb
.long 0xbf54db31,0xbf5b941a,0x3f0e39da,0x3f039c3d,0xbf68bf3c,0xbf6dfcf2,0x3ed53641,0x3ebca7af,0xbf76ba07,0xbf7a1e84,0x3e888e93,0x3e5a3997,0xbf7e70b0,0xbf7fa6e3,0x3de1bc2e,0x3d55880e
.long 0xbf7fb10f,0xbf7e70b0,0xbd48fb30,0xbde1bc2e,0xbf7a7302,0xbf76841b,0xbe541501,0xbe8a11f7,0xbf6ed89e,0xbf6816a8,0xbeb8442a,0xbed8106b,0xbf5d2d53,0xbf5389c7,0xbf00e7e4,0xbf102dd5
.long 0xbf45e403,0xbf396842,0xbf226799,0xbf3085bb,0xbf299415,0xbf1a6293,0xbf3fc767,0xbf4c3578,0xbf08f59b,0xbeee9479,0xbf584853,0xbf628210,0xbec9b953,0xbea21887,0xbf6b4b0c,0xbf72d4eb
.long 0xbe78cfcc,0xbe22abb6,0xbf7853f8,0xbf7cbfc9,0xbdafb680,0x3b490fc6,0xbf7f0e58,0xbf7fffb1,0x3d96a905,0x3e28defc,0xbf7f4e6d,0xbf7c7eb0,0x3e6c9a7f,0x3ea5129f,0xbf791298,0xbf725470
.long 0x3f800000,0x3f800000,0x00000000,0x00000000,0x3f7cfe73,0x3f7cdf6c,0x3e1c76de,0x3e1f917b,0x3f740bdd,0x3f73913f,0x3e9aa086,0x3e9d9e78,0x3f655e0b,0x3f644fac,0x3ee363fa,0x3ee79a5d
.long 0x3f514d3d,0x3f4f7a1f,0x3f13682a,0x3f15f6d9,0x3f385216,0x3f3592e7,0x3f31a81d,0x3f34768f,0x3f1b02c6,0x3f173c07,0x3f4bbbf8,0x3f4e8d90,0x3ef41f07,0x3eea6681,0x3f6106f2,0x3f6398ac
.long 0x3eac7cd4,0x3ea09ae5,0x3f710908,0x3f731447,0x3e419b37,0x3e25c58c,0x3f7b61fc,0x3f7c9f8a,0x3d16c32c,0x3bc90f88,0x3f7fd397,0x3f7ffec4,0xbdee3876,0xbe195be0,0x3f7e4323,0x3f7d1cdd
.long 0xbe888e93,0xbe9aa086,0x3f76ba07,0x3f740bdd,0xbed25a09,0xbee4cbfe,0x3f696591,0x3f650479,0xbf0b9a6b,0xbf14b039,0x3f5695e5,0x3f5064af,0xbf2ac082,0xbf33587a,0x3f3ebc1b,0x3f36ad7f
.long 0xbf45e403,0xbf4d9f02,0x3f226799,0x3f187fc0,0xbf5c61c7,0xbf62df7b,0x3f0242b1,0x3eed3063,0xbf6db293,0xbf7294f8,0x3ebe1d4a,0x3ea395c5,0xbf796e4e,0xbf7c5d3a,0x3e667c66,0x3e2bf804
.long 0xbf7f4e6d,0xbf7ffb11,0x3d96a905,0x3c490e90,0xbf7f2f9d,0xbf7d57de,0xbda3308c,0xbe1324ca,0xbf791298,0xbf748422,0xbe6c9a7f,0xbe97a117,0xbf6d1c1d,0xbf65b710,0xbec1071e,0xbee1fb6a
.long 0xbf5b941a,0xbf514d3d,0xbf039c3d,0xbf13682a,0xbf44e3f5,0xbf37c655,0xbf239da9,0xbf3238aa,0xbf299415,0xbf19c200,0xbf3fc767,0xbf4cae79,0xbf0a48ad,0xbeeff7fb,0xbf577026,0xbf62241a
.long 0xbecf7bca,0xbea68f12,0xbf6a09a7,0xbf721352,0xbe8586ce,0xbe3228d4,0xbf772417,0xbf7c187a,0xbde1bc2e,0xbc96c9b6,0xbf7e70b0,0xbf7ff4e6,0x3d2fe007,0x3e0cec4a,0xbf7fc38f,0xbf7d906e
.long 0x3f800000,0x3f800000,0x00000000,0x00000000,0x3f7c7eb0,0x3f7c5d3a,0x3e28defc,0x3e2bf804,0x3f721352,0x3f718f57,0x3ea68f12,0x3ea986c4,0x3f6106f2,0x3f5fe4e9,0x3ef41f07,0x3ef840c8
.long 0x3f49d112,0x3f47de65,0x3f1d7fd1,0x3f1ff6cb,0x3f2d1469,0x3f2a2a80,0x3f3ca003,0x3f3f41fc,0x3f0b9a6b,0x3f07a136,0x3f5695e5,0x3f591e6a,0x3ecc9b8b,0x3ec27b55,0x3f6aab7b,0x3f6cd007
.long 0x3e78cfcc,0x3e605c13,0x3f7853f8,0x3f79c79d,0x3da3308c,0x3d55880e,0x3f7f2f9d,0x3f7fa6e3,0xbdafb680,0xbdee3876,0x3f7f0e58,0x3f7e4323,0xbe7ee6e1,0xbe901c2c,0x3f77f110,0x3f75a67b
.long 0xbecf7bca,0xbee0924f,0x3f6a09a7,0x3f660f88,0xbf0cead0,0xbf1553b7,0x3f55b993,0x3f4fefa8,0xbf2e3bde,0xbf36206c,0x3f3b8f3b,0x3f33e7bc,0xbf4ac77f,0xbf51c0c2,0x3f1c420c,0x3f12c39a
.long 0xbf61c598,0xbf676bd8,0x3ef15aea,0x3edae880,0xbf7294f8,0xbf76841b,0x3ea395c5,0x3e8a11f7,0xbf7cbfc9,0xbf7e9bc9,0x3e22abb6,0x3dd53db9,0xbf7ffec4,0xbf7f7808,0xbbc90f88,0xbd83db0a
.long 0xbf7c3b28,0xbf791298,0xbe2f10a2,0xbe6c9a7f,0xbf718f57,0xbf6b99fb,0xbea986c4,0xbec8477c,0xbf604621,0xbf577026,0xbef6e0cb,0xbf0a48ad,0xbf48d8b3,0xbf3d27b8,0xbf1ebc12,0xbf2c800f
.long 0xbf2beb4a,0xbf1d7fd1,0xbf3daef9,0xbf49d112,0xbf0a48ad,0xbef2bd43,0xbf577026,0xbf61668a,0xbec9b953,0xbea395c5,0xbf6b4b0c,0xbf7294f8,0xbe72b651,0xbe1f917b,0xbf78b47b,0xbf7cdf6c
.long 0xbd96a905,0x3c490e90,0xbf7f4e6d,0xbf7ffb11,0x3dbc3ac3,0x3e3857ec,0xbf7eea9d,0xbf7bd14d,0x3e827dc0,0x3eaf713a,0xbf778bc5,0xbf708066,0x3ed25a09,0x3efdbabb,0xbf696591,0xbf5e5aa6
.long 0x3f800000,0x3f800000,0x00000000,0x00000000,0x3f7c3b28,0x3f7c187a,0x3e2f10a2,0x3e3228d4,0x3f710908,0x3f708066,0x3eac7cd4,0x3eaf713a,0x3f5ebe05,0x3f5d924d,0x3efc5d27,0x3f003a06
.long 0x3f45e403,0x3f43e200,0x3f226799,0x3f24d225,0x3f273656,0x3f24381a,0x3f41d870,0x3f446337,0x3f039c3d,0x3eff17b2,0x3f5b941a,0x3f5df6be,0x3eb8442a,0x3eadf73c,0x3f6ed89e,0x3f70c501
.long 0x3e47c5c2,0x3e2f10a2,0x3f7b14be,0x3f7c3b28,0x3cc90ab0,0xbb490fc6,0x3f7fec43,0x3f7fffb1,0xbe164083,0xbe354098,0x3f7d3aac,0x3f7bf531,0xbea09ae5,0xbeb0eacb,0x3f731447,0x3f703b37
.long 0xbef15aea,0xbf00e7e4,0x3f61c598,0x3f5d2d53,0xbf1d7fd1,0xbf256bcb,0x3f49d112,0x3f436051,0xbf3daef9,0xbf44e3f5,0x3f2beb4a,0x3f239da9,0xbf584853,0xbf5e5aa6,0x3f08f59b,0x3efdbabb
.long 0xbf6c835e,0xbf710908,0x3ec3ef15,0x3eac7cd4,0xbf79c79d,0xbf7c5d3a,0x3e605c13,0x3e2bf804,0xbf7fb10f,0xbf7ffec4,0x3d48fb30,0xbbc90f88,0xbf7e1324,0xbf7bd14d,0xbdfab273,0xbe3857ec
.long 0xbf74fa0b,0xbf6ff573,0xbe94a031,0xbeb263ef,0xbf64aa59,0xbf5cc7d1,0xbee63375,0xbf019573,0xbf4d9f02,0xbf42de29,0xbf187fc0,0xbf26050a,0xbf3085bb,0xbf2302d3,0xbf396842,0xbf456439
.long 0xbf0e39da,0xbefc5d27,0xbf54db31,0xbf5ebe05,0xbecf7bca,0xbeab0201,0xbf6a09a7,0xbf714c7a,0xbe78cfcc,0xbe28defc,0xbf7853f8,0xbf7c7eb0,0xbd96a905,0x3c16cb58,0xbf7f4e6d,0xbf7ffd39
.long 0x3dc8bd36,0x3e3b6ecf,0xbf7ec46d,0xbf7baccd,0x3e888e93,0x3eb3dca5,0xbf76ba07,0xbf6faf1b,0x3edae880,0x3f0242b1,0xbf676bd8,0xbf5c61c7,0x3f13682a,0x3f269de3,0xbf514d3d,0xbf425b89
.long 0x3f800000,0x3f800000,0x00000000,0x00000000,0x3f7baccd,0x3f7b87b2,0x3e3b6ecf,0x3e3e853e,0x3f6ed89e,0x3f6e46be,0x3eb8442a,0x3ebb31a0,0x3f59f26a,0x3f58b3a1,0x3f064b82,0x3f084b92
.long 0x3f3daef9,0x3f3b8f3b,0x3f2beb4a,0x3f2e3bde,0x3f1b02c6,0x3f17de12,0x3f4bbbf8,0x3f4e1689,0x3ee63375,0x3eddbe79,0x3f64aa59,0x3f66becc,0x3e8e9a22,0x3e840270,0x3f75dec6,0x3f77583a
.long 0x3dc8bd36,0x3d96a905,0x3f7ec46d,0x3f7f4e6d,0xbdafb680,0xbde7fa9a,0x3f7f0e58,0x3f7e5a38,0xbe888e93,0xbe97a117,0x3f76ba07,0x3f748422,0xbee0924f,0xbeeff7fb,0x3f660f88,0x3f62241a
.long 0xbf187fc0,0xbf1ff6cb,0x3f4d9f02,0x3f47de65,0xbf3b8f3b,0xbf425b89,0x3f2e3bde,0x3f269de3,0xbf584853,0xbf5df6be,0x3f08f59b,0x3eff17b2,0xbf6db293,0xbf71d19f,0x3ebe1d4a,0x3ea80b1f
.long 0xbf7b14be,0xbf7d3aac,0x3e47c5c2,0x3e164083,0xbf7ffb11,0xbf7fcbe2,0x3c490e90,0xbd2351cb,0xbf7c3b28,0xbf796e4e,0xbe2f10a2,0xbe667c66,0xbf6ff573,0xbf6a5ad9,0xbeb263ef,0xbece0bea
.long 0xbf5b941a,0xbf531849,0xbf039c3d,0xbf10d3cd,0xbf3fc767,0xbf34768f,0xbf299415,0xbf3592e7,0xbf1d7fd1,0xbf0f8784,0xbf49d112,0xbf53fac3,0xbeebcbbb,0xbecb2aae,0xbf633c5a,0xbf6afb8c
.long 0xbe94a031,0xbe605c13,0xbf74fa0b,0xbf79c79d,0xbde1bc2e,0xbd0a342f,0xbf7e70b0,0xbf7fdaaf,0x3d96a905,0x3e1c76de,0xbf7f4e6d,0xbf7cfe73,0x3e827dc0,0x3eab0201,0xbf778bc5,0xbf714c7a
.long 0x3edae880,0x3f00e7e4,0xbf676bd8,0xbf5d2d53,0x3f15f6d9,0x3f27ce61,0xbf4f7a1f,0xbf4154e1,0x3f396842,0x3f48d8b3,0xbf3085bb,0xbf1ebc12,0x3f5695e5,0x3f62df7b,0xbf0b9a6b,0xbeed3063
.long 0x3f800000,0x3f800000,0x00000000,0x00000000,0x3f7bf531,0x3f7bd14d,0x3e354098,0x3e3857ec,0x3f6ff573,0x3f6f6830,0x3eb263ef,0x3eb554ec,0x3f5c61c7,0x3f5b2c79,0x3f0242b1,0x3f044889
.long 0x3f41d870,0x3f3fc767,0x3f273656,0x3f299415,0x3f212ff9,0x3f1e1e22,0x3f46e22a,0x3f495521,0x3ef6e0cb,0x3eee9479,0x3f604621,0x3f628210,0x3ea395c5,0x3e9920fe,0x3f7294f8,0x3f74484b
.long 0x3e164083,0x3dfab273,0x3f7d3aac,0x3f7e1324,0xbcfb49ba,0xbd6ea038,0x3f7fe129,0x3f7f90b1,0xbe541501,0xbe72b651,0x3f7a7302,0x3f78b47b,0xbec1071e,0xbed0eb2a,0x3f6d1c1d,0x3f69b7e4
.long 0xbf08f59b,0xbf10d3cd,0x3f584853,0x3f531849,0xbf2d1469,0xbf34768f,0x3f3ca003,0x3f3592e7,0xbf4bbbf8,0xbf5233c6,0x3f1b02c6,0x3f121eb0,0xbf63f473,0xbf6912ae,0x3ee900b7,0x3ed3c867
.long 0xbf74fa0b,0xbf7853f8,0x3e94a031,0x3e78cfcc,0xbf7e4323,0xbf7f7808,0x3dee3876,0x3d83db0a,0xbf7f84ab,0xbf7e4323,0xbd7b2b74,0xbdee3876,0xbf78b47b,0xbf74bf62,0xbe72b651,0xbe9620d2
.long 0xbf6a09a7,0xbf633c5a,0xbecf7bca,0xbeebcbbb,0xbf53fac3,0xbf4a4c87,0xbf0f8784,0xbf1ce11f,0xbf373a23,0xbf2ac082,0xbf32c8c9,0xbf3ebc1b,0xbf14b039,0xbf05a02c,0xbf5064af,0xbf5a5ba0
.long 0xbedae880,0xbeb8442a,0xbf676bd8,0xbf6ed89e,0xbe8586ce,0xbe3e853e,0xbf772417,0xbf7b87b2,0xbdafb680,0xbbc90f88,0xbf7f0e58,0xbf7ffec4,0x3dbc3ac3,0x3e3228d4,0xbf7eea9d,0xbf7c187a
.long 0x3e888e93,0x3eb263ef,0xbf76ba07,0xbf6ff573,0x3eddbe79,0x3f02ef9f,0xbf66becc,0xbf5bfb34,0x3f15f6d9,0x3f286605,0xbf4f7a1f,0xbf40d0da,0x3f385216,0x3f485bca,0xbf31a81d,0xbf1f599f
.long 0x3f800000,0x3f800000,0x00000000,0x00000000,0x3f7b61fc,0x3f7b3bab,0x3e419b37,0x3e44b0b9,0x3f6db293,0x3f6d1c1d,0x3ebe1d4a,0x3ec1071e,0x3f577026,0x3f5627fe,0x3f0a48ad,0x3f0c42c9
.long 0x3f396842,0x3f373a23,0x3f3085bb,0x3f32c8c9,0x3f14b039,0x3f11796b,0x3f5064af,0x3f52a649,0x3ed53641,0x3ecc9b8b,0x3f68bf3c,0x3f6aab7b,0x3e72b651,0x3e5d4b1a,0x3f78b47b,0x3f79f35e
.long 0x3d48fb30,0x3cc90ab0,0x3f7fb10f,0x3f7fec43,0xbe1008b7,0xbe2bf804,0x3f7d7474,0x3f7c5d3a,0xbea68f12,0xbeb554ec,0x3f721352,0x3f6f6830,0xbeff17b2,0xbf06f686,0x3f5df6be,0x3f5988ad
.long 0xbf273656,0xbf2e3bde,0x3f41d870,0x3f3b8f3b,0xbf48d8b3,0xbf4f0417,0x3f1ebc12,0x3f16999f,0xbf633c5a,0xbf6816a8,0x3eebcbbb,0x3ed8106b,0xbf756d97,0xbf788486,0x3e919ddd,0x3e75c35a
.long 0xbf7ec46d,0xbf7fb10f,0x3dc8bd36,0x3d48fb30,0xbf7eea9d,0xbf7d57de,0xbdbc3ac3,0xbe1324ca,0xbf75dec6,0xbf718f57,0xbe8e9a22,0xbea986c4,0xbf63f473,0xbf5cc7d1,0xbee900b7,0xbf019573
.long 0xbf49d112,0xbf3fc767,0xbf1d7fd1,0xbf299415,0xbf286605,0xbf1ba299,0xbf40d0da,0xbf4b41fa,0xbf00e7e4,0xbee363fa,0xbf5d2d53,0xbf655e0b,0xbea986c4,0xbe870ada,0xbf718f57,0xbf76ef5b
.long 0xbe164083,0xbd96a905,0xbf7d3aac,0xbf7f4e6d,0x3d2fe007,0x3df475c0,0xbf7fc38f,0xbf7e2b72,0x3e6c9a7f,0x3e9d9e78,0xbf791298,0xbf73913f,0x3ed25a09,0x3ef840c8,0xbf696591,0xbf5fe4e9
.long 0x3f13682a,0x3f24d225,0xbf514d3d,0xbf43e200,0x3f385216,0x3f476085,0xbf31a81d,0xbf209393,0x3f5695e5,0x3f628210,0xbf0b9a6b,0xbeee9479,0x3f6d1c1d,0x3f75341d,0xbec1071e,0xbe931f35
.long 0x3f800000,0x3f800000,0x80000000,0x80000000,0x3f800000,0x3f7fffb1,0x80000000,0xbb490fc6,0x3f800000,0x3f7ffec4,0x80000000,0xbbc90f88,0x3f800000,0x3f7ffd39,0x80000000,0xbc16cb58
.long 0x3f800000,0x3f7ffb11,0x80000000,0xbc490e90,0x3f800000,0x3f7ff84a,0x80000000,0xbc7b514b,0x3f800000,0x3f7ff4e6,0x80000000,0xbc96c9b6,0x3f800000,0x3f7ff0e3,0x80000000,0xbcafea69
.long 0x3f800000,0x3f7fec43,0x80000000,0xbcc90ab0,0x3f800000,0x3f7fe705,0x80000000,0xbce22a7a,0x3f800000,0x3f7fe129,0x80000000,0xbcfb49ba,0x3f800000,0x3f7fdaaf,0x80000000,0xbd0a342f
.long 0x3f800000,0x3f7fd397,0x80000000,0xbd16c32c,0x3f800000,0x3f7fcbe2,0x80000000,0xbd2351cb,0x3f800000,0x3f7fc38f,0x80000000,0xbd2fe007,0x3f800000,0x3f7fba9e,0x80000000,0xbd3c6dd5
.long 0x3f800000,0x3f7fb10f,0x80000000,0xbd48fb30,0x3f800000,0x3f7fa6e3,0x80000000,0xbd55880e,0x3f800000,0x3f7f9c18,0x80000000,0xbd621469,0x3f800000,0x3f7f90b1,0x80000000,0xbd6ea038
.long 0x3f800000,0x3f7f84ab,0x80000000,0xbd7b2b74,0x3f800000,0x3f7f7808,0x80000000,0xbd83db0a,0x3f800000,0x3f7f6ac7,0x80000000,0xbd8a200a,0x3f800000,0x3f7f5ce9,0x80000000,0xbd9064b4
.long 0x3f800000,0x3f7f4e6d,0x80000000,0xbd96a905,0x3f800000,0x3f7f3f54,0x80000000,0xbd9cecf9,0x3f800000,0x3f7f2f9d,0x80000000,0xbda3308c,0x3f800000,0x3f7f1f49,0x80000000,0xbda973ba
.long 0x3f800000,0x3f7f0e58,0x80000000,0xbdafb680,0x3f800000,0x3f7efcc9,0x80000000,0xbdb5f8da,0x3f800000,0x3f7eea9d,0x80000000,0xbdbc3ac3,0x3f800000,0x3f7ed7d4,0x80000000,0xbdc27c39
.long 0x3f800000,0x3f800000,0x80000000,0x80000000,0x3f7ffb11,0x3f7ff84a,0xbc490e90,0xbc7b514b,0x3f7fec43,0x3f7fe129,0xbcc90ab0,0xbcfb49ba,0x3f7fd397,0x3f7fba9e,0xbd16c32c,0xbd3c6dd5
.long 0x3f7fb10f,0x3f7f84ab,0xbd48fb30,0xbd7b2b74,0x3f7f84ab,0x3f7f3f54,0xbd7b2b74,0xbd9cecf9,0x3f7f4e6d,0x3f7eea9d,0xbd96a905,0xbdbc3ac3,0x3f7f0e58,0x3f7e868b,0xbdafb680,0xbddb7d37
.long 0x3f7ec46d,0x3f7e1324,0xbdc8bd36,0xbdfab273,0x3f7e70b0,0x3f7d906e,0xbde1bc2e,0xbe0cec4a,0x3f7e1324,0x3f7cfe73,0xbdfab273,0xbe1c76de,0x3f7dabcc,0x3f7c5d3a,0xbe09cf86,0xbe2bf804
.long 0x3f7d3aac,0x3f7baccd,0xbe164083,0xbe3b6ecf,0x3f7cbfc9,0x3f7aed37,0xbe22abb6,0xbe4ada4f,0x3f7c3b28,0x3f7a1e84,0xbe2f10a2,0xbe5a3997,0x3f7baccd,0x3f7940c0,0xbe3b6ecf,0xbe698bba
.long 0x3f7b14be,0x3f7853f8,0xbe47c5c2,0xbe78cfcc,0x3f7a7302,0x3f77583a,0xbe541501,0xbe840270,0x3f79c79d,0x3f764d97,0xbe605c13,0xbe8b9507,0x3f791298,0x3f75341d,0xbe6c9a7f,0xbe931f35
.long 0x3f7853f8,0x3f740bdd,0xbe78cfcc,0xbe9aa086,0x3f778bc5,0x3f72d4eb,0xbe827dc0,0xbea21887,0x3f76ba07,0x3f718f57,0xbe888e93,0xbea986c4,0x3f75dec6,0x3f703b37,0xbe8e9a22,0xbeb0eacb
.long 0x3f74fa0b,0x3f6ed89e,0xbe94a031,0xbeb8442a,0x3f740bdd,0x3f6d67a1,0xbe9aa086,0xbebf926f,0x3f731447,0x3f6be858,0xbea09ae5,0xbec6d529,0x3f721352,0x3f6a5ad9,0xbea68f12,0xbece0bea
.long 0x3f710908,0x3f68bf3c,0xbeac7cd4,0xbed53641,0x3f6ff573,0x3f671599,0xbeb263ef,0xbedc53c1,0x3f6ed89e,0x3f655e0b,0xbeb8442a,0xbee363fa,0x3f6db293,0x3f6398ac,0xbebe1d4a,0xbeea6681
.long 0x3f800000,0x3f800000,0x80000000,0x80000000,0x3f7ffec4,0x3f7ffd39,0xbbc90f88,0xbc16cb58,0x3f7ffb11,0x3f7ff4e6,0xbc490e90,0xbc96c9b6,0x3f7ff4e6,0x3f7fe705,0xbc96c9b6,0xbce22a7a
.long 0x3f7fec43,0x3f7fd397,0xbcc90ab0,0xbd16c32c,0x3f7fe129,0x3f7fba9e,0xbcfb49ba,0xbd3c6dd5,0x3f7fd397,0x3f7f9c18,0xbd16c32c,0xbd621469,0x3f7fc38f,0x3f7f7808,0xbd2fe007,0xbd83db0a
.long 0x3f7fb10f,0x3f7f4e6d,0xbd48fb30,0xbd96a905,0x3f7f9c18,0x3f7f1f49,0xbd621469,0xbda973ba,0x3f7f84ab,0x3f7eea9d,0xbd7b2b74,0xbdbc3ac3,0x3f7f6ac7,0x3f7eb069,0xbd8a200a,0xbdcefdb7
.long 0x3f7f4e6d,0x3f7e70b0,0xbd96a905,0xbde1bc2e,0x3f7f2f9d,0x3f7e2b72,0xbda3308c,0xbdf475c0,0x3f7f0e58,0x3f7de0b1,0xbdafb680,0xbe039502,0x3f7eea9d,0x3f7d906e,0xbdbc3ac3,0xbe0cec4a
.long 0x3f7ec46d,0x3f7d3aac,0xbdc8bd36,0xbe164083,0x3f7e9bc9,0x3f7cdf6c,0xbdd53db9,0xbe1f917b,0x3f7e70b0,0x3f7c7eb0,0xbde1bc2e,0xbe28defc,0x3f7e4323,0x3f7c187a,0xbdee3876,0xbe3228d4
.long 0x3f7e1324,0x3f7baccd,0xbdfab273,0xbe3b6ecf,0x3f7de0b1,0x3f7b3bab,0xbe039502,0xbe44b0b9,0x3f7dabcc,0x3f7ac516,0xbe09cf86,0xbe4dee60,0x3f7d7474,0x3f7a4910,0xbe1008b7,0xbe57278f
.long 0x3f7d3aac,0x3f79c79d,0xbe164083,0xbe605c13,0x3f7cfe73,0x3f7940c0,0xbe1c76de,0xbe698bba,0x3f7cbfc9,0x3f78b47b,0xbe22abb6,0xbe72b651,0x3f7c7eb0,0x3f7822d1,0xbe28defc,0xbe7bdba4
.long 0x3f7c3b28,0x3f778bc5,0xbe2f10a2,0xbe827dc0,0x3f7bf531,0x3f76ef5b,0xbe354098,0xbe870ada,0x3f7baccd,0x3f764d97,0xbe3b6ecf,0xbe8b9507,0x3f7b61fc,0x3f75a67b,0xbe419b37,0xbe901c2c
.long 0x3f800000,0x3f800000,0x80000000,0x80000000,0x3f7ff4e6,0x3f7ff0e3,0xbc96c9b6,0xbcafea69,0x3f7fd397,0x3f7fc38f,0xbd16c32c,0xbd2fe007,0x3f7f9c18,0x3f7f7808,0xbd621469,0xbd83db0a
.long 0x3f7f4e6d,0x3f7f0e58,0xbd96a905,0xbdafb680,0x3f7eea9d,0x3f7e868b,0xbdbc3ac3,0xbddb7d37,0x3f7e70b0,0x3f7de0b1,0xbde1bc2e,0xbe039502,0x3f7de0b1,0x3f7d1cdd,0xbe039502,0xbe195be0
.long 0x3f7d3aac,0x3f7c3b28,0xbe164083,0xbe2f10a2,0x3f7c7eb0,0x3f7b3bab,0xbe28defc,0xbe44b0b9,0x3f7baccd,0x3f7a1e84,0xbe3b6ecf,0xbe5a3997,0x3f7ac516,0x3f78e3d6,0xbe4dee60,0xbe6fa8b2
.long 0x3f79c79d,0x3f778bc5,0xbe605c13,0xbe827dc0,0x3f78b47b,0x3f76167a,0xbe72b651,0xbe8d17c0,0x3f778bc5,0x3f748422,0xbe827dc0,0xbe97a117,0x3f764d97,0x3f72d4eb,0xbe8b9507,0xbea21887
.long 0x3f74fa0b,0x3f710908,0xbe94a031,0xbeac7cd4,0x3f73913f,0x3f6f20b0,0xbe9d9e78,0xbeb6ccc3,0x3f721352,0x3f6d1c1d,0xbea68f12,0xbec1071e,0x3f708066,0x3f6afb8c,0xbeaf713a,0xbecb2aae
.long 0x3f6ed89e,0x3f68bf3c,0xbeb8442a,0xbed53641,0x3f6d1c1d,0x3f666771,0xbec1071e,0xbedf28a9,0x3f6b4b0c,0x3f63f473,0xbec9b953,0xbee900b7,0x3f696591,0x3f61668a,0xbed25a09,0xbef2bd43
.long 0x3f676bd8,0x3f5ebe05,0xbedae880,0xbefc5d27,0x3f655e0b,0x3f5bfb34,0xbee363fa,0xbf02ef9f,0x3f633c5a,0x3f591e6a,0xbeebcbbb,0xbf07a136,0x3f6106f2,0x3f5627fe,0xbef41f07,0xbf0c42c9
.long 0x3f5ebe05,0x3f531849,0xbefc5d27,0xbf10d3cd,0x3f5c61c7,0x3f4fefa8,0xbf0242b1,0xbf1553b7,0x3f59f26a,0x3f4cae79,0xbf064b82,0xbf19c200,0x3f577026,0x3f495521,0xbf0a48ad,0xbf1e1e22
.long 0x3f800000,0x3f800000,0x80000000,0x80000000,0x3f7fec43,0x3f7fe705,0xbcc90ab0,0xbce22a7a,0x3f7fb10f,0x3f7f9c18,0xbd48fb30,0xbd621469,0x3f7f4e6d,0x3f7f1f49,0xbd96a905,0xbda973ba
.long 0x3f7ec46d,0x3f7e70b0,0xbdc8bd36,0xbde1bc2e,0x3f7e1324,0x3f7d906e,0xbdfab273,0xbe0cec4a,0x3f7d3aac,0x3f7c7eb0,0xbe164083,0xbe28defc,0x3f7c3b28,0x3f7b3bab,0xbe2f10a2,0xbe44b0b9
.long 0x3f7b14be,0x3f79c79d,0xbe47c5c2,0xbe605c13,0x3f79c79d,0x3f7822d1,0xbe605c13,0xbe7bdba4,0x3f7853f8,0x3f764d97,0xbe78cfcc,0xbe8b9507,0x3f76ba07,0x3f74484b,0xbe888e93,0xbe9920fe
.long 0x3f74fa0b,0x3f721352,0xbe94a031,0xbea68f12,0x3f731447,0x3f6faf1b,0xbea09ae5,0xbeb3dca5,0x3f710908,0x3f6d1c1d,0xbeac7cd4,0xbec1071e,0x3f6ed89e,0x3f6a5ad9,0xbeb8442a,0xbece0bea
.long 0x3f6c835e,0x3f676bd8,0xbec3ef15,0xbedae880,0x3f6a09a7,0x3f644fac,0xbecf7bca,0xbee79a5d,0x3f676bd8,0x3f6106f2,0xbedae880,0xbef41f07,0x3f64aa59,0x3f5d924d,0xbee63375,0xbf003a06
.long 0x3f61c598,0x3f59f26a,0xbef15aea,0xbf064b82,0x3f5ebe05,0x3f5627fe,0xbefc5d27,0xbf0c42c9,0x3f5b941a,0x3f5233c6,0xbf039c3d,0xbf121eb0,0x3f584853,0x3f4e1689,0xbf08f59b,0xbf17de12
.long 0x3f54db31,0x3f49d112,0xbf0e39da,0xbf1d7fd1,0x3f514d3d,0x3f456439,0xbf13682a,0xbf2302d3,0x3f4d9f02,0x3f40d0da,0xbf187fc0,0xbf286605,0x3f49d112,0x3f3c17d9,0xbf1d7fd1,0xbf2da859
.long 0x3f45e403,0x3f373a23,0xbf226799,0xbf32c8c9,0x3f41d870,0x3f3238aa,0xbf273656,0xbf37c655,0x3f3daef9,0x3f2d1469,0xbf2beb4a,0xbf3ca003,0x3f396842,0x3f27ce61,0xbf3085bb,0xbf4154e1
.long 0x3f800000,0x3f800000,0x80000000,0x80000000,0x3f7fd397,0x3f7fcbe2,0xbd16c32c,0xbd2351cb,0x3f7f4e6d,0x3f7f2f9d,0xbd96a905,0xbda3308c,0x3f7e70b0,0x3f7e2b72,0xbde1bc2e,0xbdf475c0
.long 0x3f7d3aac,0x3f7cbfc9,0xbe164083,0xbe22abb6,0x3f7baccd,0x3f7aed37,0xbe3b6ecf,0xbe4ada4f,0x3f79c79d,0x3f78b47b,0xbe605c13,0xbe72b651,0x3f778bc5,0x3f76167a,0xbe827dc0,0xbe8d17c0
.long 0x3f74fa0b,0x3f731447,0xbe94a031,0xbea09ae5,0x3f721352,0x3f6faf1b,0xbea68f12,0xbeb3dca5,0x3f6ed89e,0x3f6be858,0xbeb8442a,0xbec6d529,0x3f6b4b0c,0x3f67c187,0xbec9b953,0xbed97cb9
.long 0x3f676bd8,0x3f633c5a,0xbedae880,0xbeebcbbb,0x3f633c5a,0x3f5e5aa6,0xbeebcbbb,0xbefdbabb,0x3f5ebe05,0x3f591e6a,0xbefc5d27,0xbf07a136,0x3f59f26a,0x3f5389c7,0xbf064b82,0xbf102dd5
.long 0x3f54db31,0x3f4d9f02,0xbf0e39da,0xbf187fc0,0x3f4f7a1f,0x3f476085,0xbf15f6d9,0xbf209393,0x3f49d112,0x3f40d0da,0xbf1d7fd1,0xbf286605,0x3f43e200,0x3f39f2ac,0xbf24d225,0xbf2ff3e6
.long 0x3f3daef9,0x3f32c8c9,0xbf2beb4a,0xbf373a23,0x3f373a23,0x3f2b561b,0xbf32c8c9,0xbf3e35c5,0x3f3085bb,0x3f239da9,0xbf396842,0xbf44e3f5,0x3f299415,0x3f1ba299,0xbf3fc767,0xbf4b41fa
.long 0x3f226799,0x3f13682a,0xbf45e403,0xbf514d3d,0x3f1b02c6,0x3f0af1b7,0xbf4bbbf8,0xbf570348,0x3f13682a,0x3f0242b1,0xbf514d3d,0xbf5c61c7,0x3f0b9a6b,0x3ef2bd43,0xbf5695e5,0xbf61668a
.long 0x3f039c3d,0x3ee0924f,0xbf5b941a,0xbf660f88,0x3ef6e0cb,0x3ece0bea,0xbf604621,0xbf6a5ad9,0x3ee63375,0x3ebb31a0,0xbf64aa59,0xbf6e46be,0x3ed53641,0x3ea80b1f,0xbf68bf3c,0xbf71d19f
.long 0x3f800000,0x3f800000,0x80000000,0x80000000,0x3f7fe129,0x3f7fdaaf,0xbcfb49ba,0xbd0a342f,0x3f7f84ab,0x3f7f6ac7,0xbd7b2b74,0xbd8a200a,0x3f7eea9d,0x3f7eb069,0xbdbc3ac3,0xbdcefdb7
.long 0x3f7e1324,0x3f7dabcc,0xbdfab273,0xbe09cf86,0x3f7cfe73,0x3f7c5d3a,0xbe1c76de,0xbe2bf804,0x3f7baccd,0x3f7ac516,0xbe3b6ecf,0xbe4dee60,0x3f7a1e84,0x3f78e3d6,0xbe5a3997,0xbe6fa8b2
.long 0x3f7853f8,0x3f76ba07,0xbe78cfcc,0xbe888e93,0x3f764d97,0x3f74484b,0xbe8b9507,0xbe9920fe,0x3f740bdd,0x3f718f57,0xbe9aa086,0xbea986c4,0x3f718f57,0x3f6e8ff8,0xbea986c4,0xbeb9bb1e
.long 0x3f6ed89e,0x3f6b4b0c,0xbeb8442a,0xbec9b953,0x3f6be858,0x3f67c187,0xbec6d529,0xbed97cb9,0x3f68bf3c,0x3f63f473,0xbed53641,0xbee900b7,0x3f655e0b,0x3f5fe4e9,0xbee363fa,0xbef840c8
.long 0x3f61c598,0x3f5b941a,0xbef15aea,0xbf039c3d,0x3f5df6be,0x3f570348,0xbeff17b2,0xbf0af1b7,0x3f59f26a,0x3f5233c6,0xbf064b82,0xbf121eb0,0x3f55b993,0x3f4d26fd,0xbf0cead0,0xbf19210f
.long 0x3f514d3d,0x3f47de65,0xbf13682a,0xbf1ff6cb,0x3f4cae79,0x3f425b89,0xbf19c200,0xbf269de3,0x3f47de65,0x3f3ca003,0xbf1ff6cb,0xbf2d1469,0x3f42de29,0x3f36ad7f,0xbf26050a,0xbf33587a
.long 0x3f3daef9,0x3f3085bb,0xbf2beb4a,0xbf396842,0x3f385216,0x3f2a2a80,0xbf31a81d,0xbf3f41fc,0x3f32c8c9,0x3f239da9,0xbf373a23,0xbf44e3f5,0x3f2d1469,0x3f1ce11f,0xbf3ca003,0xbf4a4c87
.long 0x3f273656,0x3f15f6d9,0xbf41d870,0xbf4f7a1f,0x3f212ff9,0x3f0ee0db,0xbf46e22a,0xbf546b3b,0x3f1b02c6,0x3f07a136,0xbf4bbbf8,0xbf591e6a,0x3f14b039,0x3f003a06,0xbf5064af,0xbf5d924d
.long 0x3f800000,0x3f800000,0x80000000,0x80000000,0x3f7fc38f,0x3f7fba9e,0xbd2fe007,0xbd3c6dd5,0x3f7f0e58,0x3f7eea9d,0xbdafb680,0xbdbc3ac3,0x3f7de0b1,0x3f7d906e,0xbe039502,0xbe0cec4a
.long 0x3f7c3b28,0x3f7baccd,0xbe2f10a2,0xbe3b6ecf,0x3f7a1e84,0x3f7940c0,0xbe5a3997,0xbe698bba,0x3f778bc5,0x3f764d97,0xbe827dc0,0xbe8b9507,0x3f748422,0x3f72d4eb,0xbe97a117,0xbea21887
.long 0x3f710908,0x3f6ed89e,0xbeac7cd4,0xbeb8442a,0x3f6d1c1d,0x3f6a5ad9,0xbec1071e,0xbece0bea,0x3f68bf3c,0x3f655e0b,0xbed53641,0xbee363fa,0x3f63f473,0x3f5fe4e9,0xbee900b7,0xbef840c8
.long 0x3f5ebe05,0x3f59f26a,0xbefc5d27,0xbf064b82,0x3f591e6a,0x3f5389c7,0xbf07a136,0xbf102dd5,0x3f531849,0x3f4cae79,0xbf10d3cd,0xbf19c200,0x3f4cae79,0x3f456439,0xbf19c200,0xbf2302d3
.long 0x3f45e403,0x3f3daef9,0xbf226799,0xbf2beb4a,0x3f3ebc1b,0x3f3592e7,0xbf2ac082,0xbf34768f,0x3f373a23,0x3f2d1469,0xbf32c8c9,0xbf3ca003,0x3f2f61a5,0x3f24381a,0xbf3a7ca4,0xbf446337
.long 0x3f273656,0x3f1b02c6,0xbf41d870,0xbf4bbbf8,0x3f1ebc12,0x3f11796b,0xbf48d8b3,0xbf52a649,0x3f15f6d9,0x3f07a136,0xbf4f7a1f,0xbf591e6a,0x3f0cead0,0x3efafef7,0xbf55b993,0xbf5f20db
.long 0x3f039c3d,0x3ee63375,0xbf5b941a,0xbf64aa59,0x3ef41f07,0x3ed0eb2a,0xbf6106f2,0xbf69b7e4,0x3ee0924f,0x3ebb31a0,0xbf660f88,0xbf6e46be,0x3ecc9b8b,0x3ea5129f,0xbf6aab7b,0xbf725470
.long 0x3eb8442a,0x3e8e9a22,0xbf6ed89e,0xbf75dec6,0x3ea395c5,0x3e6fa8b2,0xbf7294f8,0xbf78e3d6,0x3e8e9a22,0x3e419b37,0xbf75dec6,0xbf7b61fc,0x3e72b651,0x3e1324ca,0xbf78b47b,0xbf7d57de
.long 0x3f800000,0x3f800000,0x80000000,0x80000000,0x3f7fb10f,0x3f7fa6e3,0xbd48fb30,0xbd55880e,0x3f7ec46d,0x3f7e9bc9,0xbdc8bd36,0xbdd53db9,0x3f7d3aac,0x3f7cdf6c,0xbe164083,0xbe1f917b
.long 0x3f7b14be,0x3f7a7302,0xbe47c5c2,0xbe541501,0x3f7853f8,0x3f77583a,0xbe78cfcc,0xbe840270,0x3f74fa0b,0x3f73913f,0xbe94a031,0xbe9d9e78,0x3f710908,0x3f6f20b0,0xbeac7cd4,0xbeb6ccc3
.long 0x3f6c835e,0x3f6a09a7,0xbec3ef15,0xbecf7bca,0x3f676bd8,0x3f644fac,0xbedae880,0xbee79a5d,0x3f61c598,0x3f5df6be,0xbef15aea,0xbeff17b2,0x3f5b941a,0x3f570348,0xbf039c3d,0xbf0af1b7
.long 0x3f54db31,0x3f4f7a1f,0xbf0e39da,0xbf15f6d9,0x3f4d9f02,0x3f476085,0xbf187fc0,0xbf209393,0x3f45e403,0x3f3ebc1b,0xbf226799,0xbf2ac082,0x3f3daef9,0x3f3592e7,0xbf2beb4a,0xbf34768f
.long 0x3f3504f3,0x3f2beb4a,0xbf3504f3,0xbf3daef9,0x3f2beb4a,0x3f21cbfb,0xbf3daef9,0xbf466354,0x3f226799,0x3f173c07,0xbf45e403,0xbf4e8d90,0x3f187fc0,0x3f0c42c9,0xbf4d9f02,0xbf5627fe
.long 0x3f0e39da,0x3f00e7e4,0xbf54db31,0xbf5d2d53,0x3f039c3d,0x3eea6681,0xbf5b941a,0xbf6398ac,0x3ef15aea,0x3ed25a09,0xbf61c598,0xbf696591,0x3edae880,0x3eb9bb1e,0xbf676bd8,0xbf6e8ff8
.long 0x3ec3ef15,0x3ea09ae5,0xbf6c835e,0xbf731447,0x3eac7cd4,0x3e870ada,0xbf710908,0xbf76ef5b,0x3e94a031,0x3e5a3997,0xbf74fa0b,0xbf7a1e84,0x3e78cfcc,0x3e25c58c,0xbf7853f8,0xbf7c9f8a
.long 0x3e47c5c2,0x3de1bc2e,0xbf7b14be,0xbf7e70b0,0x3e164083,0x3d6ea038,0xbf7d3aac,0xbf7f90b1,0x3dc8bd36,0x3bc90f88,0xbf7ec46d,0xbf7ffec4,0x3d48fb30,0xbd3c6dd5,0xbf7fb10f,0xbf7fba9e
.long 0x3f800000,0x3f800000,0x80000000,0x80000000,0x3f7f84ab,0x3f7f7808,0xbd7b2b74,0xbd83db0a,0x3f7e1324,0x3f7de0b1,0xbdfab273,0xbe039502,0x3f7baccd,0x3f7b3bab,0xbe3b6ecf,0xbe44b0b9
.long 0x3f7853f8,0x3f778bc5,0xbe78cfcc,0xbe827dc0,0x3f740bdd,0x3f72d4eb,0xbe9aa086,0xbea21887,0x3f6ed89e,0x3f6d1c1d,0xbeb8442a,0xbec1071e,0x3f68bf3c,0x3f666771,0xbed53641,0xbedf28a9
.long 0x3f61c598,0x3f5ebe05,0xbef15aea,0xbefc5d27,0x3f59f26a,0x3f5627fe,0xbf064b82,0xbf0c42c9,0x3f514d3d,0x3f4cae79,0xbf13682a,0xbf19c200,0x3f47de65,0x3f425b89,0xbf1ff6cb,0xbf269de3
.long 0x3f3daef9,0x3f373a23,0xbf2beb4a,0xbf32c8c9,0x3f32c8c9,0x3f2b561b,0xbf373a23,0xbf3e35c5,0x3f273656,0x3f1ebc12,0xbf41d870,0xbf48d8b3,0x3f1b02c6,0x3f11796b,0xbf4bbbf8,0xbf52a649
.long 0x3f0e39da,0x3f039c3d,0xbf54db31,0xbf5b941a,0x3f00e7e4,0x3eea6681,0xbf5d2d53,0xbf6398ac,0x3ee63375,0x3ecc9b8b,0xbf64aa59,0xbf6aab7b,0x3ec9b953,0x3eadf73c,0xbf6b4b0c,0xbf70c501
.long 0x3eac7cd4,0x3e8e9a22,0xbf710908,0xbf75dec6,0x3e8e9a22,0x3e5d4b1a,0xbf75dec6,0xbf79f35e,0x3e605c13,0x3e1c76de,0xbf79c79d,0xbf7cfe73,0x3e22abb6,0x3db5f8da,0xbf7cbfc9,0xbf7efcc9
.long 0x3dc8bd36,0x3cc90ab0,0xbf7ec46d,0xbf7fec43,0x3d16c32c,0xbd2351cb,0xbf7fd397,0xbf7fcbe2,0xbcc90ab0,0xbdd53db9,0xbf7fec43,0xbf7e9bc9,0xbdafb680,0xbe2bf804,0xbf7f0e58,0xbf7c5d3a
.long 0xbe164083,0xbe6c9a7f,0xbf7d3aac,0xbf791298,0xbe541501,0xbe9620d2,0xbf7a7302,0xbf74bf62,0xbe888e93,0xbeb554ec,0xbf76ba07,0xbf6f6830,0xbea68f12,0xbed3c867,0xbf721352,0xbf6912ae
.long 0x3f800000,0x3f800000,0x80000000,0x80000000,0x3f7f9c18,0x3f7f90b1,0xbd621469,0xbd6ea038,0x3f7e70b0,0x3f7e4323,0xbde1bc2e,0xbdee3876,0x3f7c7eb0,0x3f7c187a,0xbe28defc,0xbe3228d4
.long 0x3f79c79d,0x3f791298,0xbe605c13,0xbe6c9a7f,0x3f764d97,0x3f75341d,0xbe8b9507,0xbe931f35,0x3f721352,0x3f708066,0xbea68f12,0xbeaf713a,0x3f6d1c1d,0x3f6afb8c,0xbec1071e,0xbecb2aae
.long 0x3f676bd8,0x3f64aa59,0xbedae880,0xbee63375,0x3f6106f2,0x3f5d924d,0xbef41f07,0xbf003a06,0x3f59f26a,0x3f55b993,0xbf064b82,0xbf0cead0,0x3f5233c6,0x3f4d26fd,0xbf121eb0,0xbf19210f
.long 0x3f49d112,0x3f43e200,0xbf1d7fd1,0xbf24d225,0x3f40d0da,0x3f39f2ac,0xbf286605,0xbf2ff3e6,0x3f373a23,0x3f2f61a5,0xbf32c8c9,0xbf3a7ca4,0x3f2d1469,0x3f24381a,0xbf3ca003,0xbf446337
.long 0x3f226799,0x3f187fc0,0xbf45e403,0xbf4d9f02,0x3f173c07,0x3f0c42c9,0xbf4e8d90,0xbf5627fe,0x3f0b9a6b,0x3eff17b2,0xbf5695e5,0xbf5df6be,0x3eff17b2,0x3ee4cbfe,0xbf5df6be,0xbf650479
.long 0x3ee63375,0x3ec9b953,0xbf64aa59,0xbf6b4b0c,0x3ecc9b8b,0x3eadf73c,0xbf6aab7b,0xbf70c501,0x3eb263ef,0x3e919ddd,0xbf6ff573,0xbf756d97,0x3e97a117,0x3e698bba,0xbf748422,0xbf7940c0
.long 0x3e78cfcc,0x3e2f10a2,0xbf7853f8,0xbf7c3b28,0x3e419b37,0x3de7fa9a,0xbf7b61fc,0xbf7e5a38,0x3e09cf86,0x3d621469,0xbf7dabcc,0xbf7f9c18,0x3da3308c,0xbb490fc6,0xbf7f2f9d,0xbf7fffb1
.long 0x3cc90ab0,0xbd7b2b74,0xbf7fec43,0xbf7f84ab,0xbcfb49ba,0xbdf475c0,0xbf7fe129,0xbf7e2b72,0xbdafb680,0xbe354098,0xbf7f0e58,0xbf7bf531,0xbe1008b7,0xbe6fa8b2,0xbf7d7474,0xbf78e3d6
.long 0x3f800000,0x3f800000,0x80000000,0x80000000,0x3f7f6ac7,0x3f7f5ce9,0xbd8a200a,0xbd9064b4,0x3f7dabcc,0x3f7d7474,0xbe09cf86,0xbe1008b7,0x3f7ac516,0x3f7a4910,0xbe4dee60,0xbe57278f
.long 0x3f76ba07,0x3f75dec6,0xbe888e93,0xbe8e9a22,0x3f718f57,0x3f703b37,0xbea986c4,0xbeb0eacb,0x3f6b4b0c,0x3f696591,0xbec9b953,0xbed25a09,0x3f63f473,0x3f61668a,0xbee900b7,0xbef2bd43
.long 0x3f5b941a,0x3f584853,0xbf039c3d,0xbf08f59b,0x3f5233c6,0x3f4e1689,0xbf121eb0,0xbf17de12,0x3f47de65,0x3f42de29,0xbf1ff6cb,0xbf26050a,0x3f3ca003,0x3f36ad7f,0xbf2d1469,0xbf33587a
.long 0x3f3085bb,0x3f299415,0xbf396842,0xbf3fc767,0x3f239da9,0x3f1ba299,0xbf44e3f5,0xbf4b41fa,0x3f15f6d9,0x3f0cead0,0xbf4f7a1f,0xbf55b993,0x3f07a136,0x3efafef7,0xbf591e6a,0xbf5f20db
.long 0x3ef15aea,0x3edae880,0xbf61c598,0xbf676bd8,0x3ed25a09,0x3eb9bb1e,0xbf696591,0xbf6e8ff8,0x3eb263ef,0x3e97a117,0xbf6ff573,0xbf748422,0x3e919ddd,0x3e698bba,0xbf756d97,0xbf7940c0
.long 0x3e605c13,0x3e22abb6,0xbf79c79d,0xbf7cbfc9,0x3e1c76de,0x3db5f8da,0xbf7cfe73,0xbf7efcc9,0x3dafb680,0x3c96c9b6,0xbf7f0e58,0xbf7ff4e6,0x3c96c9b6,0xbd55880e,0xbf7ff4e6,0xbf7fa6e3
.long 0xbd48fb30,0xbdfab273,0xbf7fb10f,0xbf7e1324,0xbdee3876,0xbe44b0b9,0xbf7e4323,0xbf7b3bab,0xbe3b6ecf,0xbe8586ce,0xbf7baccd,0xbf772417,0xbe7ee6e1,0xbea80b1f,0xbf77f110,0xbf71d19f
.long 0xbea09ae5,0xbec9b953,0xbf731447,0xbf6b4b0c,0xbec1071e,0xbeea6681,0xbf6d1c1d,0xbf6398ac,0xbee0924f,0xbf04f484,0xbf660f88,0xbf5ac450,0xbeff17b2,0xbf140c5f,0xbf5df6be,0xbf50d937
.long 0x3f800000,0x3f800000,0x80000000,0x80000000,0x3f7f4e6d,0x3f7f3f54,0xbd96a905,0xbd9cecf9,0x3f7d3aac,0x3f7cfe73,0xbe164083,0xbe1c76de,0x3f79c79d,0x3f7940c0,0xbe605c13,0xbe698bba
.long 0x3f74fa0b,0x3f740bdd,0xbe94a031,0xbe9aa086,0x3f6ed89e,0x3f6d67a1,0xbeb8442a,0xbebf926f,0x3f676bd8,0x3f655e0b,0xbedae880,0xbee363fa,0x3f5ebe05,0x3f5bfb34,0xbefc5d27,0xbf02ef9f
.long 0x3f54db31,0x3f514d3d,0xbf0e39da,0xbf13682a,0x3f49d112,0x3f456439,0xbf1d7fd1,0xbf2302d3,0x3f3daef9,0x3f385216,0xbf2beb4a,0xbf31a81d,0x3f3085bb,0x3f2a2a80,0xbf396842,0xbf3f41fc
.long 0x3f226799,0x3f1b02c6,0xbf45e403,0xbf4bbbf8,0x3f13682a,0x3f0af1b7,0xbf514d3d,0xbf570348,0x3f039c3d,0x3ef41f07,0xbf5b941a,0xbf6106f2,0x3ee63375,0x3ed0eb2a,0xbf64aa59,0xbf69b7e4
.long 0x3ec3ef15,0x3eac7cd4,0xbf6c835e,0xbf710908,0x3ea09ae5,0x3e870ada,0xbf731447,0xbf76ef5b,0x3e78cfcc,0x3e419b37,0xbf7853f8,0xbf7b61fc,0x3e2f10a2,0x3de7fa9a,0xbf7c3b28,0xbf7e5a38
.long 0x3dc8bd36,0x3d16c32c,0xbf7ec46d,0xbf7fd397,0x3cc90ab0,0xbd2351cb,0xbf7fec43,0xbf7fcbe2,0xbd48fb30,0xbdee3876,0xbf7fb10f,0xbf7e4323,0xbdfab273,0xbe44b0b9,0xbf7e1324,0xbf7b3bab
.long 0xbe47c5c2,0xbe888e93,0xbf7b14be,0xbf76ba07,0xbe888e93,0xbeadf73c,0xbf76ba07,0xbf70c501,0xbeac7cd4,0xbed25a09,0xbf710908,0xbf696591,0xbecf7bca,0xbef58035,0xbf6a09a7,0xbf60a6cf
.long 0xbef15aea,0xbf0b9a6b,0xbf61c598,0xbf5695e5,0xbf08f59b,0xbf1ba299,0xbf584853,0xbf4b41fa,0xbf187fc0,0xbf2ac082,0xbf4d9f02,0xbf3ebc1b,0xbf273656,0xbf38dd65,0xbf41d870,0xbf311722
.long 0x3f800000,0x3f800000,0x80000000,0x80000000,0x3f7f0e58,0x3f7efcc9,0xbdafb680,0xbdb5f8da,0x3f7c3b28,0x3f7bf531,0xbe2f10a2,0xbe354098,0x3f778bc5,0x3f76ef5b,0xbe827dc0,0xbe870ada
.long 0x3f710908,0x3f6ff573,0xbeac7cd4,0xbeb263ef,0x3f68bf3c,0x3f671599,0xbed53641,0xbedc53c1,0x3f5ebe05,0x3f5c61c7,0xbefc5d27,0xbf0242b1,0x3f531849,0x3f4fefa8,0xbf10d3cd,0xbf1553b7
.long 0x3f45e403,0x3f41d870,0xbf226799,0xbf273656,0x3f373a23,0x3f3238aa,0xbf32c8c9,0xbf37c655,0x3f273656,0x3f212ff9,0xbf41d870,0xbf46e22a,0x3f15f6d9,0x3f0ee0db,0xbf4f7a1f,0xbf546b3b
.long 0x3f039c3d,0x3ef6e0cb,0xbf5b941a,0xbf604621,0x3ee0924f,0x3ece0bea,0xbf660f88,0xbf6a5ad9,0x3eb8442a,0x3ea395c5,0xbf6ed89e,0xbf7294f8,0x3e8e9a22,0x3e6fa8b2,0xbf75dec6,0xbf78e3d6
.long 0x3e47c5c2,0x3e164083,0xbf7b14be,0xbf7d3aac,0x3de1bc2e,0x3d6ea038,0xbf7e70b0,0xbf7f90b1,0x3cc90ab0,0xbcfb49ba,0xbf7fec43,0xbf7fe129,0xbd7b2b74,0xbdf475c0,0xbf7f84ab,0xbf7e2b72
.long 0xbe164083,0xbe541501,0xbf7d3aac,0xbf7a7302,0xbe6c9a7f,0xbe9620d2,0xbf791298,0xbf74bf62,0xbea09ae5,0xbec1071e,0xbf731447,0xbf6d1c1d,0xbec9b953,0xbeea6681,0xbf6b4b0c,0xbf6398ac
.long 0xbef15aea,0xbf08f59b,0xbf61c598,0xbf584853,0xbf0b9a6b,0xbf1ba299,0xbf5695e5,0xbf4b41fa,0xbf1d7fd1,0xbf2d1469,0xbf49d112,0xbf3ca003,0xbf2e3bde,0xbf3d27b8,0xbf3b8f3b,0xbf2c800f
.long 0xbf3daef9,0xbf4bbbf8,0xbf2beb4a,0xbf1b02c6,0xbf4bbbf8,0xbf58b3a1,0xbf1b02c6,0xbf084b92,0xbf584853,0xbf63f473,0xbf08f59b,0xbee900b7,0xbf633c5a,0xbf6d67a1,0xbeebcbbb,0xbebf926f
.long 0x3f800000,0x3f800000,0x80000000,0x80000000,0x3f7f2f9d,0x3f7f1f49,0xbda3308c,0xbda973ba,0x3f7cbfc9,0x3f7c7eb0,0xbe22abb6,0xbe28defc,0x3f78b47b,0x3f7822d1,0xbe72b651,0xbe7bdba4
.long 0x3f731447,0x3f721352,0xbea09ae5,0xbea68f12,0x3f6be858,0x3f6a5ad9,0xbec6d529,0xbece0bea,0x3f633c5a,0x3f6106f2,0xbeebcbbb,0xbef41f07,0x3f591e6a,0x3f5627fe,0xbf07a136,0xbf0c42c9
.long 0x3f4d9f02,0x3f49d112,0xbf187fc0,0xbf1d7fd1,0x3f40d0da,0x3f3c17d9,0xbf286605,0xbf2da859,0x3f32c8c9,0x3f2d1469,0xbf373a23,0xbf3ca003,0x3f239da9,0x3f1ce11f,0xbf44e3f5,0xbf4a4c87
.long 0x3f13682a,0x3f0b9a6b,0xbf514d3d,0xbf5695e5,0x3f0242b1,0x3ef2bd43,0xbf5c61c7,0xbf61668a,0x3ee0924f,0x3ecc9b8b,0xbf660f88,0xbf6aab7b,0x3ebb31a0,0x3ea5129f,0xbf6e46be,0xbf725470
.long 0x3e94a031,0x3e78cfcc,0xbf74fa0b,0xbf7853f8,0x3e5a3997,0x3e25c58c,0xbf7a1e84,0xbf7c9f8a,0x3e09cf86,0x3da3308c,0xbf7dabcc,0xbf7f2f9d,0x3d621469,0xbb490fc6,0xbf7f9c18,0xbf7fffb1
.long 0xbcc90ab0,0xbdafb680,0xbf7fec43,0xbf7f0e58,0xbdd53db9,0xbe2bf804,0xbf7e9bc9,0xbf7c5d3a,0xbe3b6ecf,0xbe7ee6e1,0xbf7baccd,0xbf77f110,0xbe8586ce,0xbea80b1f,0xbf772417,0xbf71d19f
.long 0xbeac7cd4,0xbecf7bca,0xbf710908,0xbf6a09a7,0xbed25a09,0xbef58035,0xbf696591,0xbf60a6cf,0xbef6e0cb,0xbf0cead0,0xbf604621,0xbf55b993,0xbf0cead0,0xbf1e1e22,0xbf55b993,0xbf495521
.long 0xbf1d7fd1,0xbf2e3bde,0xbf49d112,0xbf3b8f3b,0xbf2d1469,0xbf3d27b8,0xbf3ca003,0xbf2c800f,0xbf3b8f3b,0xbf4ac77f,0xbf2e3bde,0xbf1c420c,0xbf48d8b3,0xbf570348,0xbf1ebc12,0xbf0af1b7
.long 0x3f800000,0x3f800000,0x80000000,0x80000000,0x3f7eea9d,0x3f7ed7d4,0xbdbc3ac3,0xbdc27c39,0x3f7baccd,0x3f7b61fc,0xbe3b6ecf,0xbe419b37,0x3f764d97,0x3f75a67b,0xbe8b9507,0xbe901c2c
.long 0x3f6ed89e,0x3f6db293,0xbeb8442a,0xbebe1d4a,0x3f655e0b,0x3f6398ac,0xbee363fa,0xbeea6681,0x3f59f26a,0x3f577026,0xbf064b82,0xbf0a48ad,0x3f4cae79,0x3f495521,0xbf19c200,0xbf1e1e22
.long 0x3f3daef9,0x3f396842,0xbf2beb4a,0xbf3085bb,0x3f2d1469,0x3f27ce61,0xbf3ca003,0xbf4154e1,0x3f1b02c6,0x3f14b039,0xbf4bbbf8,0xbf5064af,0x3f07a136,0x3f003a06,0xbf591e6a,0xbf5d924d
.long 0x3ee63375,0x3ed53641,0xbf64aa59,0xbf68bf3c,0x3ebb31a0,0x3ea80b1f,0xbf6e46be,0xbf71d19f,0x3e8e9a22,0x3e72b651,0xbf75dec6,0xbf78b47b,0x3e419b37,0x3e1324ca,0xbf7b61fc,0xbf7d57de
.long 0x3dc8bd36,0x3d48fb30,0xbf7ec46d,0xbf7fb10f,0x3bc90f88,0xbd3c6dd5,0xbf7ffec4,0xbf7fba9e,0xbdafb680,0xbe1008b7,0xbf7f0e58,0xbf7d7474,0xbe354098,0xbe6fa8b2,0xbf7bf531,0xbf78e3d6
.long 0xbe888e93,0xbea68f12,0xbf76ba07,0xbf721352,0xbeb554ec,0xbed3c867,0xbf6f6830,0xbf6912ae,0xbee0924f,0xbeff17b2,0xbf660f88,0xbf5df6be,0xbf04f484,0xbf140c5f,0xbf5ac450,0xbf50d937
.long 0xbf187fc0,0xbf273656,0xbf4d9f02,0xbf41d870,0xbf2ac082,0xbf38dd65,0xbf3ebc1b,0xbf311722,0xbf3b8f3b,0xbf48d8b3,0xbf2e3bde,0xbf1ebc12,0xbf4ac77f,0xbf570348,0xbf1c420c,0xbf0af1b7
.long 0xbf584853,0xbf633c5a,0xbf08f59b,0xbeebcbbb,0xbf63f473,0xbf6d67a1,0xbee900b7,0xbebf926f,0xbf6db293,0xbf756d97,0xbebe1d4a,0xbe919ddd,0xbf756d97,0xbf7b3bab,0xbe919ddd,0xbe44b0b9
.long 0x3f800000,0x3f7ec46d,0x80000000,0xbdc8bd36,0x3f800000,0x3f7eb069,0x80000000,0xbdcefdb7,0x3f800000,0x3f7e9bc9,0x80000000,0xbdd53db9,0x3f800000,0x3f7e868b,0x80000000,0xbddb7d37
.long 0x3f800000,0x3f7e70b0,0x80000000,0xbde1bc2e,0x3f800000,0x3f7e5a38,0x80000000,0xbde7fa9a,0x3f800000,0x3f7e4323,0x80000000,0xbdee3876,0x3f800000,0x3f7e2b72,0x80000000,0xbdf475c0
.long 0x3f800000,0x3f7e1324,0x80000000,0xbdfab273,0x3f800000,0x3f7dfa38,0x80000000,0xbe007745,0x3f800000,0x3f7de0b1,0x80000000,0xbe039502,0x3f800000,0x3f7dc68c,0x80000000,0xbe06b26e
.long 0x3f800000,0x3f7dabcc,0x80000000,0xbe09cf86,0x3f800000,0x3f7d906e,0x80000000,0xbe0cec4a,0x3f800000,0x3f7d7474,0x80000000,0xbe1008b7,0x3f800000,0x3f7d57de,0x80000000,0xbe1324ca
.long 0x3f800000,0x3f7d3aac,0x80000000,0xbe164083,0x3f800000,0x3f7d1cdd,0x80000000,0xbe195be0,0x3f800000,0x3f7cfe73,0x80000000,0xbe1c76de,0x3f800000,0x3f7cdf6c,0x80000000,0xbe1f917b
.long 0x3f800000,0x3f7cbfc9,0x80000000,0xbe22abb6,0x3f800000,0x3f7c9f8a,0x80000000,0xbe25c58c,0x3f800000,0x3f7c7eb0,0x80000000,0xbe28defc,0x3f800000,0x3f7c5d3a,0x80000000,0xbe2bf804
.long 0x3f800000,0x3f7c3b28,0x80000000,0xbe2f10a2,0x3f800000,0x3f7c187a,0x80000000,0xbe3228d4,0x3f800000,0x3f7bf531,0x80000000,0xbe354098,0x3f800000,0x3f7bd14d,0x80000000,0xbe3857ec
.long 0x3f800000,0x3f7baccd,0x80000000,0xbe3b6ecf,0x3f800000,0x3f7b87b2,0x80000000,0xbe3e853e,0x3f800000,0x3f7b61fc,0x80000000,0xbe419b37,0x3f800000,0x3f7b3bab,0x80000000,0xbe44b0b9
.long 0x3f6c835e,0x3f61c598,0xbec3ef15,0xbef15aea,0x3f6b4b0c,0x3f5fe4e9,0xbec9b953,0xbef840c8,0x3f6a09a7,0x3f5df6be,0xbecf7bca,0xbeff17b2,0x3f68bf3c,0x3f5bfb34,0xbed53641,0xbf02ef9f
.long 0x3f676bd8,0x3f59f26a,0xbedae880,0xbf064b82,0x3f660f88,0x3f57dc7f,0xbee0924f,0xbf099f4e,0x3f64aa59,0x3f55b993,0xbee63375,0xbf0cead0,0x3f633c5a,0x3f5389c7,0xbeebcbbb,0xbf102dd5
.long 0x3f61c598,0x3f514d3d,0xbef15aea,0xbf13682a,0x3f604621,0x3f4f0417,0xbef6e0cb,0xbf16999f,0x3f5ebe05,0x3f4cae79,0xbefc5d27,0xbf19c200,0x3f5d2d53,0x3f4a4c87,0xbf00e7e4,0xbf1ce11f
.long 0x3f5b941a,0x3f47de65,0xbf039c3d,0xbf1ff6cb,0x3f59f26a,0x3f456439,0xbf064b82,0xbf2302d3,0x3f584853,0x3f42de29,0xbf08f59b,0xbf26050a,0x3f5695e5,0x3f404c5c,0xbf0b9a6b,0xbf28fd41
.long 0x3f54db31,0x3f3daef9,0xbf0e39da,0xbf2beb4a,0x3f531849,0x3f3b0629,0xbf10d3cd,0xbf2ecef7,0x3f514d3d,0x3f385216,0xbf13682a,0xbf31a81d,0x3f4f7a1f,0x3f3592e7,0xbf15f6d9,0xbf34768f
.long 0x3f4d9f02,0x3f32c8c9,0xbf187fc0,0xbf373a23,0x3f4bbbf8,0x3f2ff3e6,0xbf1b02c6,0xbf39f2ac,0x3f49d112,0x3f2d1469,0xbf1d7fd1,0xbf3ca003,0x3f47de65,0x3f2a2a80,0xbf1ff6cb,0xbf3f41fc
.long 0x3f45e403,0x3f273656,0xbf226799,0xbf41d870,0x3f43e200,0x3f24381a,0xbf24d225,0xbf446337,0x3f41d870,0x3f212ff9,0xbf273656,0xbf46e22a,0x3f3fc767,0x3f1e1e22,0xbf299415,0xbf495521
.long 0x3f3daef9,0x3f1b02c6,0xbf2beb4a,0xbf4bbbf8,0x3f3b8f3b,0x3f17de12,0xbf2e3bde,0xbf4e1689,0x3f396842,0x3f14b039,0xbf3085bb,0xbf5064af,0x3f373a23,0x3f11796b,0xbf32c8c9,0xbf52a649
.long 0x3f7b14be,0x3f74fa0b,0xbe47c5c2,0xbe94a031,0x3f7ac516,0x3f74484b,0xbe4dee60,0xbe9920fe,0x3f7a7302,0x3f73913f,0xbe541501,0xbe9d9e78,0x3f7a1e84,0x3f72d4eb,0xbe5a3997,0xbea21887
.long 0x3f79c79d,0x3f721352,0xbe605c13,0xbea68f12,0x3f796e4e,0x3f714c7a,0xbe667c66,0xbeab0201,0x3f791298,0x3f708066,0xbe6c9a7f,0xbeaf713a,0x3f78b47b,0x3f6faf1b,0xbe72b651,0xbeb3dca5
.long 0x3f7853f8,0x3f6ed89e,0xbe78cfcc,0xbeb8442a,0x3f77f110,0x3f6dfcf2,0xbe7ee6e1,0xbebca7af,0x3f778bc5,0x3f6d1c1d,0xbe827dc0,0xbec1071e,0x3f772417,0x3f6c3624,0xbe8586ce,0xbec5625c
.long 0x3f76ba07,0x3f6b4b0c,0xbe888e93,0xbec9b953,0x3f764d97,0x3f6a5ad9,0xbe8b9507,0xbece0bea,0x3f75dec6,0x3f696591,0xbe8e9a22,0xbed25a09,0x3f756d97,0x3f686b39,0xbe919ddd,0xbed6a399
.long 0x3f74fa0b,0x3f676bd8,0xbe94a031,0xbedae880,0x3f748422,0x3f666771,0xbe97a117,0xbedf28a9,0x3f740bdd,0x3f655e0b,0xbe9aa086,0xbee363fa,0x3f73913f,0x3f644fac,0xbe9d9e78,0xbee79a5d
.long 0x3f731447,0x3f633c5a,0xbea09ae5,0xbeebcbbb,0x3f7294f8,0x3f62241a,0xbea395c5,0xbeeff7fb,0x3f721352,0x3f6106f2,0xbea68f12,0xbef41f07,0x3f718f57,0x3f5fe4e9,0xbea986c4,0xbef840c8
.long 0x3f710908,0x3f5ebe05,0xbeac7cd4,0xbefc5d27,0x3f708066,0x3f5d924d,0xbeaf713a,0xbf003a06,0x3f6ff573,0x3f5c61c7,0xbeb263ef,0xbf0242b1,0x3f6f6830,0x3f5b2c79,0xbeb554ec,0xbf044889
.long 0x3f6ed89e,0x3f59f26a,0xbeb8442a,0xbf064b82,0x3f6e46be,0x3f58b3a1,0xbebb31a0,0xbf084b92,0x3f6db293,0x3f577026,0xbebe1d4a,0xbf0a48ad,0x3f6d1c1d,0x3f5627fe,0xbec1071e,0xbf0c42c9
.long 0x3f54db31,0x3f45e403,0xbf0e39da,0xbf226799,0x3f5233c6,0x3f425b89,0xbf121eb0,0xbf269de3,0x3f4f7a1f,0x3f3ebc1b,0xbf15f6d9,0xbf2ac082,0x3f4cae79,0x3f3b0629,0xbf19c200,0xbf2ecef7
.long 0x3f49d112,0x3f373a23,0xbf1d7fd1,0xbf32c8c9,0x3f46e22a,0x3f33587a,0xbf212ff9,0xbf36ad7f,0x3f43e200,0x3f2f61a5,0xbf24d225,0xbf3a7ca4,0x3f40d0da,0x3f2b561b,0xbf286605,0xbf3e35c5
.long 0x3f3daef9,0x3f273656,0xbf2beb4a,0xbf41d870,0x3f3a7ca4,0x3f2302d3,0xbf2f61a5,0xbf456439,0x3f373a23,0x3f1ebc12,0xbf32c8c9,0xbf48d8b3,0x3f33e7bc,0x3f1a6293,0xbf36206c,0xbf4c3578
.long 0x3f3085bb,0x3f15f6d9,0xbf396842,0xbf4f7a1f,0x3f2d1469,0x3f11796b,0xbf3ca003,0xbf52a649,0x3f299415,0x3f0cead0,0xbf3fc767,0xbf55b993,0x3f26050a,0x3f084b92,0xbf42de29,0xbf58b3a1
.long 0x3f226799,0x3f039c3d,0xbf45e403,0xbf5b941a,0x3f1ebc12,0x3efdbabb,0xbf48d8b3,0xbf5e5aa6,0x3f1b02c6,0x3ef41f07,0xbf4bbbf8,0xbf6106f2,0x3f173c07,0x3eea6681,0xbf4e8d90,0xbf6398ac
.long 0x3f13682a,0x3ee0924f,0xbf514d3d,0xbf660f88,0x3f0f8784,0x3ed6a399,0xbf53fac3,0xbf686b39,0x3f0b9a6b,0x3ecc9b8b,0xbf5695e5,0xbf6aab7b,0x3f07a136,0x3ec27b55,0xbf591e6a,0xbf6cd007
.long 0x3f039c3d,0x3eb8442a,0xbf5b941a,0xbf6ed89e,0x3eff17b2,0x3eadf73c,0xbf5df6be,0xbf70c501,0x3ef6e0cb,0x3ea395c5,0xbf604621,0xbf7294f8,0x3eee9479,0x3e9920fe,0xbf628210,0xbf74484b
.long 0x3ee63375,0x3e8e9a22,0xbf64aa59,0xbf75dec6,0x3eddbe79,0x3e840270,0xbf66becc,0xbf77583a,0x3ed53641,0x3e72b651,0xbf68bf3c,0xbf78b47b,0x3ecc9b8b,0x3e5d4b1a,0xbf6aab7b,0xbf79f35e
.long 0x3f3504f3,0x3f226799,0xbf3504f3,0xbf45e403,0x3f3085bb,0x3f1ce11f,0xbf396842,0xbf4a4c87,0x3f2beb4a,0x3f173c07,0xbf3daef9,0xbf4e8d90,0x3f273656,0x3f11796b,0xbf41d870,0xbf52a649
.long 0x3f226799,0x3f0b9a6b,0xbf45e403,0xbf5695e5,0x3f1d7fd1,0x3f05a02c,0xbf49d112,0xbf5a5ba0,0x3f187fc0,0x3eff17b2,0xbf4d9f02,0xbf5df6be,0x3f13682a,0x3ef2bd43,0xbf514d3d,0xbf61668a
.long 0x3f0e39da,0x3ee63375,0xbf54db31,0xbf64aa59,0x3f08f59b,0x3ed97cb9,0xbf584853,0xbf67c187,0x3f039c3d,0x3ecc9b8b,0xbf5b941a,0xbf6aab7b,0x3efc5d27,0x3ebf926f,0xbf5ebe05,0xbf6d67a1
.long 0x3ef15aea,0x3eb263ef,0xbf61c598,0xbf6ff573,0x3ee63375,0x3ea5129f,0xbf64aa59,0xbf725470,0x3edae880,0x3e97a117,0xbf676bd8,0xbf748422,0x3ecf7bca,0x3e8a11f7,0xbf6a09a7,0xbf76841b
.long 0x3ec3ef15,0x3e78cfcc,0xbf6c835e,0xbf7853f8,0x3eb8442a,0x3e5d4b1a,0xbf6ed89e,0xbf79f35e,0x3eac7cd4,0x3e419b37,0xbf710908,0xbf7b61fc,0x3ea09ae5,0x3e25c58c,0xbf731447,0xbf7c9f8a
.long 0x3e94a031,0x3e09cf86,0xbf74fa0b,0xbf7dabcc,0x3e888e93,0x3ddb7d37,0xbf76ba07,0xbf7e868b,0x3e78cfcc,0x3da3308c,0xbf7853f8,0xbf7f2f9d,0x3e605c13,0x3d55880e,0xbf79c79d,0xbf7fa6e3
.long 0x3e47c5c2,0x3cc90ab0,0xbf7b14be,0xbf7fec43,0x3e2f10a2,0xbb490fc6,0xbf7c3b28,0xbf7fffb1,0x3e164083,0xbcfb49ba,0xbf7d3aac,0xbf7fe129,0x3dfab273,0xbd6ea038,0xbf7e1324,0xbf7f90b1
.long 0x3dc8bd36,0xbdafb680,0xbf7ec46d,0xbf7f0e58,0x3d96a905,0xbde7fa9a,0xbf7f4e6d,0xbf7e5a38,0x3d48fb30,0xbe1008b7,0xbf7fb10f,0xbf7d7474,0x3cc90ab0,0xbe2bf804,0xbf7fec43,0xbf7c5d3a
.long 0x3ec3ef15,0x3e94a031,0xbf6c835e,0xbf74fa0b,0x3eb263ef,0x3e80f8c0,0xbf6ff573,0xbf77beb7,0x3ea09ae5,0x3e5a3997,0xbf731447,0xbf7a1e84,0x3e8e9a22,0x3e3228d4,0xbf75dec6,0xbf7c187a
.long 0x3e78cfcc,0x3e09cf86,0xbf7853f8,0xbf7dabcc,0x3e541501,0x3dc27c39,0xbf7a7302,0xbf7ed7d4,0x3e2f10a2,0x3d621469,0xbf7c3b28,0xbf7f9c18,0x3e09cf86,0x3c7b514b,0xbf7dabcc,0xbf7ff84a
.long 0x3dc8bd36,0xbcc90ab0,0xbf7ec46d,0xbf7fec43,0x3d7b2b74,0xbd83db0a,0xbf7f84ab,0xbf7f7808,0x3cc90ab0,0xbdd53db9,0xbf7fec43,0xbf7e9bc9,0xbc490e90,0xbe1324ca,0xbf7ffb11,0xbf7d57de
.long 0xbd48fb30,0xbe3b6ecf,0xbf7fb10f,0xbf7baccd,0xbdafb680,0xbe636c83,0xbf7f0e58,0xbf799b43,0xbdfab273,0xbe8586ce,0xbf7e1324,0xbf772417,0xbe22abb6,0xbe9920fe,0xbf7cbfc9,0xbf74484b
.long 0xbe47c5c2,0xbeac7cd4,0xbf7b14be,0xbf710908,0xbe6c9a7f,0xbebf926f,0xbf791298,0xbf6d67a1,0xbe888e93,0xbed25a09,0xbf76ba07,0xbf696591,0xbe9aa086,0xbee4cbfe,0xbf740bdd,0xbf650479
.long 0xbeac7cd4,0xbef6e0cb,0xbf710908,0xbf604621,0xbebe1d4a,0xbf044889,0xbf6db293,0xbf5b2c79,0xbecf7bca,0xbf0cead0,0xbf6a09a7,0xbf55b993,0xbee0924f,0xbf1553b7,0xbf660f88,0xbf4fefa8
.long 0xbef15aea,0xbf1d7fd1,0xbf61c598,0xbf49d112,0xbf00e7e4,0xbf256bcb,0xbf5d2d53,0xbf436051,0xbf08f59b,0xbf2d1469,0xbf584853,0xbf3ca003,0xbf10d3cd,0xbf34768f,0xbf531849,0xbf3592e7
.long 0xbf187fc0,0xbf3b8f3b,0xbf4d9f02,0xbf2e3bde,0xbf1ff6cb,0xbf425b89,0xbf47de65,0xbf269de3,0xbf273656,0xbf48d8b3,0xbf41d870,0xbf1ebc12,0xbf2e3bde,0xbf4f0417,0xbf3b8f3b,0xbf16999f
.long 0x3f0e39da,0x3ef15aea,0xbf54db31,0xbf61c598,0x3f07a136,0x3ee1fb6a,0xbf591e6a,0xbf65b710,0x3f00e7e4,0x3ed25a09,0xbf5d2d53,0xbf696591,0x3ef41f07,0x3ec27b55,0xbf6106f2,0xbf6cd007
.long 0x3ee63375,0x3eb263ef,0xbf64aa59,0xbf6ff573,0x3ed8106b,0x3ea21887,0xbf6816a8,0xbf72d4eb,0x3ec9b953,0x3e919ddd,0xbf6b4b0c,0xbf756d97,0x3ebb31a0,0x3e80f8c0,0xbf6e46be,0xbf77beb7
.long 0x3eac7cd4,0x3e605c13,0xbf710908,0xbf79c79d,0x3e9d9e78,0x3e3e853e,0xbf73913f,0xbf7b87b2,0x3e8e9a22,0x3e1c76de,0xbf75dec6,0xbf7cfe73,0x3e7ee6e1,0x3df475c0,0xbf77f110,0xbf7e2b72
.long 0x3e605c13,0x3dafb680,0xbf79c79d,0xbf7f0e58,0x3e419b37,0x3d55880e,0xbf7b61fc,0xbf7fa6e3,0x3e22abb6,0x3c96c9b6,0xbf7cbfc9,0xbf7ff4e6,0x3e039502,0xbc7b514b,0xbf7de0b1,0xbf7ff84a
.long 0x3dc8bd36,0xbd48fb30,0xbf7ec46d,0xbf7fb10f,0x3d8a200a,0xbda973ba,0xbf7f6ac7,0xbf7f1f49,0x3d16c32c,0xbdee3876,0xbf7fd397,0xbf7e4323,0x3bc90f88,0xbe195be0,0xbf7ffec4,0xbf7d1cdd
.long 0xbcc90ab0,0xbe3b6ecf,0xbf7fec43,0xbf7baccd,0xbd621469,0xbe5d4b1a,0xbf7f9c18,0xbf79f35e,0xbdafb680,0xbe7ee6e1,0xbf7f0e58,0xbf77f110,0xbdee3876,0xbe901c2c,0xbf7e4323,0xbf75a67b
.long 0xbe164083,0xbea09ae5,0xbf7d3aac,0xbf731447,0xbe354098,0xbeb0eacb,0xbf7bf531,0xbf703b37,0xbe541501,0xbec1071e,0xbf7a7302,0xbf6d1c1d,0xbe72b651,0xbed0eb2a,0xbf78b47b,0xbf69b7e4
.long 0xbe888e93,0xbee0924f,0xbf76ba07,0xbf660f88,0xbe97a117,0xbeeff7fb,0xbf748422,0xbf62241a,0xbea68f12,0xbeff17b2,0xbf721352,0xbf5df6be,0xbeb554ec,0xbf06f686,0xbf6f6830,0xbf5988ad
.long 0x3e47c5c2,0x3dc8bd36,0xbf7b14be,0xbf7ec46d,0x3e1c76de,0x3d55880e,0xbf7cfe73,0xbf7fa6e3,0x3de1bc2e,0x3bc90f88,0xbf7e70b0,0xbf7ffec4,0x3d8a200a,0xbd2351cb,0xbf7f6ac7,0xbf7fcbe2
.long 0x3cc90ab0,0xbdafb680,0xbf7fec43,0xbf7f0e58,0xbc96c9b6,0xbe06b26e,0xbf7ff4e6,0xbf7dc68c,0xbd7b2b74,0xbe354098,0xbf7f84ab,0xbf7bf531,0xbdd53db9,0xbe636c83,0xbf7e9bc9,0xbf799b43
.long 0xbe164083,0xbe888e93,0xbf7d3aac,0xbf76ba07,0xbe419b37,0xbe9f1cdf,0xbf7b61fc,0xbf73530e,0xbe6c9a7f,0xbeb554ec,0xbf791298,0xbf6f6830,0xbe8b9507,0xbecb2aae,0xbf764d97,0xbf6afb8c
.long 0xbea09ae5,0xbee0924f,0xbf731447,0xbf660f88,0xbeb554ec,0xbef58035,0xbf6f6830,0xbf60a6cf,0xbec9b953,0xbf04f484,0xbf6b4b0c,0xbf5ac450,0xbeddbe79,0xbf0ee0db,0xbf66becc,0xbf546b3b
.long 0xbef15aea,0xbf187fc0,0xbf61c598,0xbf4d9f02,0xbf0242b1,0xbf21cbfb,0xbf5c61c7,0xbf466354,0xbf0b9a6b,0xbf2ac082,0xbf5695e5,0xbf3ebc1b,0xbf14b039,0xbf33587a,0xbf5064af,0xbf36ad7f
.long 0xbf1d7fd1,0xbf3b8f3b,0xbf49d112,0xbf2e3bde,0xbf26050a,0xbf436051,0xbf42de29,0xbf256bcb,0xbf2e3bde,0xbf4ac77f,0xbf3b8f3b,0xbf1c420c,0xbf36206c,0xbf51c0c2,0xbf33e7bc,0xbf12c39a
.long 0xbf3daef9,0xbf584853,0xbf2beb4a,0xbf08f59b,0xbf44e3f5,0xbf5e5aa6,0xbf239da9,0xbefdbabb,0xbf4bbbf8,0xbf63f473,0xbf1b02c6,0xbee900b7,0xbf5233c6,0xbf6912ae,0xbf121eb0,0xbed3c867
.long 0xbf584853,0xbf6db293,0xbf08f59b,0xbebe1d4a,0xbf5df6be,0xbf71d19f,0xbeff17b2,0xbea80b1f,0xbf633c5a,0xbf756d97,0xbeebcbbb,0xbe919ddd,0xbf6816a8,0xbf788486,0xbed8106b,0xbe75c35a
.long 0x248d3132,0xbdc8bd36,0xbf800000,0xbf7ec46d,0xbd48fb30,0xbe195be0,0xbf7fb10f,0xbf7d1cdd,0xbdc8bd36,0xbe4dee60,0xbf7ec46d,0xbf7ac516,0xbe164083,0xbe80f8c0,0xbf7d3aac,0xbf77beb7
.long 0xbe47c5c2,0xbe9aa086,0xbf7b14be,0xbf740bdd,0xbe78cfcc,0xbeb3dca5,0xbf7853f8,0xbf6faf1b,0xbe94a031,0xbecc9b8b,0xbf74fa0b,0xbf6aab7b,0xbeac7cd4,0xbee4cbfe,0xbf710908,0xbf650479
.long 0xbec3ef15,0xbefc5d27,0xbf6c835e,0xbf5ebe05,0xbedae880,0xbf099f4e,0xbf676bd8,0xbf57dc7f,0xbef15aea,0xbf14b039,0xbf61c598,0xbf5064af,0xbf039c3d,0xbf1f599f,0xbf5b941a,0xbf485bca
.long 0xbf0e39da,0xbf299415,0xbf54db31,0xbf3fc767,0xbf187fc0,0xbf33587a,0xbf4d9f02,0xbf36ad7f,0xbf226799,0xbf3ca003,0xbf45e403,0xbf2d1469,0xbf2beb4a,0xbf456439,0xbf3daef9,0xbf2302d3
.long 0xbf3504f3,0xbf4d9f02,0xbf3504f3,0xbf187fc0,0xbf3daef9,0xbf554aa4,0xbf2beb4a,0xbf0d9281,0xbf45e403,0xbf5c61c7,0xbf226799,0xbf0242b1,0xbf4d9f02,0xbf62df7b,0xbf187fc0,0xbeed3063
.long 0xbf54db31,0xbf68bf3c,0xbf0e39da,0xbed53641,0xbf5b941a,0xbf6dfcf2,0xbf039c3d,0xbebca7af,0xbf61c598,0xbf7294f8,0xbef15aea,0xbea395c5,0xbf676bd8,0xbf76841b,0xbedae880,0xbe8a11f7
.long 0xbf6c835e,0xbf79c79d,0xbec3ef15,0xbe605c13,0xbf710908,0xbf7c5d3a,0xbeac7cd4,0xbe2bf804,0xbf74fa0b,0xbf7e4323,0xbe94a031,0xbdee3876,0xbf7853f8,0xbf7f7808,0xbe78cfcc,0xbd83db0a
.long 0xbf7b14be,0xbf7ffb11,0xbe47c5c2,0xbc490e90,0xbf7d3aac,0xbf7fcbe2,0xbe164083,0x3d2351cb,0xbf7ec46d,0xbf7eea9d,0xbdc8bd36,0x3dbc3ac3,0xbf7fb10f,0xbf7d57de,0xbd48fb30,0x3e1324ca
.long 0xbec3ef15,0xbef15aea,0xbf6c835e,0xbf61c598,0xbee0924f,0xbf06f686,0xbf660f88,0xbf5988ad,0xbefc5d27,0xbf14b039,0xbf5ebe05,0xbf5064af,0xbf0b9a6b,0xbf21cbfb,0xbf5695e5,0xbf466354
.long 0xbf187fc0,0xbf2e3bde,0xbf4d9f02,0xbf3b8f3b,0xbf24d225,0xbf39f2ac,0xbf43e200,0xbf2ff3e6,0xbf3085bb,0xbf44e3f5,0xbf396842,0xbf239da9,0xbf3b8f3b,0xbf4f0417,0xbf2e3bde,0xbf16999f
.long 0xbf45e403,0xbf584853,0xbf226799,0xbf08f59b,0xbf4f7a1f,0xbf60a6cf,0xbf15f6d9,0xbef58035,0xbf584853,0xbf6816a8,0xbf08f59b,0xbed8106b,0xbf604621,0xbf6e8ff8,0xbef6e0cb,0xbeb9bb1e
.long 0xbf676bd8,0xbf740bdd,0xbedae880,0xbe9aa086,0xbf6db293,0xbf788486,0xbebe1d4a,0xbe75c35a,0xbf731447,0xbf7bf531,0xbea09ae5,0xbe354098,0xbf778bc5,0xbf7e5a38,0xbe827dc0,0xbde7fa9a
.long 0xbf7b14be,0xbf7fb10f,0xbe47c5c2,0xbd48fb30,0xbf7dabcc,0xbf7ff84a,0xbe09cf86,0x3c7b514b,0xbf7f4e6d,0xbf7f2f9d,0xbd96a905,0x3da3308c,0xbf7ffb11,0xbf7d57de,0xbc490e90,0x3e1324ca
.long 0xbf7fb10f,0xbf7a7302,0x3d48fb30,0x3e541501,0xbf7e70b0,0xbf76841b,0x3de1bc2e,0x3e8a11f7,0xbf7c3b28,0xbf718f57,0x3e2f10a2,0x3ea986c4,0xbf791298,0xbf6b99fb,0x3e6c9a7f,0x3ec8477c
.long 0xbf74fa0b,0xbf64aa59,0x3e94a031,0x3ee63375,0xbf6ff573,0xbf5cc7d1,0x3eb263ef,0x3f019573,0xbf6a09a7,0xbf53fac3,0x3ecf7bca,0x3f0f8784,0xbf633c5a,0xbf4a4c87,0x3eebcbbb,0x3f1ce11f
.long 0xbf5b941a,0xbf3fc767,0x3f039c3d,0x3f299415,0xbf531849,0xbf34768f,0x3f10d3cd,0x3f3592e7,0xbf49d112,0xbf286605,0x3f1d7fd1,0x3f40d0da,0xbf3fc767,0xbf1ba299,0x3f299415,0x3f4b41fa
.long 0xbe47c5c2,0xbe94a031,0xbf7b14be,0xbf74fa0b,0xbe7ee6e1,0xbeb0eacb,0xbf77f110,0xbf703b37,0xbe9aa086,0xbecc9b8b,0xbf740bdd,0xbf6aab7b,0xbeb554ec,0xbee79a5d,0xbf6f6830,0xbf644fac
.long 0xbecf7bca,0xbf00e7e4,0xbf6a09a7,0xbf5d2d53,0xbee900b7,0xbf0d9281,0xbf63f473,0xbf554aa4,0xbf00e7e4,0xbf19c200,0xbf5d2d53,0xbf4cae79,0xbf0cead0,0xbf256bcb,0xbf55b993,0xbf436051
.long 0xbf187fc0,0xbf3085bb,0xbf4d9f02,0xbf396842,0xbf239da9,0xbf3b0629,0xbf44e3f5,0xbf2ecef7,0xbf2e3bde,0xbf44e3f5,0xbf3b8f3b,0xbf239da9,0xbf385216,0xbf4e1689,0xbf31a81d,0xbf17de12
.long 0xbf41d870,0xbf5695e5,0xbf273656,0xbf0b9a6b,0xbf4ac77f,0xbf5e5aa6,0xbf1c420c,0xbefdbabb,0xbf531849,0xbf655e0b,0xbf10d3cd,0xbee363fa,0xbf5ac450,0xbf6b99fb,0xbf04f484,0xbec8477c
.long 0xbf61c598,0xbf710908,0xbef15aea,0xbeac7cd4,0xbf6816a8,0xbf75a67b,0xbed8106b,0xbe901c2c,0xbf6db293,0xbf796e4e,0xbebe1d4a,0xbe667c66,0xbf7294f8,0xbf7c5d3a,0xbea395c5,0xbe2bf804
.long 0xbf76ba07,0xbf7e70b0,0xbe888e93,0xbde1bc2e,0xbf7a1e84,0xbf7fa6e3,0xbe5a3997,0xbd55880e,0xbf7cbfc9,0xbf7ffec4,0xbe22abb6,0x3bc90f88,0xbf7e9bc9,0xbf7f7808,0xbdd53db9,0x3d83db0a
.long 0xbf7fb10f,0xbf7e1324,0xbd48fb30,0x3dfab273,0xbf7ffec4,0xbf7bd14d,0x3bc90f88,0x3e3857ec,0xbf7f84ab,0xbf78b47b,0x3d7b2b74,0x3e72b651,0xbf7e4323,0xbf74bf62,0x3dee3876,0x3e9620d2
.long 0xbf7c3b28,0xbf6ff573,0x3e2f10a2,0x3eb263ef,0xbf796e4e,0xbf6a5ad9,0x3e667c66,0x3ece0bea,0xbf75dec6,0xbf63f473,0x3e8e9a22,0x3ee900b7,0xbf718f57,0xbf5cc7d1,0x3ea986c4,0x3f019573
.long 0xbf0e39da,0xbf226799,0xbf54db31,0xbf45e403,0xbf1c420c,0xbf2ff3e6,0xbf4ac77f,0xbf39f2ac,0xbf299415,0xbf3ca003,0xbf3fc767,0xbf2d1469,0xbf36206c,0xbf485bca,0xbf33e7bc,0xbf1f599f
.long 0xbf41d870,0xbf531849,0xbf273656,0xbf10d3cd,0xbf4cae79,0xbf5cc7d1,0xbf19c200,0xbf019573,0xbf5695e5,0xbf655e0b,0xbf0b9a6b,0xbee363fa,0xbf5f8327,0xbf6cd007,0xbef9a02d,0xbec27b55
.long 0xbf676bd8,0xbf731447,0xbedae880,0xbea09ae5,0xbf6e46be,0xbf7822d1,0xbebb31a0,0xbe7bdba4,0xbf740bdd,0xbf7bf531,0xbe9aa086,0xbe354098,0xbf78b47b,0xbf7e868b,0xbe72b651,0xbddb7d37
.long 0xbf7c3b28,0xbf7fd397,0xbe2f10a2,0xbd16c32c,0xbf7e9bc9,0xbf7fdaaf,0xbdd53db9,0x3d0a342f,0xbf7fd397,0xbf7e9bc9,0xbd16c32c,0x3dd53db9,0xbf7fe129,0xbf7c187a,0x3cfb49ba,0x3e3228d4
.long 0xbf7ec46d,0xbf7853f8,0x3dc8bd36,0x3e78cfcc,0xbf7c7eb0,0xbf73530e,0x3e28defc,0x3e9f1cdf,0xbf791298,0xbf6d1c1d,0x3e6c9a7f,0x3ec1071e,0xbf748422,0xbf65b710,0x3e97a117,0x3ee1fb6a
.long 0xbf6ed89e,0xbf5d2d53,0x3eb8442a,0x3f00e7e4,0xbf6816a8,0xbf5389c7,0x3ed8106b,0x3f102dd5,0xbf604621,0xbf48d8b3,0x3ef6e0cb,0x3f1ebc12,0xbf577026,0xbf3d27b8,0x3f0a48ad,0x3f2c800f
.long 0xbf4d9f02,0xbf3085bb,0x3f187fc0,0x3f396842,0xbf42de29,0xbf2302d3,0x3f26050a,0x3f456439,0xbf373a23,0xbf14b039,0x3f32c8c9,0x3f5064af,0xbf2ac082,0xbf05a02c,0x3f3ebc1b,0x3f5a5ba0
.long 0xbf1d7fd1,0xbeebcbbb,0x3f49d112,0x3f633c5a,0xbf0f8784,0xbecb2aae,0x3f53fac3,0x3f6afb8c,0xbf00e7e4,0xbea986c4,0x3f5d2d53,0x3f718f57,0xbee363fa,0xbe870ada,0x3f655e0b,0x3f76ef5b
.long 0xbf3504f3,0xbf45e403,0xbf3504f3,0xbf226799,0xbf41d870,0xbf51c0c2,0xbf273656,0xbf12c39a,0xbf4d9f02,0xbf5c61c7,0xbf187fc0,0xbf0242b1,0xbf584853,0xbf65b710,0xbf08f59b,0xbee1fb6a
.long 0xbf61c598,0xbf6db293,0xbef15aea,0xbebe1d4a,0xbf6a09a7,0xbf74484b,0xbecf7bca,0xbe9920fe,0xbf710908,0xbf796e4e,0xbeac7cd4,0xbe667c66,0xbf76ba07,0xbf7d1cdd,0xbe888e93,0xbe195be0
.long 0xbf7b14be,0xbf7f4e6d,0xbe47c5c2,0xbd96a905,0xbf7e1324,0xbf7fffb1,0xbdfab273,0x3b490fc6,0xbf7fb10f,0xbf7f2f9d,0xbd48fb30,0x3da3308c,0xbf7fec43,0xbf7cdf6c,0x3cc90ab0,0x3e1f917b
.long 0xbf7ec46d,0xbf791298,0x3dc8bd36,0x3e6c9a7f,0xbf7c3b28,0xbf73ced9,0x3e2f10a2,0x3e9c1faf,0xbf7853f8,0xbf6d1c1d,0x3e78cfcc,0x3ec1071e,0xbf731447,0xbf650479,0x3ea09ae5,0x3ee4cbfe
.long 0xbf6c835e,0xbf5b941a,0x3ec3ef15,0x3f039c3d,0xbf64aa59,0xbf50d937,0x3ee63375,0x3f140c5f,0xbf5b941a,0xbf44e3f5,0x3f039c3d,0x3f239da9,0xbf514d3d,0xbf37c655,0x3f13682a,0x3f3238aa
.long 0xbf45e403,0xbf299415,0x3f226799,0x3f3fc767,0xbf396842,0xbf1a6293,0x3f3085bb,0x3f4c3578,0xbf2beb4a,0xbf0a48ad,0x3f3daef9,0x3f577026,0xbf1d7fd1,0xbef2bd43,0x3f49d112,0x3f61668a
.long 0xbf0e39da,0xbecf7bca,0x3f54db31,0x3f6a09a7,0xbefc5d27,0xbeab0201,0x3f5ebe05,0x3f714c7a,0xbedae880,0xbe8586ce,0x3f676bd8,0x3f772417,0xbeb8442a,0xbe3e853e,0x3f6ed89e,0x3f7b87b2
.long 0xbe94a031,0xbde1bc2e,0x3f74fa0b,0x3f7e70b0,0xbe605c13,0xbd0a342f,0x3f79c79d,0x3f7fdaaf,0xbe164083,0x3d2fe007,0x3f7d3aac,0x3f7fc38f,0xbd96a905,0x3df475c0,0x3f7f4e6d,0x3f7e2b72
.long 0xbf6c835e,0xbf74fa0b,0xbec3ef15,0xbe94a031,0xbf740bdd,0xbf7a9c59,0xbe9aa086,0xbe5101f1,0xbf79c79d,0xbf7e4323,0xbe605c13,0xbdee3876,0xbf7dabcc,0xbf7fe705,0xbe09cf86,0xbce22a7a
.long 0xbf7fb10f,0xbf7f84ab,0xbd48fb30,0x3d7b2b74,0xbf7fd397,0xbf7d1cdd,0x3d16c32c,0x3e195be0,0xbf7e1324,0xbf78b47b,0x3dfab273,0x3e72b651,0xbf7a7302,0xbf725470,0x3e541501,0x3ea5129f
.long 0xbf74fa0b,0xbf6a09a7,0x3e94a031,0x3ecf7bca,0xbf6db293,0xbf5fe4e9,0x3ebe1d4a,0x3ef840c8,0xbf64aa59,0xbf53fac3,0x3ee63375,0x3f0f8784,0xbf59f26a,0xbf466354,0x3f064b82,0x3f21cbfb
.long 0xbf4d9f02,0xbf373a23,0x3f187fc0,0x3f32c8c9,0xbf3fc767,0xbf269de3,0x3f299415,0x3f425b89,0xbf3085bb,0xbf14b039,0x3f396842,0x3f5064af,0xbf1ff6cb,0xbf019573,0x3f47de65,0x3f5cc7d1
.long 0xbf0e39da,0xbedae880,0x3f54db31,0x3f676bd8,0xbef6e0cb,0xbeb0eacb,0x3f604621,0x3f703b37,0xbecf7bca,0xbe8586ce,0x3f6a09a7,0x3f772417,0xbea68f12,0xbe3228d4,0x3f721352,0x3f7c187a
.long 0xbe78cfcc,0xbdafb680,0x3f7853f8,0x3f7f0e58,0xbe22abb6,0x3b490fc6,0x3f7cbfc9,0x3f7fffb1,0xbd96a905,0x3dbc3ac3,0x3f7f4e6d,0x3f7eea9d,0x3c490e90,0x3e3857ec,0x3f7ffb11,0x3f7bd14d
.long 0x3dc8bd36,0x3e888e93,0x3f7ec46d,0x3f76ba07,0x3e3b6ecf,0x3eb3dca5,0x3f7baccd,0x3f6faf1b,0x3e888e93,0x3eddbe79,0x3f76ba07,0x3f66becc,0x3eb263ef,0x3f02ef9f,0x3f6ff573,0x3f5bfb34
.long 0x3edae880,0x3f15f6d9,0x3f676bd8,0x3f4f7a1f,0x3f00e7e4,0x3f27ce61,0x3f5d2d53,0x3f4154e1,0x3f13682a,0x3f385216,0x3f514d3d,0x3f31a81d,0x3f24d225,0x3f476085,0x3f43e200,0x3f209393
.long 0xbf54db31,0xbf61c598,0xbf0e39da,0xbef15aea,0xbf5f8327,0xbf6afb8c,0xbef9a02d,0xbecb2aae,0xbf68bf3c,0xbf7294f8,0xbed53641,0xbea395c5,0xbf708066,0xbf788486,0xbeaf713a,0xbe75c35a
.long 0xbf76ba07,0xbf7cbfc9,0xbe888e93,0xbe22abb6,0xbf7b61fc,0xbf7f3f54,0xbe419b37,0xbd9cecf9,0xbf7e70b0,0xbf7ffec4,0xbde1bc2e,0x3bc90f88,0xbf7fe129,0xbf7efcc9,0xbcfb49ba,0x3db5f8da
.long 0xbf7fb10f,0xbf7c3b28,0x3d48fb30,0x3e2f10a2,0xbf7de0b1,0xbf77beb7,0x3e039502,0x3e80f8c0,0xbf7a7302,0xbf718f57,0x3e541501,0x3ea986c4,0xbf756d97,0xbf69b7e4,0x3e919ddd,0x3ed0eb2a
.long 0xbf6ed89e,0xbf604621,0x3eb8442a,0x3ef6e0cb,0xbf66becc,0xbf554aa4,0x3eddbe79,0x3f0d9281,0xbf5d2d53,0xbf48d8b3,0x3f00e7e4,0x3f1ebc12,0xbf5233c6,0xbf3b0629,0x3f121eb0,0x3f2ecef7
.long 0xbf45e403,0xbf2beb4a,0x3f226799,0x3f3daef9,0xbf385216,0xbf1ba299,0x3f31a81d,0x3f4b41fa,0xbf299415,0xbf0a48ad,0x3f3fc767,0x3f577026,0xbf19c200,0xbeeff7fb,0x3f4cae79,0x3f62241a
.long 0xbf08f59b,0xbec9b953,0x3f584853,0x3f6b4b0c,0xbeee9479,0xbea21887,0x3f628210,0x3f72d4eb,0xbec9b953,0xbe72b651,0x3f6b4b0c,0x3f78b47b,0xbea395c5,0xbe1f917b,0x3f7294f8,0x3f7cdf6c
.long 0xbe78cfcc,0xbd96a905,0x3f7853f8,0x3f7f4e6d,0xbe28defc,0x3c16cb58,0x3f7c7eb0,0x3f7ffd39,0xbdafb680,0x3dbc3ac3,0x3f7f0e58,0x3f7eea9d,0xbbc90f88,0x3e3228d4,0x3f7ffec4,0x3f7c187a
.long 0x3d96a905,0x3e827dc0,0x3f7f4e6d,0x3f778bc5,0x3e1c76de,0x3eab0201,0x3f7cfe73,0x3f714c7a,0x3e6c9a7f,0x3ed25a09,0x3f791298,0x3f696591,0x3e9d9e78,0x3ef840c8,0x3f73913f,0x3f5fe4e9
.long 0xbf7b14be,0xbf7ec46d,0xbe47c5c2,0xbdc8bd36,0xbf7e9bc9,0xbf7fffb1,0xbdd53db9,0xbb490fc6,0xbf7ffb11,0xbf7eea9d,0xbc490e90,0x3dbc3ac3,0xbf7f2f9d,0xbf7b87b2,0x3da3308c,0x3e3e853e
.long 0xbf7c3b28,0xbf75dec6,0x3e2f10a2,0x3e8e9a22,0xbf772417,0xbf6dfcf2,0x3e8586ce,0x3ebca7af,0xbf6ff573,0xbf63f473,0x3eb263ef,0x3ee900b7,0xbf66becc,0xbf57dc7f,0x3eddbe79,0x3f099f4e
.long 0xbf5b941a,0xbf49d112,0x3f039c3d,0x3f1d7fd1,0xbf4e8d90,0xbf39f2ac,0x3f173c07,0x3f2ff3e6,0xbf3fc767,0xbf286605,0x3f299415,0x3f40d0da,0xbf2f61a5,0xbf1553b7,0x3f3a7ca4,0x3f4fefa8
.long 0xbf1d7fd1,0xbf00e7e4,0x3f49d112,0x3f5d2d53,0xbf0a48ad,0xbed6a399,0x3f577026,0x3f686b39,0xbeebcbbb,0xbea986c4,0x3f633c5a,0x3f718f57,0xbec1071e,0xbe75c35a,0x3f6d1c1d,0x3f788486
.long 0xbe94a031,0xbe164083,0x3f74fa0b,0x3f7d3aac,0xbe4dee60,0xbd55880e,0x3f7ac516,0x3f7fa6e3,0xbde1bc2e,0x3d2fe007,0x3f7e70b0,0x3f7fc38f,0xbc96c9b6,0x3e0cec4a,0x3f7ff4e6,0x3f7d906e
.long 0x3d96a905,0x3e6c9a7f,0x3f7f4e6d,0x3f791298,0x3e28defc,0x3ea5129f,0x3f7c7eb0,0x3f725470,0x3e827dc0,0x3ed25a09,0x3f778bc5,0x3f696591,0x3eaf713a,0x3efdbabb,0x3f708066,0x3f5e5aa6
.long 0x3edae880,0x3f13682a,0x3f676bd8,0x3f514d3d,0x3f0242b1,0x3f269de3,0x3f5c61c7,0x3f425b89,0x3f15f6d9,0x3f385216,0x3f4f7a1f,0x3f31a81d,0x3f286605,0x3f485bca,0x3f40d0da,0x3f1f599f
.long 0x3f396842,0x3f5695e5,0x3f3085bb,0x3f0b9a6b,0x3f48d8b3,0x3f62df7b,0x3f1ebc12,0x3eed3063,0x3f5695e5,0x3f6d1c1d,0x3f0b9a6b,0x3ec1071e,0x3f628210,0x3f75341d,0x3eee9479,0x3e931f35
```
